```python
import torch

def _softmax(x, axis=-1):
    return torch.softmax(x, dim=axis)
def _gelu(x):
    return torch.nn.functional.gelu(x, approximate="tanh")
def _silu(x):
    return torch.nn.functional.silu(x)
def _sigmoid(x):
    return torch.sigmoid(x)
def _layernorm(x, axis=-1, eps=1e-5):
    m = x.mean(dim=axis, keepdim=True)
    v = x.var(dim=axis, keepdim=True, unbiased=False)
    return (x - m) / torch.sqrt(v + eps)
def _scatter_add(tgt, idx, src, axis=0):
    return tgt.clone().index_add_(axis, idx, src)
def _segment_sum(src, seg, n):
    out = torch.zeros((n,) + src.shape[1:], dtype=src.dtype)
    return out.index_add_(0, seg, src)
def _pad(x, pw):
    flat = tuple(v for pair in reversed(pw) for v in pair)
    return torch.nn.functional.pad(x, flat)

kernel_name = 'concat_heads__mha_block_cached__gqa_block_cached__near_ridge'

def setup_inputs():

    _w = (lambda a: (lambda t: t.to(torch.bfloat16) if t.is_floating_point() else t)(torch.as_tensor(a)))
    def _A_setup():
        B, Sq, D = 8, 128, 512
        H, Sk, Dh = 32, 1024, 128
        return {
            "x": _w((lambda *s: torch.randn(*s, dtype=torch.bfloat16) * 0.8)(B, Sq, D)),
            "k_cache": _w((lambda *s: torch.randn(*s, dtype=torch.bfloat16) * 0.8)(B, H, Sk, Dh)),
            "v_cache": _w((lambda *s: torch.randn(*s, dtype=torch.bfloat16) * 0.05)(B, H, Sk, Dh)),
            "wq": _w((lambda *s: torch.randn(*s, dtype=torch.bfloat16) * 0.8)(D, H * Dh) * (D ** -0.5)),
            "wo": _w((lambda *s: torch.randn(*s, dtype=torch.bfloat16) * 0.05)(H * Dh, D) * ((H * Dh) ** -0.5)),
        }
    _A_in = _A_setup()

    def _B_setup():
        B, Sq, D = 8, 128, 512
        Hq, Hkv, Sk, Dh = 32, 32, 1024, 128
        assert Hq % Hkv == 0, (Hq, Hkv)
        return {
            "x": _w((lambda *s: torch.randn(*s, dtype=torch.bfloat16) * 0.8)(B, Sq, D)),
            "k_cache": _w((lambda *s: torch.randn(*s, dtype=torch.bfloat16) * 0.8)(B, Hkv, Sk, Dh)),
            "v_cache": _w((lambda *s: torch.randn(*s, dtype=torch.bfloat16) * 0.05)(B, Hkv, Sk, Dh)),
            "wq": _w((lambda *s: torch.randn(*s, dtype=torch.bfloat16) * 0.8)(D, Hq * Dh) * (D ** -0.5)),
            "wo": _w((lambda *s: torch.randn(*s, dtype=torch.bfloat16) * 0.05)(Hq * Dh, D) * ((Hq * Dh) ** -0.5)),
        }
    _B_in = _B_setup()

    return {
        "A_x": _A_in["x"],
        "A_k_cache": _A_in["k_cache"],
        "A_v_cache": _A_in["v_cache"],
        "A_wq": _A_in["wq"],
        "A_wo": _A_in["wo"],
        "B_x": _B_in["x"],
        "B_k_cache": _B_in["k_cache"],
        "B_v_cache": _B_in["v_cache"],
        "B_wq": _B_in["wq"],
        "B_wo": _B_in["wo"],
    }

def reference(A_x, A_k_cache, A_v_cache, A_wq, A_wo, B_x, B_k_cache, B_v_cache, B_wq, B_wo):
    def _A_ref(x, k_cache, v_cache, wq, wo):
        B, Sq, D = x.shape
        H, Dh = 32, 128
        q = (lambda x, *d: x.permute(*d))((x @ wq).reshape(B, Sq, H, Dh), 0, 2, 1, 3)
        scores = torch.einsum("bhqd,bhkd->bhqk", q, k_cache) * (Dh ** -0.5)
        p = _softmax(scores, axis=-1)
        o = torch.einsum("bhqk,bhkd->bhqd", p, v_cache)
        return (lambda x, *d: x.permute(*d))(o, 0, 2, 1, 3).reshape(B, Sq, H * Dh) @ wo

    def _B_ref(x, k_cache, v_cache, wq, wo):
        B, Sq, D = x.shape
        Hq, Dh = 32, 128
        Hkv = k_cache.shape[1]
        rep = Hq // Hkv
        q = (lambda x, *d: x.permute(*d))((x @ wq).reshape(B, Sq, Hq, Dh), 0, 2, 1, 3)
        k = (lambda x, n, axis: torch.repeat_interleave(x, n, dim=axis))(k_cache, rep, axis=1)
        v = (lambda x, n, axis: torch.repeat_interleave(x, n, dim=axis))(v_cache, rep, axis=1)
        scores = torch.einsum("bhqd,bhkd->bhqk", q, k) * (Dh ** -0.5)
        p = _softmax(scores, axis=-1)
        o = torch.einsum("bhqk,bhkd->bhqd", p, v)
        return (lambda x, *d: x.permute(*d))(o, 0, 2, 1, 3).reshape(B, Sq, Hq * Dh) @ wo

    a = _A_ref(A_x, A_k_cache, A_v_cache, A_wq, A_wo)
    b = _B_ref(B_x, B_k_cache, B_v_cache, B_wq, B_wo)
    return torch.concatenate([a, b], axis=-1)
```

```asm
; @launch grid=(256,1,1) block=(512,1,1) lds=163840
.amdgcn_target "amdgcn-amd-amdhsa--gfx950"
.text
.globl concat_heads__mha_block_cached__gqa_block_cached__near_ridge_kernel
.p2align 8
.type concat_heads__mha_block_cached__gqa_block_cached__near_ridge_kernel,@function
concat_heads__mha_block_cached__gqa_block_cached__near_ridge_kernel:
    s_cmp_ge_u32 s2, 256
    s_cbranch_scc1 L_end
    s_load_dwordx16 s[4:19], s[0:1], 0
    s_load_dwordx4 s[20:23], s[0:1], 64
    s_load_dwordx4 s[24:27], s[0:1], 80
    s_load_dwordx2 s[28:29], s[0:1], 96
    v_lshrrev_b32 v24, 6, v0
    v_and_b32 v22, 63, v0
    v_readfirstlane_b32 s52, v24
    s_bfe_u32 s53, s2, 0x10002
    s_and_b32 s97, s2, 3
    s_bfe_u32 s98, s2, 0x20003
    s_bfe_u32 s55, s2, 0x30005
    s_lshr_b32 s96, s52, 2
    s_and_b32 s52, s52, 3
    s_lshl_b32 s54, s97, 2
    s_add_u32 s54, s54, s98
    s_lshl_b32 s54, s54, 1
    s_lshl_b32 s30, s98, 1
    s_add_u32 s30, s30, s55
    s_and_b32 s30, s30, 4
    s_lshl_b32 s56, s52, 11
    s_lshl_b32 s101, s52, 12
    s_add_u32 s101, s101, 114688
    v_lshrrev_b32 v24, 4, v22
    v_and_b32 v25, 15, v22
    v_lshlrev_b32 v26, 1, v24
    v_xor_b32 v26, v26, v25
    v_lshlrev_b32 v26, 4, v26
    v_lshl_add_u32 v14, v24, 8, v26
    v_lshl_add_u32 v248, v24, 13, v26
    s_lshl_b32 s60, s52, 16
    v_add_u32 v248, s60, v248
    v_xor_b32 v249, 0x80, v248
    v_lshrrev_b32 v26, 3, v22
    v_and_b32 v27, 7, v22
    v_xor_b32 v27, v27, v24
    v_lshlrev_b32 v20, 10, v26
    v_lshl_add_u32 v20, v27, 4, v20
    s_lshl_b32 s60, s52, 15
    v_add_u32 v20, s60, v20
    v_xor_b32 v21, 64, v20
    s_waitcnt lgkmcnt(0)
    s_cmp_eq_u32 s53, 0
    s_cselect_b64 s[4:5], s[4:5], s[14:15]
    s_cselect_b64 s[6:7], s[6:7], s[16:17]
    s_cselect_b64 s[8:9], s[8:9], s[18:19]
    s_cselect_b64 s[10:11], s[10:11], s[20:21]
    s_cselect_b64 s[12:13], s[12:13], s[22:23]
    s_lshl_b32 s60, s55, 17
    s_add_u32 s40, s4, s60
    s_addc_u32 s41, s5, 0
    s_mov_b32 s42, 131072
    s_mov_b32 s43, 0x20000
    s_lshl_b32 s60, s54, 8
    s_add_u32 s44, s10, s60
    s_addc_u32 s45, s11, 0
    s_mov_b32 s46, 0
    s_mov_b32 s47, 0x20000
    s_sub_u32 s46, 4194304, s60
    s_add_u32 s15, s56, 65536
    s_cmp_lg_u32 s96, 0
    s_cbranch_scc0 L_g0
L_g1:
    s_setprio 3
    s_add_u32 s3, s30, 0
    s_and_b32 s3, s3, 7
    s_lshl_b32 s3, s3, 7
    s_add_u32 m0, s101, 0
    s_add_u32 s60, s3, 0
    buffer_load_dwordx4 v20, s[40:43], s60 offen lds
    s_add_u32 m0, s101, 1024
    s_add_u32 s60, s3, 8192
    buffer_load_dwordx4 v21, s[40:43], s60 offen lds
    s_add_u32 m0, s101, 2048
    s_add_u32 s60, s3, 16384
    buffer_load_dwordx4 v20, s[40:43], s60 offen lds
    s_add_u32 m0, s101, 3072
    s_add_u32 s60, s3, 24576
    buffer_load_dwordx4 v21, s[40:43], s60 offen lds
    s_lshl_b32 s31, s3, 12
    s_add_u32 m0, s15, 0
    s_add_u32 s60, s31, 0
    buffer_load_dwordx4 v248, s[44:47], s60 offen lds
    s_add_u32 m0, s15, 1024
    s_add_u32 s60, s31, 32768
    buffer_load_dwordx4 v249, s[44:47], s60 offen lds
    s_add_u32 m0, s15, 8192
    s_add_u32 s60, s31, 262144
    buffer_load_dwordx4 v248, s[44:47], s60 offen lds
    s_add_u32 m0, s15, 9216
    s_add_u32 s60, s31, 294912
    buffer_load_dwordx4 v249, s[44:47], s60 offen lds
    s_lshl_b32 s60, s55, 5
    s_add_u32 s60, s60, s54
    s_lshl_b32 s60, s60, 18
    s_add_u32 s32, s6, s60
    s_addc_u32 s33, s7, 0
    s_mov_b32 s34, 524288
    s_mov_b32 s35, 0x20000
    s_add_u32 s36, s8, s60
    s_addc_u32 s37, s9, 0
    s_mov_b32 s38, 524288
    s_mov_b32 s39, 0x20000
    s_lshl_b32 s21, s53, 3
    s_add_u32 s21, s21, s55
    s_lshl_b32 s21, s21, 2
    s_add_u32 s60, s21, s97
    s_lshl_b32 s60, s60, 2
    s_add_u32 s60, s60, s52
    s_lshl_b32 s60, s60, 2
    s_add_u32 s60, s60, s98
    s_mul_i32 s60, s60, 8192
    s_add_u32 s60, s60, 67108864
    s_add_u32 s48, s28, s60
    s_addc_u32 s49, s29, 0
    s_mov_b32 s50, 8192
    s_mov_b32 s51, 0x20000
    s_add_u32 s16, s28, 50331648
    s_addc_u32 s17, s29, 0
    s_mov_b32 s18, 557184
    s_mov_b32 s19, 0x20000
    s_add_u32 s23, s21, s97
    s_lshl_b32 s23, s23, 3
    s_add_u32 s23, s23, s52
    s_lshl_b32 s60, s96, 2
    s_add_u32 s23, s23, s60
    s_lshl_b32 s23, s23, 9
    s_lshl_b32 s20, s98, 7
    s_add_u32 s20, s20, s23
    s_add_u32 s7, s21, s97
    s_lshl_b32 s7, s7, 9
    s_add_u32 s7, s7, 262144
    s_lshl_b32 s14, s2, 2
    s_add_u32 s14, s14, s52
    s_mov_b32 s61, 0x41000000
    s_mov_b32 s62, 0x3e0293ee
    s_add_u32 s57, s56, 0
    s_add_u32 s58, s56, 0
    v_xor_b32 v15, 0x80, v14
    s_and_b32 s60, s52, 1
    s_lshl_b32 s60, s60, 3
    v_add_u32 v26, s60, v24
    v_xor_b32 v12, v26, v25
    v_xor_b32 v13, 4, v12
    v_lshlrev_b32 v12, 4, v12
    v_lshlrev_b32 v13, 4, v13
    v_lshl_add_u32 v12, v24, 8, v12
    v_lshl_add_u32 v13, v24, 8, v13
    v_lshrrev_b32 v26, 1, v25
    v_lshrrev_b32 v27, 1, v24
    v_xor_b32 v26, v26, v27
    v_lshlrev_b32 v26, 4, v26
    v_lshl_add_u32 v16, v25, 7, v26
    v_and_b32 v27, 1, v24
    v_lshl_add_u32 v16, v27, 3, v16
    v_add_u32 v16, s101, v16
    v_xor_b32 v17, 32, v16
    v_xor_b32 v18, 64, v16
    v_xor_b32 v19, 96, v16
    v_xor_b32 v0, v24, v25
    v_lshlrev_b32 v0, 4, v0
    v_lshl_add_u32 v0, v25, 8, v0
    v_xor_b32 v1, 64, v0
    v_xor_b32 v2, 128, v0
    v_xor_b32 v3, 192, v0
    v_lshrrev_b32 v26, 2, v22
    v_and_b32 v27, 7, v26
    v_lshlrev_b32 v27, 5, v27
    v_lshl_add_u32 v4, v26, 8, v27
    v_and_b32 v26, 3, v22
    v_lshl_add_u32 v4, v26, 3, v4
    v_add_u32 v4, 65536, v4
    v_xor_b32 v5, 32, v4
    v_xor_b32 v6, 64, v4
    v_xor_b32 v7, 96, v4
    v_xor_b32 v8, 128, v4
    v_xor_b32 v9, 160, v4
    v_xor_b32 v10, 192, v4
    v_xor_b32 v11, 224, v4
    v_lshlrev_b32 v23, 4, v22
    v_mov_b32 v254, 0
    s_add_u32 s3, s30, 1
    s_and_b32 s3, s3, 7
    s_lshl_b32 s3, s3, 7
    s_add_u32 m0, s101, 16384
    s_add_u32 s60, s3, 0
    buffer_load_dwordx4 v20, s[40:43], s60 offen lds
    s_add_u32 m0, s101, 17408
    s_add_u32 s60, s3, 8192
    buffer_load_dwordx4 v21, s[40:43], s60 offen lds
    s_add_u32 m0, s101, 18432
    s_add_u32 s60, s3, 16384
    buffer_load_dwordx4 v20, s[40:43], s60 offen lds
    s_add_u32 m0, s101, 19456
    s_add_u32 s60, s3, 24576
    buffer_load_dwordx4 v21, s[40:43], s60 offen lds
    s_lshl_b32 s31, s3, 12
    s_add_u32 m0, s15, 16384
    s_add_u32 s60, s31, 0
    buffer_load_dwordx4 v248, s[44:47], s60 offen lds
    s_add_u32 m0, s15, 17408
    s_add_u32 s60, s31, 32768
    buffer_load_dwordx4 v249, s[44:47], s60 offen lds
    s_add_u32 m0, s15, 24576
    s_add_u32 s60, s31, 262144
    buffer_load_dwordx4 v248, s[44:47], s60 offen lds
    s_add_u32 m0, s15, 25600
    s_add_u32 s60, s31, 294912
    buffer_load_dwordx4 v249, s[44:47], s60 offen lds
    s_waitcnt vmcnt(8)
    s_barrier
    ds_read_b64 v[120:121], v16 offset:0
    ds_read_b64 v[122:123], v17 offset:0
    ds_read_b64 v[124:125], v16 offset:2048
    ds_read_b64 v[126:127], v17 offset:2048
    ds_read_b64 v[128:129], v18 offset:0
    ds_read_b64 v[130:131], v19 offset:0
    ds_read_b64 v[132:133], v18 offset:2048
    ds_read_b64 v[134:135], v19 offset:2048
    s_add_u32 s3, s30, 2
    s_and_b32 s3, s3, 7
    s_lshl_b32 s3, s3, 7
    s_add_u32 m0, s101, 32768
    s_add_u32 s60, s3, 0
    buffer_load_dwordx4 v20, s[40:43], s60 offen lds
    s_add_u32 m0, s101, 33792
    s_add_u32 s60, s3, 8192
    buffer_load_dwordx4 v21, s[40:43], s60 offen lds
    s_add_u32 m0, s101, 34816
    s_add_u32 s60, s3, 16384
    buffer_load_dwordx4 v20, s[40:43], s60 offen lds
    s_add_u32 m0, s101, 35840
    s_add_u32 s60, s3, 24576
    buffer_load_dwordx4 v21, s[40:43], s60 offen lds
    s_lshl_b32 s31, s3, 12
    s_add_u32 m0, s15, 32768
    s_add_u32 s60, s31, 0
    buffer_load_dwordx4 v248, s[44:47], s60 offen lds
    s_add_u32 m0, s15, 33792
    s_add_u32 s60, s31, 32768
    buffer_load_dwordx4 v249, s[44:47], s60 offen lds
    s_add_u32 m0, s15, 40960
    s_add_u32 s60, s31, 262144
    buffer_load_dwordx4 v248, s[44:47], s60 offen lds
    s_add_u32 m0, s15, 41984
    s_add_u32 s60, s31, 294912
    buffer_load_dwordx4 v249, s[44:47], s60 offen lds
    s_waitcnt vmcnt(8) lgkmcnt(0)
    s_barrier
    ds_read_b64 v[136:137], v16 offset:16384
    ds_read_b64 v[138:139], v17 offset:16384
    ds_read_b64 v[140:141], v16 offset:18432
    ds_read_b64 v[142:143], v17 offset:18432
    ds_read_b64 v[144:145], v18 offset:16384
    ds_read_b64 v[146:147], v19 offset:16384
    ds_read_b64 v[148:149], v18 offset:18432
    ds_read_b64 v[150:151], v19 offset:18432
    s_add_u32 s3, s30, 3
    s_and_b32 s3, s3, 7
    s_lshl_b32 s3, s3, 7
    s_add_u32 m0, s101, 0
    s_add_u32 s60, s3, 0
    buffer_load_dwordx4 v20, s[40:43], s60 offen lds
    s_add_u32 m0, s101, 1024
    s_add_u32 s60, s3, 8192
    buffer_load_dwordx4 v21, s[40:43], s60 offen lds
    s_add_u32 m0, s101, 2048
    s_add_u32 s60, s3, 16384
    buffer_load_dwordx4 v20, s[40:43], s60 offen lds
    s_add_u32 m0, s101, 3072
    s_add_u32 s60, s3, 24576
    buffer_load_dwordx4 v21, s[40:43], s60 offen lds
    s_lshl_b32 s31, s3, 12
    s_add_u32 m0, s15, 0
    s_add_u32 s60, s31, 0
    buffer_load_dwordx4 v248, s[44:47], s60 offen lds
    s_add_u32 m0, s15, 1024
    s_add_u32 s60, s31, 32768
    buffer_load_dwordx4 v249, s[44:47], s60 offen lds
    s_add_u32 m0, s15, 8192
    s_add_u32 s60, s31, 262144
    buffer_load_dwordx4 v248, s[44:47], s60 offen lds
    s_add_u32 m0, s15, 9216
    s_add_u32 s60, s31, 294912
    buffer_load_dwordx4 v249, s[44:47], s60 offen lds
    s_waitcnt vmcnt(8) lgkmcnt(0)
    s_barrier
    ds_read_b64 v[152:153], v16 offset:32768
    ds_read_b64 v[154:155], v17 offset:32768
    ds_read_b64 v[156:157], v16 offset:34816
    ds_read_b64 v[158:159], v17 offset:34816
    ds_read_b64 v[160:161], v18 offset:32768
    ds_read_b64 v[162:163], v19 offset:32768
    ds_read_b64 v[164:165], v18 offset:34816
    ds_read_b64 v[166:167], v19 offset:34816
    s_add_u32 s3, s30, 4
    s_and_b32 s3, s3, 7
    s_lshl_b32 s3, s3, 7
    s_add_u32 m0, s101, 16384
    s_add_u32 s60, s3, 0
    buffer_load_dwordx4 v20, s[40:43], s60 offen lds
    s_add_u32 m0, s101, 17408
    s_add_u32 s60, s3, 8192
    buffer_load_dwordx4 v21, s[40:43], s60 offen lds
    s_add_u32 m0, s101, 18432
    s_add_u32 s60, s3, 16384
    buffer_load_dwordx4 v20, s[40:43], s60 offen lds
    s_add_u32 m0, s101, 19456
    s_add_u32 s60, s3, 24576
    buffer_load_dwordx4 v21, s[40:43], s60 offen lds
    s_lshl_b32 s31, s3, 12
    s_add_u32 m0, s15, 16384
    s_add_u32 s60, s31, 0
    buffer_load_dwordx4 v248, s[44:47], s60 offen lds
    s_add_u32 m0, s15, 17408
    s_add_u32 s60, s31, 32768
    buffer_load_dwordx4 v249, s[44:47], s60 offen lds
    s_add_u32 m0, s15, 24576
    s_add_u32 s60, s31, 262144
    buffer_load_dwordx4 v248, s[44:47], s60 offen lds
    s_add_u32 m0, s15, 25600
    s_add_u32 s60, s31, 294912
    buffer_load_dwordx4 v249, s[44:47], s60 offen lds
    s_waitcnt vmcnt(8) lgkmcnt(0)
    s_barrier
    ds_read_b64 v[168:169], v16 offset:0
    ds_read_b64 v[170:171], v17 offset:0
    ds_read_b64 v[172:173], v16 offset:2048
    ds_read_b64 v[174:175], v17 offset:2048
    ds_read_b64 v[176:177], v18 offset:0
    ds_read_b64 v[178:179], v19 offset:0
    ds_read_b64 v[180:181], v18 offset:2048
    ds_read_b64 v[182:183], v19 offset:2048
    s_add_u32 s3, s30, 5
    s_and_b32 s3, s3, 7
    s_lshl_b32 s3, s3, 7
    s_add_u32 m0, s101, 32768
    s_add_u32 s60, s3, 0
    buffer_load_dwordx4 v20, s[40:43], s60 offen lds
    s_add_u32 m0, s101, 33792
    s_add_u32 s60, s3, 8192
    buffer_load_dwordx4 v21, s[40:43], s60 offen lds
    s_add_u32 m0, s101, 34816
    s_add_u32 s60, s3, 16384
    buffer_load_dwordx4 v20, s[40:43], s60 offen lds
    s_add_u32 m0, s101, 35840
    s_add_u32 s60, s3, 24576
    buffer_load_dwordx4 v21, s[40:43], s60 offen lds
    s_lshl_b32 s31, s3, 12
    s_add_u32 m0, s15, 32768
    s_add_u32 s60, s31, 0
    buffer_load_dwordx4 v248, s[44:47], s60 offen lds
    s_add_u32 m0, s15, 33792
    s_add_u32 s60, s31, 32768
    buffer_load_dwordx4 v249, s[44:47], s60 offen lds
    s_add_u32 m0, s15, 40960
    s_add_u32 s60, s31, 262144
    buffer_load_dwordx4 v248, s[44:47], s60 offen lds
    s_add_u32 m0, s15, 41984
    s_add_u32 s60, s31, 294912
    buffer_load_dwordx4 v249, s[44:47], s60 offen lds
    s_waitcnt vmcnt(8) lgkmcnt(0)
    s_barrier
    ds_read_b64 v[184:185], v16 offset:16384
    ds_read_b64 v[186:187], v17 offset:16384
    ds_read_b64 v[188:189], v16 offset:18432
    ds_read_b64 v[190:191], v17 offset:18432
    ds_read_b64 v[192:193], v18 offset:16384
    ds_read_b64 v[194:195], v19 offset:16384
    ds_read_b64 v[196:197], v18 offset:18432
    ds_read_b64 v[198:199], v19 offset:18432
    s_add_u32 s3, s30, 6
    s_and_b32 s3, s3, 7
    s_lshl_b32 s3, s3, 7
    s_add_u32 m0, s101, 0
    s_add_u32 s60, s3, 0
    buffer_load_dwordx4 v20, s[40:43], s60 offen lds
    s_add_u32 m0, s101, 1024
    s_add_u32 s60, s3, 8192
    buffer_load_dwordx4 v21, s[40:43], s60 offen lds
    s_add_u32 m0, s101, 2048
    s_add_u32 s60, s3, 16384
    buffer_load_dwordx4 v20, s[40:43], s60 offen lds
    s_add_u32 m0, s101, 3072
    s_add_u32 s60, s3, 24576
    buffer_load_dwordx4 v21, s[40:43], s60 offen lds
    s_lshl_b32 s31, s3, 12
    s_add_u32 m0, s15, 0
    s_add_u32 s60, s31, 0
    buffer_load_dwordx4 v248, s[44:47], s60 offen lds
    s_add_u32 m0, s15, 1024
    s_add_u32 s60, s31, 32768
    buffer_load_dwordx4 v249, s[44:47], s60 offen lds
    s_add_u32 m0, s15, 8192
    s_add_u32 s60, s31, 262144
    buffer_load_dwordx4 v248, s[44:47], s60 offen lds
    s_add_u32 m0, s15, 9216
    s_add_u32 s60, s31, 294912
    buffer_load_dwordx4 v249, s[44:47], s60 offen lds
    s_waitcnt vmcnt(8) lgkmcnt(0)
    s_barrier
    ds_read_b64 v[200:201], v16 offset:32768
    ds_read_b64 v[202:203], v17 offset:32768
    ds_read_b64 v[204:205], v16 offset:34816
    ds_read_b64 v[206:207], v17 offset:34816
    ds_read_b64 v[208:209], v18 offset:32768
    ds_read_b64 v[210:211], v19 offset:32768
    ds_read_b64 v[212:213], v18 offset:34816
    ds_read_b64 v[214:215], v19 offset:34816
    s_add_u32 s3, s30, 7
    s_and_b32 s3, s3, 7
    s_lshl_b32 s3, s3, 7
    s_add_u32 m0, s101, 16384
    s_add_u32 s60, s3, 0
    buffer_load_dwordx4 v20, s[40:43], s60 offen lds
    s_add_u32 m0, s101, 17408
    s_add_u32 s60, s3, 8192
    buffer_load_dwordx4 v21, s[40:43], s60 offen lds
    s_add_u32 m0, s101, 18432
    s_add_u32 s60, s3, 16384
    buffer_load_dwordx4 v20, s[40:43], s60 offen lds
    s_add_u32 m0, s101, 19456
    s_add_u32 s60, s3, 24576
    buffer_load_dwordx4 v21, s[40:43], s60 offen lds
    s_lshl_b32 s31, s3, 12
    s_add_u32 m0, s15, 16384
    s_add_u32 s60, s31, 0
    buffer_load_dwordx4 v248, s[44:47], s60 offen lds
    s_add_u32 m0, s15, 17408
    s_add_u32 s60, s31, 32768
    buffer_load_dwordx4 v249, s[44:47], s60 offen lds
    s_add_u32 m0, s15, 24576
    s_add_u32 s60, s31, 262144
    buffer_load_dwordx4 v248, s[44:47], s60 offen lds
    s_add_u32 m0, s15, 25600
    s_add_u32 s60, s31, 294912
    buffer_load_dwordx4 v249, s[44:47], s60 offen lds
    s_waitcnt vmcnt(8) lgkmcnt(0)
    s_barrier
    ds_read_b64 v[216:217], v16 offset:0
    ds_read_b64 v[218:219], v17 offset:0
    ds_read_b64 v[220:221], v16 offset:2048
    ds_read_b64 v[222:223], v17 offset:2048
    ds_read_b64 v[224:225], v18 offset:0
    ds_read_b64 v[226:227], v19 offset:0
    ds_read_b64 v[228:229], v18 offset:2048
    ds_read_b64 v[230:231], v19 offset:2048
    s_add_u32 m0, s56, 0
    s_nop 0
    buffer_load_dwordx4 v12, s[32:35], s57 offen nt lds
    buffer_load_dwordx4 v13, s[32:35], s57 offen offset:1024 nt lds
    s_add_u32 s57, s57, 8192
    s_add_u32 m0, s56, 8192
    s_nop 0
    buffer_load_dwordx4 v12, s[32:35], s57 offen nt lds
    buffer_load_dwordx4 v13, s[32:35], s57 offen offset:1024 nt lds
    s_add_u32 s57, s57, 8192
    s_add_u32 m0, s56, 16384
    s_nop 0
    buffer_load_dwordx4 v14, s[36:39], s58 offen nt lds
    buffer_load_dwordx4 v15, s[36:39], s58 offen offset:1024 nt lds
    s_add_u32 s58, s58, 8192
    s_waitcnt vmcnt(6) lgkmcnt(0)
    s_barrier
    ds_read_b64 v[232:233], v16 offset:16384
    ds_read_b64 v[234:235], v17 offset:16384
    ds_read_b64 v[236:237], v16 offset:18432
    ds_read_b64 v[238:239], v17 offset:18432
    ds_read_b64 v[240:241], v18 offset:16384
    ds_read_b64 v[242:243], v19 offset:16384
    ds_read_b64 v[244:245], v18 offset:18432
    ds_read_b64 v[246:247], v19 offset:18432
    s_add_u32 m0, s56, 24576
    s_nop 0
    buffer_load_dwordx4 v12, s[32:35], s57 offen nt lds
    buffer_load_dwordx4 v13, s[32:35], s57 offen offset:1024 nt lds
    s_add_u32 s57, s57, 8192
    s_add_u32 m0, s56, 32768
    s_nop 0
    buffer_load_dwordx4 v14, s[36:39], s58 offen nt lds
    buffer_load_dwordx4 v15, s[36:39], s58 offen offset:1024 nt lds
    s_add_u32 s58, s58, 8192
    s_waitcnt lgkmcnt(0)
    s_barrier
    s_add_u32 m0, s56, 40960
    s_nop 0
    buffer_load_dwordx4 v12, s[32:35], s57 offen nt lds
    buffer_load_dwordx4 v13, s[32:35], s57 offen offset:1024 nt lds
    s_add_u32 s57, s57, 8192
    s_waitcnt vmcnt(8)
    s_barrier
    s_setprio 0
    s_mov_b32 s40, s26
    s_mov_b32 s41, s27
    s_mov_b32 s42, 256
    s_mov_b32 s43, 0x20000
    s_add_u32 s44, s44, 256
    s_addc_u32 s45, s45, 0
    s_sub_u32 s46, s46, 256
    s_lshl_b32 s60, s98, 8
    s_add_u32 s8, s12, s60
    s_addc_u32 s9, s13, 0
    s_mov_b32 s10, 0
    s_mov_b32 s11, 0x20000
    s_sub_u32 s10, 4194304, s60
    v_lshrrev_b32 v16, 4, v22
    v_mul_u32_u24 v16, 768, v16
    v_add_u32 v16, v14, v16
    s_lshl_b32 s60, s52, 13
    v_add_u32 v16, s60, v16
    v_xor_b32 v17, 0x80, v16
    s_waitcnt vmcnt(4) lgkmcnt(0)
    s_barrier
    s_add_u32 s31, s30, 0
    s_and_b32 s31, s31, 7
    s_lshl_b32 s31, s31, 19
    s_add_u32 m0, s15, 0
    s_add_u32 s60, s31, 0
    buffer_load_dwordx4 v248, s[44:47], s60 offen lds
    s_add_u32 m0, s15, 1024
    s_add_u32 s60, s31, 32768
    buffer_load_dwordx4 v249, s[44:47], s60 offen lds
    s_cmp_eq_u32 s14, 0
    s_cbranch_scc0 L_nc0
    s_mov_b32 s60, 557056
    buffer_load_dword v252, v254, s[16:19], s60 offen sc1
L_nc0:
    s_waitcnt vmcnt(2) lgkmcnt(0)
    s_barrier
    s_add_u32 s31, s30, 0
    s_and_b32 s31, s31, 7
    s_lshl_b32 s31, s31, 19
    s_add_u32 m0, s15, 8192
    s_add_u32 s60, s31, 262144
    buffer_load_dwordx4 v248, s[44:47], s60 offen lds
    s_add_u32 m0, s15, 9216
    s_add_u32 s60, s31, 294912
    buffer_load_dwordx4 v249, s[44:47], s60 offen lds
    s_waitcnt lgkmcnt(0)
    s_barrier
    s_add_u32 s31, s30, 1
    s_and_b32 s31, s31, 7
    s_lshl_b32 s31, s31, 19
    s_add_u32 m0, s15, 16384
    s_add_u32 s60, s31, 0
    buffer_load_dwordx4 v248, s[44:47], s60 offen lds
    s_add_u32 m0, s15, 17408
    s_add_u32 s60, s31, 32768
    buffer_load_dwordx4 v249, s[44:47], s60 offen lds
    s_add_u32 s31, s30, 1
    s_and_b32 s31, s31, 7
    s_lshl_b32 s31, s31, 19
    s_add_u32 m0, s15, 24576
    s_add_u32 s60, s31, 262144
    buffer_load_dwordx4 v248, s[44:47], s60 offen lds
    s_add_u32 m0, s15, 25600
    s_add_u32 s60, s31, 294912
    buffer_load_dwordx4 v249, s[44:47], s60 offen lds
    s_waitcnt vmcnt(6) lgkmcnt(0)
    s_barrier
    ds_read_b64_tr_b16 v[24:25], v4 offset:0
    ds_read_b64_tr_b16 v[26:27], v4 offset:4096
    ds_read_b64_tr_b16 v[28:29], v5 offset:0
    ds_read_b64_tr_b16 v[30:31], v5 offset:4096
    ds_read_b64_tr_b16 v[32:33], v6 offset:0
    ds_read_b64_tr_b16 v[34:35], v6 offset:4096
    ds_read_b64_tr_b16 v[36:37], v7 offset:0
    ds_read_b64_tr_b16 v[38:39], v7 offset:4096
    ds_read_b64_tr_b16 v[40:41], v8 offset:0
    ds_read_b64_tr_b16 v[42:43], v8 offset:4096
    ds_read_b64_tr_b16 v[44:45], v9 offset:0
    ds_read_b64_tr_b16 v[46:47], v9 offset:4096
    ds_read_b64_tr_b16 v[48:49], v10 offset:0
    ds_read_b64_tr_b16 v[50:51], v10 offset:4096
    ds_read_b64_tr_b16 v[52:53], v11 offset:0
    ds_read_b64_tr_b16 v[54:55], v11 offset:4096
    s_waitcnt lgkmcnt(14)
    v_mfma_f32_16x16x32_bf16 v[56:59], v[24:27], v[120:123], 0
    s_waitcnt lgkmcnt(12)
    v_mfma_f32_16x16x32_bf16 v[60:63], v[28:31], v[120:123], 0
    s_waitcnt lgkmcnt(10)
    v_mfma_f32_16x16x32_bf16 v[64:67], v[32:35], v[120:123], 0
    s_waitcnt lgkmcnt(8)
    v_mfma_f32_16x16x32_bf16 v[68:71], v[36:39], v[120:123], 0
    s_waitcnt lgkmcnt(6)
    v_mfma_f32_16x16x32_bf16 v[72:75], v[40:43], v[120:123], 0
    s_waitcnt lgkmcnt(4)
    v_mfma_f32_16x16x32_bf16 v[76:79], v[44:47], v[120:123], 0
    s_waitcnt lgkmcnt(2)
    v_mfma_f32_16x16x32_bf16 v[80:83], v[48:51], v[120:123], 0
    s_waitcnt lgkmcnt(0)
    v_mfma_f32_16x16x32_bf16 v[84:87], v[52:55], v[120:123], 0
    v_mfma_f32_16x16x32_bf16 v[88:91], v[24:27], v[124:127], 0
    v_mfma_f32_16x16x32_bf16 v[92:95], v[28:31], v[124:127], 0
    v_mfma_f32_16x16x32_bf16 v[96:99], v[32:35], v[124:127], 0
    v_mfma_f32_16x16x32_bf16 v[100:103], v[36:39], v[124:127], 0
    v_mfma_f32_16x16x32_bf16 v[104:107], v[40:43], v[124:127], 0
    v_mfma_f32_16x16x32_bf16 v[108:111], v[44:47], v[124:127], 0
    v_mfma_f32_16x16x32_bf16 v[112:115], v[48:51], v[124:127], 0
    v_mfma_f32_16x16x32_bf16 v[116:119], v[52:55], v[124:127], 0
    s_waitcnt vmcnt(4) lgkmcnt(0)
    s_barrier
    s_add_u32 s31, s30, 2
    s_and_b32 s31, s31, 7
    s_lshl_b32 s31, s31, 19
    s_add_u32 m0, s15, 0
    s_add_u32 s60, s31, 0
    buffer_load_dwordx4 v248, s[44:47], s60 offen lds
    s_add_u32 m0, s15, 1024
    s_add_u32 s60, s31, 32768
    buffer_load_dwordx4 v249, s[44:47], s60 offen lds
    s_cmp_eq_u32 s14, 0
    s_cbranch_scc0 L_nc4
    s_waitcnt vmcnt(8)
    v_readfirstlane_b32 s99, v252
    s_nop 0
    s_add_u32 s99, s99, 1
    s_max_u32 s99, s99, 1
    v_mov_b32 v252, s99
    v_mov_b32 v253, 0
    s_mov_b64 exec, 1
    buffer_atomic_cmpswap v[252:253], v254, s[40:43], 0 offen sc0 sc1
    s_mov_b64 exec, -1
L_nc4:
    ds_read_b64_tr_b16 v[24:25], v4 offset:8192
    ds_read_b64_tr_b16 v[26:27], v4 offset:12288
    ds_read_b64_tr_b16 v[28:29], v5 offset:8192
    ds_read_b64_tr_b16 v[30:31], v5 offset:12288
    ds_read_b64_tr_b16 v[32:33], v6 offset:8192
    ds_read_b64_tr_b16 v[34:35], v6 offset:12288
    ds_read_b64_tr_b16 v[36:37], v7 offset:8192
    ds_read_b64_tr_b16 v[38:39], v7 offset:12288
    ds_read_b64_tr_b16 v[40:41], v8 offset:8192
    ds_read_b64_tr_b16 v[42:43], v8 offset:12288
    ds_read_b64_tr_b16 v[44:45], v9 offset:8192
    ds_read_b64_tr_b16 v[46:47], v9 offset:12288
    ds_read_b64_tr_b16 v[48:49], v10 offset:8192
    ds_read_b64_tr_b16 v[50:51], v10 offset:12288
    ds_read_b64_tr_b16 v[52:53], v11 offset:8192
    ds_read_b64_tr_b16 v[54:55], v11 offset:12288
    s_waitcnt lgkmcnt(14)
    v_mfma_f32_16x16x32_bf16 v[56:59], v[24:27], v[128:131], v[56:59]
    s_waitcnt lgkmcnt(12)
    v_mfma_f32_16x16x32_bf16 v[60:63], v[28:31], v[128:131], v[60:63]
    s_waitcnt lgkmcnt(10)
    v_mfma_f32_16x16x32_bf16 v[64:67], v[32:35], v[128:131], v[64:67]
    s_waitcnt lgkmcnt(8)
    v_mfma_f32_16x16x32_bf16 v[68:71], v[36:39], v[128:131], v[68:71]
    s_waitcnt lgkmcnt(6)
    v_mfma_f32_16x16x32_bf16 v[72:75], v[40:43], v[128:131], v[72:75]
    s_waitcnt lgkmcnt(4)
    v_mfma_f32_16x16x32_bf16 v[76:79], v[44:47], v[128:131], v[76:79]
    s_waitcnt lgkmcnt(2)
    v_mfma_f32_16x16x32_bf16 v[80:83], v[48:51], v[128:131], v[80:83]
    s_waitcnt lgkmcnt(0)
    v_mfma_f32_16x16x32_bf16 v[84:87], v[52:55], v[128:131], v[84:87]
    s_waitcnt lgkmcnt(0)
    s_barrier
    s_add_u32 s31, s30, 2
    s_and_b32 s31, s31, 7
    s_lshl_b32 s31, s31, 19
    s_add_u32 m0, s15, 8192
    s_add_u32 s60, s31, 262144
    buffer_load_dwordx4 v248, s[44:47], s60 offen lds
    s_add_u32 m0, s15, 9216
    s_add_u32 s60, s31, 294912
    buffer_load_dwordx4 v249, s[44:47], s60 offen lds
    v_mfma_f32_16x16x32_bf16 v[88:91], v[24:27], v[132:135], v[88:91]
    v_mfma_f32_16x16x32_bf16 v[92:95], v[28:31], v[132:135], v[92:95]
    v_mfma_f32_16x16x32_bf16 v[96:99], v[32:35], v[132:135], v[96:99]
    v_mfma_f32_16x16x32_bf16 v[100:103], v[36:39], v[132:135], v[100:103]
    v_mfma_f32_16x16x32_bf16 v[104:107], v[40:43], v[132:135], v[104:107]
    v_mfma_f32_16x16x32_bf16 v[108:111], v[44:47], v[132:135], v[108:111]
    v_mfma_f32_16x16x32_bf16 v[112:115], v[48:51], v[132:135], v[112:115]
    v_mfma_f32_16x16x32_bf16 v[116:119], v[52:55], v[132:135], v[116:119]
    s_waitcnt vmcnt(6) lgkmcnt(0)
    s_barrier
    ds_read_b64_tr_b16 v[24:25], v4 offset:16384
    ds_read_b64_tr_b16 v[26:27], v4 offset:20480
    ds_read_b64_tr_b16 v[28:29], v5 offset:16384
    ds_read_b64_tr_b16 v[30:31], v5 offset:20480
    ds_read_b64_tr_b16 v[32:33], v6 offset:16384
    ds_read_b64_tr_b16 v[34:35], v6 offset:20480
    ds_read_b64_tr_b16 v[36:37], v7 offset:16384
    ds_read_b64_tr_b16 v[38:39], v7 offset:20480
    ds_read_b64_tr_b16 v[40:41], v8 offset:16384
    ds_read_b64_tr_b16 v[42:43], v8 offset:20480
    ds_read_b64_tr_b16 v[44:45], v9 offset:16384
    ds_read_b64_tr_b16 v[46:47], v9 offset:20480
    ds_read_b64_tr_b16 v[48:49], v10 offset:16384
    ds_read_b64_tr_b16 v[50:51], v10 offset:20480
    ds_read_b64_tr_b16 v[52:53], v11 offset:16384
    ds_read_b64_tr_b16 v[54:55], v11 offset:20480
    s_waitcnt lgkmcnt(14)
    v_mfma_f32_16x16x32_bf16 v[56:59], v[24:27], v[136:139], v[56:59]
    s_waitcnt lgkmcnt(12)
    v_mfma_f32_16x16x32_bf16 v[60:63], v[28:31], v[136:139], v[60:63]
    s_waitcnt lgkmcnt(10)
    v_mfma_f32_16x16x32_bf16 v[64:67], v[32:35], v[136:139], v[64:67]
    s_waitcnt lgkmcnt(8)
    v_mfma_f32_16x16x32_bf16 v[68:71], v[36:39], v[136:139], v[68:71]
    s_waitcnt lgkmcnt(6)
    v_mfma_f32_16x16x32_bf16 v[72:75], v[40:43], v[136:139], v[72:75]
    s_waitcnt lgkmcnt(4)
    v_mfma_f32_16x16x32_bf16 v[76:79], v[44:47], v[136:139], v[76:79]
    s_waitcnt lgkmcnt(2)
    v_mfma_f32_16x16x32_bf16 v[80:83], v[48:51], v[136:139], v[80:83]
    s_waitcnt lgkmcnt(0)
    v_mfma_f32_16x16x32_bf16 v[84:87], v[52:55], v[136:139], v[84:87]
    s_waitcnt lgkmcnt(0)
    s_barrier
    s_add_u32 s31, s30, 3
    s_and_b32 s31, s31, 7
    s_lshl_b32 s31, s31, 19
    s_add_u32 m0, s15, 16384
    s_add_u32 s60, s31, 0
    buffer_load_dwordx4 v248, s[44:47], s60 offen lds
    s_add_u32 m0, s15, 17408
    s_add_u32 s60, s31, 32768
    buffer_load_dwordx4 v249, s[44:47], s60 offen lds
    v_mfma_f32_16x16x32_bf16 v[88:91], v[24:27], v[140:143], v[88:91]
    v_mfma_f32_16x16x32_bf16 v[92:95], v[28:31], v[140:143], v[92:95]
    v_mfma_f32_16x16x32_bf16 v[96:99], v[32:35], v[140:143], v[96:99]
    v_mfma_f32_16x16x32_bf16 v[100:103], v[36:39], v[140:143], v[100:103]
    v_mfma_f32_16x16x32_bf16 v[104:107], v[40:43], v[140:143], v[104:107]
    v_mfma_f32_16x16x32_bf16 v[108:111], v[44:47], v[140:143], v[108:111]
    v_mfma_f32_16x16x32_bf16 v[112:115], v[48:51], v[140:143], v[112:115]
    v_mfma_f32_16x16x32_bf16 v[116:119], v[52:55], v[140:143], v[116:119]
    s_waitcnt vmcnt(6) lgkmcnt(0)
    s_barrier
    ds_read_b64_tr_b16 v[24:25], v4 offset:24576
    ds_read_b64_tr_b16 v[26:27], v4 offset:28672
    ds_read_b64_tr_b16 v[28:29], v5 offset:24576
    ds_read_b64_tr_b16 v[30:31], v5 offset:28672
    ds_read_b64_tr_b16 v[32:33], v6 offset:24576
    ds_read_b64_tr_b16 v[34:35], v6 offset:28672
    ds_read_b64_tr_b16 v[36:37], v7 offset:24576
    ds_read_b64_tr_b16 v[38:39], v7 offset:28672
    ds_read_b64_tr_b16 v[40:41], v8 offset:24576
    ds_read_b64_tr_b16 v[42:43], v8 offset:28672
    ds_read_b64_tr_b16 v[44:45], v9 offset:24576
    ds_read_b64_tr_b16 v[46:47], v9 offset:28672
    ds_read_b64_tr_b16 v[48:49], v10 offset:24576
    ds_read_b64_tr_b16 v[50:51], v10 offset:28672
    ds_read_b64_tr_b16 v[52:53], v11 offset:24576
    ds_read_b64_tr_b16 v[54:55], v11 offset:28672
    s_waitcnt lgkmcnt(14)
    v_mfma_f32_16x16x32_bf16 v[56:59], v[24:27], v[144:147], v[56:59]
    s_waitcnt lgkmcnt(12)
    v_mfma_f32_16x16x32_bf16 v[60:63], v[28:31], v[144:147], v[60:63]
    s_waitcnt lgkmcnt(10)
    v_mfma_f32_16x16x32_bf16 v[64:67], v[32:35], v[144:147], v[64:67]
    s_waitcnt lgkmcnt(8)
    v_mfma_f32_16x16x32_bf16 v[68:71], v[36:39], v[144:147], v[68:71]
    s_waitcnt lgkmcnt(6)
    v_mfma_f32_16x16x32_bf16 v[72:75], v[40:43], v[144:147], v[72:75]
    s_waitcnt lgkmcnt(4)
    v_mfma_f32_16x16x32_bf16 v[76:79], v[44:47], v[144:147], v[76:79]
    s_waitcnt lgkmcnt(2)
    v_mfma_f32_16x16x32_bf16 v[80:83], v[48:51], v[144:147], v[80:83]
    s_waitcnt lgkmcnt(0)
    v_mfma_f32_16x16x32_bf16 v[84:87], v[52:55], v[144:147], v[84:87]
    v_mfma_f32_16x16x32_bf16 v[88:91], v[24:27], v[148:151], v[88:91]
    v_mfma_f32_16x16x32_bf16 v[92:95], v[28:31], v[148:151], v[92:95]
    v_mfma_f32_16x16x32_bf16 v[96:99], v[32:35], v[148:151], v[96:99]
    v_mfma_f32_16x16x32_bf16 v[100:103], v[36:39], v[148:151], v[100:103]
    v_mfma_f32_16x16x32_bf16 v[104:107], v[40:43], v[148:151], v[104:107]
    v_mfma_f32_16x16x32_bf16 v[108:111], v[44:47], v[148:151], v[108:111]
    v_mfma_f32_16x16x32_bf16 v[112:115], v[48:51], v[148:151], v[112:115]
    v_mfma_f32_16x16x32_bf16 v[116:119], v[52:55], v[148:151], v[116:119]
    s_waitcnt vmcnt(4) lgkmcnt(0)
    s_barrier
    s_add_u32 s31, s30, 3
    s_and_b32 s31, s31, 7
    s_lshl_b32 s31, s31, 19
    s_add_u32 m0, s15, 24576
    s_add_u32 s60, s31, 262144
    buffer_load_dwordx4 v248, s[44:47], s60 offen lds
    s_add_u32 m0, s15, 25600
    s_add_u32 s60, s31, 294912
    buffer_load_dwordx4 v249, s[44:47], s60 offen lds
    s_cmp_eq_u32 s14, 0
    s_cbranch_scc0 L_nc9
    s_waitcnt vmcnt(6)
    v_readfirstlane_b32 s63, v252
    s_nop 0
    s_cmp_eq_u32 s63, 0
    s_cbranch_scc0 L_loste
    v_mov_b32 v252, s99
    s_mov_b32 s60, 557056
    s_mov_b64 exec, 1
    buffer_store_dword v252, v254, s[16:19], s60 offen sc1
    s_mov_b64 exec, -1
    s_branch L_gote
L_loste:
    s_mov_b32 s99, s63
L_gote:
L_nc9:
    ds_read_b64_tr_b16 v[24:25], v4 offset:0
    ds_read_b64_tr_b16 v[26:27], v4 offset:4096
    ds_read_b64_tr_b16 v[28:29], v5 offset:0
    ds_read_b64_tr_b16 v[30:31], v5 offset:4096
    ds_read_b64_tr_b16 v[32:33], v6 offset:0
    ds_read_b64_tr_b16 v[34:35], v6 offset:4096
    ds_read_b64_tr_b16 v[36:37], v7 offset:0
    ds_read_b64_tr_b16 v[38:39], v7 offset:4096
    ds_read_b64_tr_b16 v[40:41], v8 offset:0
    ds_read_b64_tr_b16 v[42:43], v8 offset:4096
    ds_read_b64_tr_b16 v[44:45], v9 offset:0
    ds_read_b64_tr_b16 v[46:47], v9 offset:4096
    ds_read_b64_tr_b16 v[48:49], v10 offset:0
    ds_read_b64_tr_b16 v[50:51], v10 offset:4096
    ds_read_b64_tr_b16 v[52:53], v11 offset:0
    ds_read_b64_tr_b16 v[54:55], v11 offset:4096
    s_waitcnt lgkmcnt(14)
    v_mfma_f32_16x16x32_bf16 v[56:59], v[24:27], v[152:155], v[56:59]
    s_waitcnt lgkmcnt(12)
    v_mfma_f32_16x16x32_bf16 v[60:63], v[28:31], v[152:155], v[60:63]
    s_waitcnt lgkmcnt(10)
    v_mfma_f32_16x16x32_bf16 v[64:67], v[32:35], v[152:155], v[64:67]
    s_waitcnt lgkmcnt(8)
    v_mfma_f32_16x16x32_bf16 v[68:71], v[36:39], v[152:155], v[68:71]
    s_waitcnt lgkmcnt(6)
    v_mfma_f32_16x16x32_bf16 v[72:75], v[40:43], v[152:155], v[72:75]
    s_waitcnt lgkmcnt(4)
    v_mfma_f32_16x16x32_bf16 v[76:79], v[44:47], v[152:155], v[76:79]
    s_waitcnt lgkmcnt(2)
    v_mfma_f32_16x16x32_bf16 v[80:83], v[48:51], v[152:155], v[80:83]
    s_waitcnt lgkmcnt(0)
    v_mfma_f32_16x16x32_bf16 v[84:87], v[52:55], v[152:155], v[84:87]
    s_waitcnt lgkmcnt(0)
    s_barrier
    s_add_u32 s31, s30, 4
    s_and_b32 s31, s31, 7
    s_lshl_b32 s31, s31, 19
    s_add_u32 m0, s15, 0
    s_add_u32 s60, s31, 0
    buffer_load_dwordx4 v248, s[44:47], s60 offen lds
    s_add_u32 m0, s15, 1024
    s_add_u32 s60, s31, 32768
    buffer_load_dwordx4 v249, s[44:47], s60 offen lds
    v_mfma_f32_16x16x32_bf16 v[88:91], v[24:27], v[156:159], v[88:91]
    v_mfma_f32_16x16x32_bf16 v[92:95], v[28:31], v[156:159], v[92:95]
    v_mfma_f32_16x16x32_bf16 v[96:99], v[32:35], v[156:159], v[96:99]
    v_mfma_f32_16x16x32_bf16 v[100:103], v[36:39], v[156:159], v[100:103]
    v_mfma_f32_16x16x32_bf16 v[104:107], v[40:43], v[156:159], v[104:107]
    v_mfma_f32_16x16x32_bf16 v[108:111], v[44:47], v[156:159], v[108:111]
    v_mfma_f32_16x16x32_bf16 v[112:115], v[48:51], v[156:159], v[112:115]
    v_mfma_f32_16x16x32_bf16 v[116:119], v[52:55], v[156:159], v[116:119]
    s_waitcnt vmcnt(6) lgkmcnt(0)
    s_barrier
    ds_read_b64_tr_b16 v[24:25], v4 offset:8192
    ds_read_b64_tr_b16 v[26:27], v4 offset:12288
    ds_read_b64_tr_b16 v[28:29], v5 offset:8192
    ds_read_b64_tr_b16 v[30:31], v5 offset:12288
    ds_read_b64_tr_b16 v[32:33], v6 offset:8192
    ds_read_b64_tr_b16 v[34:35], v6 offset:12288
    ds_read_b64_tr_b16 v[36:37], v7 offset:8192
    ds_read_b64_tr_b16 v[38:39], v7 offset:12288
    ds_read_b64_tr_b16 v[40:41], v8 offset:8192
    ds_read_b64_tr_b16 v[42:43], v8 offset:12288
    ds_read_b64_tr_b16 v[44:45], v9 offset:8192
    ds_read_b64_tr_b16 v[46:47], v9 offset:12288
    ds_read_b64_tr_b16 v[48:49], v10 offset:8192
    ds_read_b64_tr_b16 v[50:51], v10 offset:12288
    ds_read_b64_tr_b16 v[52:53], v11 offset:8192
    ds_read_b64_tr_b16 v[54:55], v11 offset:12288
    s_waitcnt lgkmcnt(14)
    v_mfma_f32_16x16x32_bf16 v[56:59], v[24:27], v[160:163], v[56:59]
    s_waitcnt lgkmcnt(12)
    v_mfma_f32_16x16x32_bf16 v[60:63], v[28:31], v[160:163], v[60:63]
    s_waitcnt lgkmcnt(10)
    v_mfma_f32_16x16x32_bf16 v[64:67], v[32:35], v[160:163], v[64:67]
    s_waitcnt lgkmcnt(8)
    v_mfma_f32_16x16x32_bf16 v[68:71], v[36:39], v[160:163], v[68:71]
    s_waitcnt lgkmcnt(6)
    v_mfma_f32_16x16x32_bf16 v[72:75], v[40:43], v[160:163], v[72:75]
    s_waitcnt lgkmcnt(4)
    v_mfma_f32_16x16x32_bf16 v[76:79], v[44:47], v[160:163], v[76:79]
    s_waitcnt lgkmcnt(2)
    v_mfma_f32_16x16x32_bf16 v[80:83], v[48:51], v[160:163], v[80:83]
    s_waitcnt lgkmcnt(0)
    v_mfma_f32_16x16x32_bf16 v[84:87], v[52:55], v[160:163], v[84:87]
    s_waitcnt lgkmcnt(0)
    s_barrier
    s_add_u32 s31, s30, 4
    s_and_b32 s31, s31, 7
    s_lshl_b32 s31, s31, 19
    s_add_u32 m0, s15, 8192
    s_add_u32 s60, s31, 262144
    buffer_load_dwordx4 v248, s[44:47], s60 offen lds
    s_add_u32 m0, s15, 9216
    s_add_u32 s60, s31, 294912
    buffer_load_dwordx4 v249, s[44:47], s60 offen lds
    v_mfma_f32_16x16x32_bf16 v[88:91], v[24:27], v[164:167], v[88:91]
    v_mfma_f32_16x16x32_bf16 v[92:95], v[28:31], v[164:167], v[92:95]
    v_mfma_f32_16x16x32_bf16 v[96:99], v[32:35], v[164:167], v[96:99]
    v_mfma_f32_16x16x32_bf16 v[100:103], v[36:39], v[164:167], v[100:103]
    v_mfma_f32_16x16x32_bf16 v[104:107], v[40:43], v[164:167], v[104:107]
    v_mfma_f32_16x16x32_bf16 v[108:111], v[44:47], v[164:167], v[108:111]
    v_mfma_f32_16x16x32_bf16 v[112:115], v[48:51], v[164:167], v[112:115]
    v_mfma_f32_16x16x32_bf16 v[116:119], v[52:55], v[164:167], v[116:119]
    s_waitcnt vmcnt(6) lgkmcnt(0)
    s_barrier
    s_add_u32 s3, s98, 0
    s_and_b32 s3, s3, 3
    s_lshl_b32 s3, s3, 1
    s_lshl_b32 s63, s97, 3
    s_add_u32 s3, s3, s63
    s_lshl_b32 s3, s3, 17
    s_add_u32 m0, s56, 98304
    s_add_u32 s60, s3, 0
    buffer_load_dwordx4 v16, s[8:11], s60 offen lds
    s_add_u32 m0, s56, 99328
    s_add_u32 s60, s3, 4096
    buffer_load_dwordx4 v17, s[8:11], s60 offen lds
    ds_read_b64_tr_b16 v[24:25], v4 offset:16384
    ds_read_b64_tr_b16 v[26:27], v4 offset:20480
    ds_read_b64_tr_b16 v[28:29], v5 offset:16384
    ds_read_b64_tr_b16 v[30:31], v5 offset:20480
    ds_read_b64_tr_b16 v[32:33], v6 offset:16384
    ds_read_b64_tr_b16 v[34:35], v6 offset:20480
    ds_read_b64_tr_b16 v[36:37], v7 offset:16384
    ds_read_b64_tr_b16 v[38:39], v7 offset:20480
    ds_read_b64_tr_b16 v[40:41], v8 offset:16384
    ds_read_b64_tr_b16 v[42:43], v8 offset:20480
    ds_read_b64_tr_b16 v[44:45], v9 offset:16384
    ds_read_b64_tr_b16 v[46:47], v9 offset:20480
    ds_read_b64_tr_b16 v[48:49], v10 offset:16384
    ds_read_b64_tr_b16 v[50:51], v10 offset:20480
    ds_read_b64_tr_b16 v[52:53], v11 offset:16384
    ds_read_b64_tr_b16 v[54:55], v11 offset:20480
    s_waitcnt lgkmcnt(14)
    v_mfma_f32_16x16x32_bf16 v[56:59], v[24:27], v[168:171], v[56:59]
    s_waitcnt lgkmcnt(12)
    v_mfma_f32_16x16x32_bf16 v[60:63], v[28:31], v[168:171], v[60:63]
    s_waitcnt lgkmcnt(10)
    v_mfma_f32_16x16x32_bf16 v[64:67], v[32:35], v[168:171], v[64:67]
    s_waitcnt lgkmcnt(8)
    v_mfma_f32_16x16x32_bf16 v[68:71], v[36:39], v[168:171], v[68:71]
    s_waitcnt lgkmcnt(6)
    v_mfma_f32_16x16x32_bf16 v[72:75], v[40:43], v[168:171], v[72:75]
    s_waitcnt lgkmcnt(4)
    v_mfma_f32_16x16x32_bf16 v[76:79], v[44:47], v[168:171], v[76:79]
    s_waitcnt lgkmcnt(2)
    v_mfma_f32_16x16x32_bf16 v[80:83], v[48:51], v[168:171], v[80:83]
    s_waitcnt lgkmcnt(0)
    v_mfma_f32_16x16x32_bf16 v[84:87], v[52:55], v[168:171], v[84:87]
    v_mfma_f32_16x16x32_bf16 v[88:91], v[24:27], v[172:175], v[88:91]
    v_mfma_f32_16x16x32_bf16 v[92:95], v[28:31], v[172:175], v[92:95]
    v_mfma_f32_16x16x32_bf16 v[96:99], v[32:35], v[172:175], v[96:99]
    v_mfma_f32_16x16x32_bf16 v[100:103], v[36:39], v[172:175], v[100:103]
    v_mfma_f32_16x16x32_bf16 v[104:107], v[40:43], v[172:175], v[104:107]
    v_mfma_f32_16x16x32_bf16 v[108:111], v[44:47], v[172:175], v[108:111]
    v_mfma_f32_16x16x32_bf16 v[112:115], v[48:51], v[172:175], v[112:115]
    v_mfma_f32_16x16x32_bf16 v[116:119], v[52:55], v[172:175], v[116:119]
    s_waitcnt vmcnt(6) lgkmcnt(0)
    s_barrier
    s_add_u32 s31, s30, 5
    s_and_b32 s31, s31, 7
    s_lshl_b32 s31, s31, 19
    s_add_u32 m0, s15, 16384
    s_add_u32 s60, s31, 0
    buffer_load_dwordx4 v248, s[44:47], s60 offen lds
    s_add_u32 m0, s15, 17408
    s_add_u32 s60, s31, 32768
    buffer_load_dwordx4 v249, s[44:47], s60 offen lds
    ds_read_b64_tr_b16 v[24:25], v4 offset:24576
    ds_read_b64_tr_b16 v[26:27], v4 offset:28672
    ds_read_b64_tr_b16 v[28:29], v5 offset:24576
    ds_read_b64_tr_b16 v[30:31], v5 offset:28672
    ds_read_b64_tr_b16 v[32:33], v6 offset:24576
    ds_read_b64_tr_b16 v[34:35], v6 offset:28672
    ds_read_b64_tr_b16 v[36:37], v7 offset:24576
    ds_read_b64_tr_b16 v[38:39], v7 offset:28672
    ds_read_b64_tr_b16 v[40:41], v8 offset:24576
    ds_read_b64_tr_b16 v[42:43], v8 offset:28672
    ds_read_b64_tr_b16 v[44:45], v9 offset:24576
    ds_read_b64_tr_b16 v[46:47], v9 offset:28672
    ds_read_b64_tr_b16 v[48:49], v10 offset:24576
    ds_read_b64_tr_b16 v[50:51], v10 offset:28672
    ds_read_b64_tr_b16 v[52:53], v11 offset:24576
    ds_read_b64_tr_b16 v[54:55], v11 offset:28672
    s_waitcnt lgkmcnt(14)
    v_mfma_f32_16x16x32_bf16 v[56:59], v[24:27], v[176:179], v[56:59]
    s_waitcnt lgkmcnt(12)
    v_mfma_f32_16x16x32_bf16 v[60:63], v[28:31], v[176:179], v[60:63]
    s_waitcnt lgkmcnt(10)
    v_mfma_f32_16x16x32_bf16 v[64:67], v[32:35], v[176:179], v[64:67]
    s_waitcnt lgkmcnt(8)
    v_mfma_f32_16x16x32_bf16 v[68:71], v[36:39], v[176:179], v[68:71]
    s_waitcnt lgkmcnt(6)
    v_mfma_f32_16x16x32_bf16 v[72:75], v[40:43], v[176:179], v[72:75]
    s_waitcnt lgkmcnt(4)
    v_mfma_f32_16x16x32_bf16 v[76:79], v[44:47], v[176:179], v[76:79]
    s_waitcnt lgkmcnt(2)
    v_mfma_f32_16x16x32_bf16 v[80:83], v[48:51], v[176:179], v[80:83]
    s_waitcnt lgkmcnt(0)
    v_mfma_f32_16x16x32_bf16 v[84:87], v[52:55], v[176:179], v[84:87]
    buffer_load_dword v250, v254, s[40:43], 0 offen sc1
    s_waitcnt lgkmcnt(0)
    s_barrier
    s_add_u32 s31, s30, 5
    s_and_b32 s31, s31, 7
    s_lshl_b32 s31, s31, 19
    s_add_u32 m0, s15, 24576
    s_add_u32 s60, s31, 262144
    buffer_load_dwordx4 v248, s[44:47], s60 offen lds
    s_add_u32 m0, s15, 25600
    s_add_u32 s60, s31, 294912
    buffer_load_dwordx4 v249, s[44:47], s60 offen lds
    s_add_u32 s3, s98, 0
    s_and_b32 s3, s3, 3
    s_lshl_b32 s3, s3, 1
    s_lshl_b32 s63, s97, 3
    s_add_u32 s3, s3, s63
    s_lshl_b32 s3, s3, 17
    s_add_u32 m0, s56, 106496
    s_add_u32 s60, s3, 32768
    buffer_load_dwordx4 v16, s[8:11], s60 offen lds
    s_add_u32 m0, s56, 107520
    s_add_u32 s60, s3, 36864
    buffer_load_dwordx4 v17, s[8:11], s60 offen lds
    v_mfma_f32_16x16x32_bf16 v[88:91], v[24:27], v[180:183], v[88:91]
    v_mfma_f32_16x16x32_bf16 v[92:95], v[28:31], v[180:183], v[92:95]
    v_mfma_f32_16x16x32_bf16 v[96:99], v[32:35], v[180:183], v[96:99]
    v_mfma_f32_16x16x32_bf16 v[100:103], v[36:39], v[180:183], v[100:103]
    v_mfma_f32_16x16x32_bf16 v[104:107], v[40:43], v[180:183], v[104:107]
    v_mfma_f32_16x16x32_bf16 v[108:111], v[44:47], v[180:183], v[108:111]
    v_mfma_f32_16x16x32_bf16 v[112:115], v[48:51], v[180:183], v[112:115]
    v_mfma_f32_16x16x32_bf16 v[116:119], v[52:55], v[180:183], v[116:119]
    s_waitcnt vmcnt(11) lgkmcnt(0)
    s_barrier
    ds_read_b64_tr_b16 v[24:25], v4 offset:0
    ds_read_b64_tr_b16 v[26:27], v4 offset:4096
    ds_read_b64_tr_b16 v[28:29], v5 offset:0
    ds_read_b64_tr_b16 v[30:31], v5 offset:4096
    ds_read_b64_tr_b16 v[32:33], v6 offset:0
    ds_read_b64_tr_b16 v[34:35], v6 offset:4096
    ds_read_b64_tr_b16 v[36:37], v7 offset:0
    ds_read_b64_tr_b16 v[38:39], v7 offset:4096
    ds_read_b64_tr_b16 v[40:41], v8 offset:0
    ds_read_b64_tr_b16 v[42:43], v8 offset:4096
    ds_read_b64_tr_b16 v[44:45], v9 offset:0
    ds_read_b64_tr_b16 v[46:47], v9 offset:4096
    ds_read_b64_tr_b16 v[48:49], v10 offset:0
    ds_read_b64_tr_b16 v[50:51], v10 offset:4096
    ds_read_b64_tr_b16 v[52:53], v11 offset:0
    ds_read_b64_tr_b16 v[54:55], v11 offset:4096
    s_waitcnt lgkmcnt(14)
    v_mfma_f32_16x16x32_bf16 v[56:59], v[24:27], v[184:187], v[56:59]
    s_waitcnt lgkmcnt(12)
    v_mfma_f32_16x16x32_bf16 v[60:63], v[28:31], v[184:187], v[60:63]
    s_waitcnt lgkmcnt(10)
    v_mfma_f32_16x16x32_bf16 v[64:67], v[32:35], v[184:187], v[64:67]
    s_waitcnt lgkmcnt(8)
    v_mfma_f32_16x16x32_bf16 v[68:71], v[36:39], v[184:187], v[68:71]
    s_waitcnt lgkmcnt(6)
    v_mfma_f32_16x16x32_bf16 v[72:75], v[40:43], v[184:187], v[72:75]
    s_waitcnt lgkmcnt(4)
    v_mfma_f32_16x16x32_bf16 v[76:79], v[44:47], v[184:187], v[76:79]
    s_waitcnt lgkmcnt(2)
    v_mfma_f32_16x16x32_bf16 v[80:83], v[48:51], v[184:187], v[80:83]
    s_waitcnt lgkmcnt(0)
    v_mfma_f32_16x16x32_bf16 v[84:87], v[52:55], v[184:187], v[84:87]
    s_waitcnt vmcnt(4) lgkmcnt(0)
    s_barrier
    s_add_u32 s31, s30, 6
    s_and_b32 s31, s31, 7
    s_lshl_b32 s31, s31, 19
    s_add_u32 m0, s15, 0
    s_add_u32 s60, s31, 0
    buffer_load_dwordx4 v248, s[44:47], s60 offen lds
    s_add_u32 m0, s15, 1024
    s_add_u32 s60, s31, 32768
    buffer_load_dwordx4 v249, s[44:47], s60 offen lds
    s_add_u32 s3, s98, 0
    s_and_b32 s3, s3, 3
    s_lshl_b32 s3, s3, 1
    s_lshl_b32 s63, s97, 3
    s_add_u32 s3, s3, s63
    s_lshl_b32 s3, s3, 17
    s_add_u32 m0, s56, 114688
    s_add_u32 s60, s3, 65536
    buffer_load_dwordx4 v16, s[8:11], s60 offen lds
    s_add_u32 m0, s56, 115712
    s_add_u32 s60, s3, 69632
    buffer_load_dwordx4 v17, s[8:11], s60 offen lds
    v_mfma_f32_16x16x32_bf16 v[88:91], v[24:27], v[188:191], v[88:91]
    v_mfma_f32_16x16x32_bf16 v[92:95], v[28:31], v[188:191], v[92:95]
    v_mfma_f32_16x16x32_bf16 v[96:99], v[32:35], v[188:191], v[96:99]
    v_mfma_f32_16x16x32_bf16 v[100:103], v[36:39], v[188:191], v[100:103]
    v_mfma_f32_16x16x32_bf16 v[104:107], v[40:43], v[188:191], v[104:107]
    v_mfma_f32_16x16x32_bf16 v[108:111], v[44:47], v[188:191], v[108:111]
    v_mfma_f32_16x16x32_bf16 v[112:115], v[48:51], v[188:191], v[112:115]
    v_mfma_f32_16x16x32_bf16 v[116:119], v[52:55], v[188:191], v[116:119]
    v_readfirstlane_b32 s99, v250
    s_nop 0
    s_cmp_lg_u32 s99, 0
    s_cbranch_scc1 L_havenonceg
    s_mov_b32 s60, 557056
    buffer_load_dword v252, v254, s[16:19], s60 offen sc1
    s_waitcnt vmcnt(0)
    v_readfirstlane_b32 s99, v252
    s_nop 0
    s_add_u32 s99, s99, 1
    s_max_u32 s99, s99, 1
    v_mov_b32 v252, s99
    v_mov_b32 v253, 0
    s_mov_b64 exec, 1
    buffer_atomic_cmpswap v[252:253], v254, s[40:43], 0 offen sc0 sc1
    s_mov_b64 exec, -1
    s_waitcnt vmcnt(0)
    v_readfirstlane_b32 s63, v252
    s_nop 0
    s_cmp_eq_u32 s63, 0
    s_cbranch_scc0 L_lostg
    v_mov_b32 v252, s99
    s_mov_b32 s60, 557056
    s_mov_b64 exec, 1
    buffer_store_dword v252, v254, s[16:19], s60 offen sc1
    s_mov_b64 exec, -1
    s_branch L_gotg
L_lostg:
    s_mov_b32 s99, s63
L_gotg:
L_havenonceg:
    s_xor_b32 s100, s99, 1540483477
    v_mov_b32 v252, s99
    v_mov_b32 v253, s100
    s_getreg_b32 s63, hwreg(HW_REG_XCC_ID, 0, 4)
    s_add_u32 s63, s63, s100
    v_mov_b32 v20, s99
    v_mov_b32 v21, s63
    s_lshl_b32 s60, s98, 7
    s_add_u32 s60, s60, s7
    s_cmp_eq_u32 s52, 0
    s_cbranch_scc0 L_noid
    s_mov_b64 exec, 1
    buffer_store_dwordx2 v[20:21], v254, s[16:19], s60 offen sc1
    s_mov_b64 exec, -1
L_noid:
    s_waitcnt lgkmcnt(0)
    s_barrier
    ds_read_b64_tr_b16 v[24:25], v4 offset:8192
    ds_read_b64_tr_b16 v[26:27], v4 offset:12288
    ds_read_b64_tr_b16 v[28:29], v5 offset:8192
    ds_read_b64_tr_b16 v[30:31], v5 offset:12288
    ds_read_b64_tr_b16 v[32:33], v6 offset:8192
    ds_read_b64_tr_b16 v[34:35], v6 offset:12288
    ds_read_b64_tr_b16 v[36:37], v7 offset:8192
    ds_read_b64_tr_b16 v[38:39], v7 offset:12288
    ds_read_b64_tr_b16 v[40:41], v8 offset:8192
    ds_read_b64_tr_b16 v[42:43], v8 offset:12288
    ds_read_b64_tr_b16 v[44:45], v9 offset:8192
    ds_read_b64_tr_b16 v[46:47], v9 offset:12288
    ds_read_b64_tr_b16 v[48:49], v10 offset:8192
    ds_read_b64_tr_b16 v[50:51], v10 offset:12288
    ds_read_b64_tr_b16 v[52:53], v11 offset:8192
    ds_read_b64_tr_b16 v[54:55], v11 offset:12288
    s_waitcnt lgkmcnt(14)
    v_mfma_f32_16x16x32_bf16 v[56:59], v[24:27], v[192:195], v[56:59]
    s_waitcnt lgkmcnt(12)
    v_mfma_f32_16x16x32_bf16 v[60:63], v[28:31], v[192:195], v[60:63]
    s_waitcnt lgkmcnt(10)
    v_mfma_f32_16x16x32_bf16 v[64:67], v[32:35], v[192:195], v[64:67]
    s_waitcnt lgkmcnt(8)
    v_mfma_f32_16x16x32_bf16 v[68:71], v[36:39], v[192:195], v[68:71]
    s_waitcnt lgkmcnt(6)
    v_mfma_f32_16x16x32_bf16 v[72:75], v[40:43], v[192:195], v[72:75]
    s_waitcnt lgkmcnt(4)
    v_mfma_f32_16x16x32_bf16 v[76:79], v[44:47], v[192:195], v[76:79]
    s_waitcnt lgkmcnt(2)
    v_mfma_f32_16x16x32_bf16 v[80:83], v[48:51], v[192:195], v[80:83]
    s_waitcnt lgkmcnt(0)
    v_mfma_f32_16x16x32_bf16 v[84:87], v[52:55], v[192:195], v[84:87]
    v_mfma_f32_16x16x32_bf16 v[88:91], v[24:27], v[196:199], v[88:91]
    v_mfma_f32_16x16x32_bf16 v[92:95], v[28:31], v[196:199], v[92:95]
    v_mfma_f32_16x16x32_bf16 v[96:99], v[32:35], v[196:199], v[96:99]
    v_mfma_f32_16x16x32_bf16 v[100:103], v[36:39], v[196:199], v[100:103]
    v_mfma_f32_16x16x32_bf16 v[104:107], v[40:43], v[196:199], v[104:107]
    v_mfma_f32_16x16x32_bf16 v[108:111], v[44:47], v[196:199], v[108:111]
    v_mfma_f32_16x16x32_bf16 v[112:115], v[48:51], v[196:199], v[112:115]
    v_mfma_f32_16x16x32_bf16 v[116:119], v[52:55], v[196:199], v[116:119]
    s_waitcnt lgkmcnt(0)
    s_barrier
    s_add_u32 s31, s30, 6
    s_and_b32 s31, s31, 7
    s_lshl_b32 s31, s31, 19
    s_add_u32 m0, s15, 8192
    s_add_u32 s60, s31, 262144
    buffer_load_dwordx4 v248, s[44:47], s60 offen lds
    s_add_u32 m0, s15, 9216
    s_add_u32 s60, s31, 294912
    buffer_load_dwordx4 v249, s[44:47], s60 offen lds
    s_add_u32 s3, s98, 0
    s_and_b32 s3, s3, 3
    s_lshl_b32 s3, s3, 1
    s_lshl_b32 s63, s97, 3
    s_add_u32 s3, s3, s63
    s_lshl_b32 s3, s3, 17
    s_add_u32 m0, s56, 122880
    s_add_u32 s60, s3, 98304
    buffer_load_dwordx4 v16, s[8:11], s60 offen lds
    s_add_u32 m0, s56, 123904
    s_add_u32 s60, s3, 102400
    buffer_load_dwordx4 v17, s[8:11], s60 offen lds
    ds_read_b64_tr_b16 v[24:25], v4 offset:16384
    ds_read_b64_tr_b16 v[26:27], v4 offset:20480
    ds_read_b64_tr_b16 v[28:29], v5 offset:16384
    ds_read_b64_tr_b16 v[30:31], v5 offset:20480
    ds_read_b64_tr_b16 v[32:33], v6 offset:16384
    ds_read_b64_tr_b16 v[34:35], v6 offset:20480
    ds_read_b64_tr_b16 v[36:37], v7 offset:16384
    ds_read_b64_tr_b16 v[38:39], v7 offset:20480
    ds_read_b64_tr_b16 v[40:41], v8 offset:16384
    ds_read_b64_tr_b16 v[42:43], v8 offset:20480
    ds_read_b64_tr_b16 v[44:45], v9 offset:16384
    ds_read_b64_tr_b16 v[46:47], v9 offset:20480
    ds_read_b64_tr_b16 v[48:49], v10 offset:16384
    ds_read_b64_tr_b16 v[50:51], v10 offset:20480
    ds_read_b64_tr_b16 v[52:53], v11 offset:16384
    ds_read_b64_tr_b16 v[54:55], v11 offset:20480
    s_waitcnt lgkmcnt(14)
    v_mfma_f32_16x16x32_bf16 v[56:59], v[24:27], v[200:203], v[56:59]
    s_waitcnt lgkmcnt(12)
    v_mfma_f32_16x16x32_bf16 v[60:63], v[28:31], v[200:203], v[60:63]
    s_waitcnt lgkmcnt(10)
    v_mfma_f32_16x16x32_bf16 v[64:67], v[32:35], v[200:203], v[64:67]
    s_waitcnt lgkmcnt(8)
    v_mfma_f32_16x16x32_bf16 v[68:71], v[36:39], v[200:203], v[68:71]
    s_waitcnt lgkmcnt(6)
    v_mfma_f32_16x16x32_bf16 v[72:75], v[40:43], v[200:203], v[72:75]
    s_waitcnt lgkmcnt(4)
    v_mfma_f32_16x16x32_bf16 v[76:79], v[44:47], v[200:203], v[76:79]
    s_waitcnt lgkmcnt(2)
    v_mfma_f32_16x16x32_bf16 v[80:83], v[48:51], v[200:203], v[80:83]
    s_waitcnt lgkmcnt(0)
    v_mfma_f32_16x16x32_bf16 v[84:87], v[52:55], v[200:203], v[84:87]
    s_waitcnt lgkmcnt(0)
    s_barrier
    s_add_u32 s31, s30, 7
    s_and_b32 s31, s31, 7
    s_lshl_b32 s31, s31, 19
    s_add_u32 m0, s15, 16384
    s_add_u32 s60, s31, 0
    buffer_load_dwordx4 v248, s[44:47], s60 offen lds
    s_add_u32 m0, s15, 17408
    s_add_u32 s60, s31, 32768
    buffer_load_dwordx4 v249, s[44:47], s60 offen lds
    v_mfma_f32_16x16x32_bf16 v[88:91], v[24:27], v[204:207], v[88:91]
    v_mfma_f32_16x16x32_bf16 v[92:95], v[28:31], v[204:207], v[92:95]
    v_mfma_f32_16x16x32_bf16 v[96:99], v[32:35], v[204:207], v[96:99]
    v_mfma_f32_16x16x32_bf16 v[100:103], v[36:39], v[204:207], v[100:103]
    v_mfma_f32_16x16x32_bf16 v[104:107], v[40:43], v[204:207], v[104:107]
    v_mfma_f32_16x16x32_bf16 v[108:111], v[44:47], v[204:207], v[108:111]
    v_mfma_f32_16x16x32_bf16 v[112:115], v[48:51], v[204:207], v[112:115]
    v_mfma_f32_16x16x32_bf16 v[116:119], v[52:55], v[204:207], v[116:119]
    s_waitcnt vmcnt(12) lgkmcnt(0)
    s_barrier
    s_add_u32 s3, s98, 1
    s_and_b32 s3, s3, 3
    s_lshl_b32 s3, s3, 1
    s_lshl_b32 s63, s97, 3
    s_add_u32 s3, s3, s63
    s_lshl_b32 s3, s3, 17
    s_add_u32 m0, s56, 131072
    s_add_u32 s60, s3, 0
    buffer_load_dwordx4 v16, s[8:11], s60 offen lds
    s_add_u32 m0, s56, 132096
    s_add_u32 s60, s3, 4096
    buffer_load_dwordx4 v17, s[8:11], s60 offen lds
    ds_read_b64_tr_b16 v[24:25], v4 offset:24576
    ds_read_b64_tr_b16 v[26:27], v4 offset:28672
    ds_read_b64_tr_b16 v[28:29], v5 offset:24576
    ds_read_b64_tr_b16 v[30:31], v5 offset:28672
    ds_read_b64_tr_b16 v[32:33], v6 offset:24576
    ds_read_b64_tr_b16 v[34:35], v6 offset:28672
    ds_read_b64_tr_b16 v[36:37], v7 offset:24576
    ds_read_b64_tr_b16 v[38:39], v7 offset:28672
    ds_read_b64_tr_b16 v[40:41], v8 offset:24576
    ds_read_b64_tr_b16 v[42:43], v8 offset:28672
    ds_read_b64_tr_b16 v[44:45], v9 offset:24576
    ds_read_b64_tr_b16 v[46:47], v9 offset:28672
    ds_read_b64_tr_b16 v[48:49], v10 offset:24576
    ds_read_b64_tr_b16 v[50:51], v10 offset:28672
    ds_read_b64_tr_b16 v[52:53], v11 offset:24576
    ds_read_b64_tr_b16 v[54:55], v11 offset:28672
    s_waitcnt lgkmcnt(14)
    v_mfma_f32_16x16x32_bf16 v[56:59], v[24:27], v[208:211], v[56:59]
    s_waitcnt lgkmcnt(12)
    v_mfma_f32_16x16x32_bf16 v[60:63], v[28:31], v[208:211], v[60:63]
    s_waitcnt lgkmcnt(10)
    v_mfma_f32_16x16x32_bf16 v[64:67], v[32:35], v[208:211], v[64:67]
    s_waitcnt lgkmcnt(8)
    v_mfma_f32_16x16x32_bf16 v[68:71], v[36:39], v[208:211], v[68:71]
    s_waitcnt lgkmcnt(6)
    v_mfma_f32_16x16x32_bf16 v[72:75], v[40:43], v[208:211], v[72:75]
    s_waitcnt lgkmcnt(4)
    v_mfma_f32_16x16x32_bf16 v[76:79], v[44:47], v[208:211], v[76:79]
    s_waitcnt lgkmcnt(2)
    v_mfma_f32_16x16x32_bf16 v[80:83], v[48:51], v[208:211], v[80:83]
    s_waitcnt lgkmcnt(0)
    v_mfma_f32_16x16x32_bf16 v[84:87], v[52:55], v[208:211], v[84:87]
    s_waitcnt vmcnt(10) lgkmcnt(0)
    s_barrier
    s_add_u32 s31, s30, 7
    s_and_b32 s31, s31, 7
    s_lshl_b32 s31, s31, 19
    s_add_u32 m0, s15, 24576
    s_add_u32 s60, s31, 262144
    buffer_load_dwordx4 v248, s[44:47], s60 offen lds
    s_add_u32 m0, s15, 25600
    s_add_u32 s60, s31, 294912
    buffer_load_dwordx4 v249, s[44:47], s60 offen lds
    s_lshr_b32 s3, s55, 1
    s_lshl_b32 s63, s97, 2
    s_add_u32 s3, s3, s63
    s_lshl_b32 s3, s3, 2
    s_and_b32 s63, s55, 1
    s_add_u32 s3, s3, s63
    s_lshl_b32 s3, s3, 16
    s_add_u32 s3, s3, 131072
    buffer_load_dwordx4 v[120:123], v16, s[8:11], s3 offen
    v_mfma_f32_16x16x32_bf16 v[88:91], v[24:27], v[212:215], v[88:91]
    v_mfma_f32_16x16x32_bf16 v[92:95], v[28:31], v[212:215], v[92:95]
    v_mfma_f32_16x16x32_bf16 v[96:99], v[32:35], v[212:215], v[96:99]
    v_mfma_f32_16x16x32_bf16 v[100:103], v[36:39], v[212:215], v[100:103]
    v_mfma_f32_16x16x32_bf16 v[104:107], v[40:43], v[212:215], v[104:107]
    v_mfma_f32_16x16x32_bf16 v[108:111], v[44:47], v[212:215], v[108:111]
    v_mfma_f32_16x16x32_bf16 v[112:115], v[48:51], v[212:215], v[112:115]
    v_mfma_f32_16x16x32_bf16 v[116:119], v[52:55], v[212:215], v[116:119]
    ds_read_b64_tr_b16 v[24:25], v4 offset:0
    ds_read_b64_tr_b16 v[26:27], v4 offset:4096
    ds_read_b64_tr_b16 v[28:29], v5 offset:0
    ds_read_b64_tr_b16 v[30:31], v5 offset:4096
    ds_read_b64_tr_b16 v[32:33], v6 offset:0
    ds_read_b64_tr_b16 v[34:35], v6 offset:4096
    ds_read_b64_tr_b16 v[36:37], v7 offset:0
    ds_read_b64_tr_b16 v[38:39], v7 offset:4096
    ds_read_b64_tr_b16 v[40:41], v8 offset:0
    ds_read_b64_tr_b16 v[42:43], v8 offset:4096
    ds_read_b64_tr_b16 v[44:45], v9 offset:0
    ds_read_b64_tr_b16 v[46:47], v9 offset:4096
    ds_read_b64_tr_b16 v[48:49], v10 offset:0
    ds_read_b64_tr_b16 v[50:51], v10 offset:4096
    ds_read_b64_tr_b16 v[52:53], v11 offset:0
    ds_read_b64_tr_b16 v[54:55], v11 offset:4096
    s_waitcnt lgkmcnt(14)
    v_mfma_f32_16x16x32_bf16 v[56:59], v[24:27], v[216:219], v[56:59]
    s_waitcnt lgkmcnt(12)
    v_mfma_f32_16x16x32_bf16 v[60:63], v[28:31], v[216:219], v[60:63]
    s_waitcnt lgkmcnt(10)
    v_mfma_f32_16x16x32_bf16 v[64:67], v[32:35], v[216:219], v[64:67]
    s_waitcnt lgkmcnt(8)
    v_mfma_f32_16x16x32_bf16 v[68:71], v[36:39], v[216:219], v[68:71]
    s_waitcnt lgkmcnt(6)
    v_mfma_f32_16x16x32_bf16 v[72:75], v[40:43], v[216:219], v[72:75]
    s_waitcnt lgkmcnt(4)
    v_mfma_f32_16x16x32_bf16 v[76:79], v[44:47], v[216:219], v[76:79]
    s_waitcnt lgkmcnt(2)
    v_mfma_f32_16x16x32_bf16 v[80:83], v[48:51], v[216:219], v[80:83]
    s_waitcnt lgkmcnt(0)
    v_mfma_f32_16x16x32_bf16 v[84:87], v[52:55], v[216:219], v[84:87]
    s_waitcnt lgkmcnt(0)
    s_barrier
    s_add_u32 s3, s98, 1
    s_and_b32 s3, s3, 3
    s_lshl_b32 s3, s3, 1
    s_lshl_b32 s63, s97, 3
    s_add_u32 s3, s3, s63
    s_lshl_b32 s3, s3, 17
    s_add_u32 m0, s56, 139264
    s_add_u32 s60, s3, 32768
    buffer_load_dwordx4 v16, s[8:11], s60 offen lds
    s_add_u32 m0, s56, 140288
    s_add_u32 s60, s3, 36864
    buffer_load_dwordx4 v17, s[8:11], s60 offen lds
    v_mfma_f32_16x16x32_bf16 v[88:91], v[24:27], v[220:223], v[88:91]
    v_mfma_f32_16x16x32_bf16 v[92:95], v[28:31], v[220:223], v[92:95]
    v_mfma_f32_16x16x32_bf16 v[96:99], v[32:35], v[220:223], v[96:99]
    v_mfma_f32_16x16x32_bf16 v[100:103], v[36:39], v[220:223], v[100:103]
    v_mfma_f32_16x16x32_bf16 v[104:107], v[40:43], v[220:223], v[104:107]
    v_mfma_f32_16x16x32_bf16 v[108:111], v[44:47], v[220:223], v[108:111]
    v_mfma_f32_16x16x32_bf16 v[112:115], v[48:51], v[220:223], v[112:115]
    v_mfma_f32_16x16x32_bf16 v[116:119], v[52:55], v[220:223], v[116:119]
    s_waitcnt vmcnt(11) lgkmcnt(0)
    s_barrier
    ds_read_b64_tr_b16 v[24:25], v4 offset:8192
    ds_read_b64_tr_b16 v[26:27], v4 offset:12288
    ds_read_b64_tr_b16 v[28:29], v5 offset:8192
    ds_read_b64_tr_b16 v[30:31], v5 offset:12288
    ds_read_b64_tr_b16 v[32:33], v6 offset:8192
    ds_read_b64_tr_b16 v[34:35], v6 offset:12288
    ds_read_b64_tr_b16 v[36:37], v7 offset:8192
    ds_read_b64_tr_b16 v[38:39], v7 offset:12288
    ds_read_b64_tr_b16 v[40:41], v8 offset:8192
    ds_read_b64_tr_b16 v[42:43], v8 offset:12288
    ds_read_b64_tr_b16 v[44:45], v9 offset:8192
    ds_read_b64_tr_b16 v[46:47], v9 offset:12288
    ds_read_b64_tr_b16 v[48:49], v10 offset:8192
    ds_read_b64_tr_b16 v[50:51], v10 offset:12288
    ds_read_b64_tr_b16 v[52:53], v11 offset:8192
    ds_read_b64_tr_b16 v[54:55], v11 offset:12288
    s_waitcnt lgkmcnt(14)
    v_mfma_f32_16x16x32_bf16 v[56:59], v[24:27], v[224:227], v[56:59]
    s_waitcnt lgkmcnt(12)
    v_mfma_f32_16x16x32_bf16 v[60:63], v[28:31], v[224:227], v[60:63]
    s_waitcnt lgkmcnt(10)
    v_mfma_f32_16x16x32_bf16 v[64:67], v[32:35], v[224:227], v[64:67]
    s_waitcnt lgkmcnt(8)
    v_mfma_f32_16x16x32_bf16 v[68:71], v[36:39], v[224:227], v[68:71]
    s_waitcnt lgkmcnt(6)
    v_mfma_f32_16x16x32_bf16 v[72:75], v[40:43], v[224:227], v[72:75]
    s_waitcnt lgkmcnt(4)
    v_mfma_f32_16x16x32_bf16 v[76:79], v[44:47], v[224:227], v[76:79]
    s_waitcnt lgkmcnt(2)
    v_mfma_f32_16x16x32_bf16 v[80:83], v[48:51], v[224:227], v[80:83]
    s_waitcnt lgkmcnt(0)
    v_mfma_f32_16x16x32_bf16 v[84:87], v[52:55], v[224:227], v[84:87]
    s_waitcnt lgkmcnt(0)
    s_barrier
    s_add_u32 s3, s98, 1
    s_and_b32 s3, s3, 3
    s_lshl_b32 s3, s3, 1
    s_lshl_b32 s63, s97, 3
    s_add_u32 s3, s3, s63
    s_lshl_b32 s3, s3, 17
    s_add_u32 m0, s56, 147456
    s_add_u32 s60, s3, 65536
    buffer_load_dwordx4 v16, s[8:11], s60 offen lds
    s_add_u32 m0, s56, 148480
    s_add_u32 s60, s3, 69632
    buffer_load_dwordx4 v17, s[8:11], s60 offen lds
    v_mfma_f32_16x16x32_bf16 v[88:91], v[24:27], v[228:231], v[88:91]
    v_mfma_f32_16x16x32_bf16 v[92:95], v[28:31], v[228:231], v[92:95]
    v_mfma_f32_16x16x32_bf16 v[96:99], v[32:35], v[228:231], v[96:99]
    v_mfma_f32_16x16x32_bf16 v[100:103], v[36:39], v[228:231], v[100:103]
    v_mfma_f32_16x16x32_bf16 v[104:107], v[40:43], v[228:231], v[104:107]
    v_mfma_f32_16x16x32_bf16 v[108:111], v[44:47], v[228:231], v[108:111]
    v_mfma_f32_16x16x32_bf16 v[112:115], v[48:51], v[228:231], v[112:115]
    v_mfma_f32_16x16x32_bf16 v[116:119], v[52:55], v[228:231], v[116:119]
    s_waitcnt vmcnt(9) lgkmcnt(0)
    s_barrier
    s_lshr_b32 s3, s55, 1
    s_lshl_b32 s63, s97, 2
    s_add_u32 s3, s3, s63
    s_lshl_b32 s3, s3, 2
    s_and_b32 s63, s55, 1
    s_add_u32 s3, s3, s63
    s_lshl_b32 s3, s3, 16
    s_add_u32 s3, s3, 135168
    buffer_load_dwordx4 v[120:123], v16, s[8:11], s3 offen
    ds_read_b64_tr_b16 v[24:25], v4 offset:16384
    ds_read_b64_tr_b16 v[26:27], v4 offset:20480
    ds_read_b64_tr_b16 v[28:29], v5 offset:16384
    ds_read_b64_tr_b16 v[30:31], v5 offset:20480
    ds_read_b64_tr_b16 v[32:33], v6 offset:16384
    ds_read_b64_tr_b16 v[34:35], v6 offset:20480
    ds_read_b64_tr_b16 v[36:37], v7 offset:16384
    ds_read_b64_tr_b16 v[38:39], v7 offset:20480
    ds_read_b64_tr_b16 v[40:41], v8 offset:16384
    ds_read_b64_tr_b16 v[42:43], v8 offset:20480
    ds_read_b64_tr_b16 v[44:45], v9 offset:16384
    ds_read_b64_tr_b16 v[46:47], v9 offset:20480
    ds_read_b64_tr_b16 v[48:49], v10 offset:16384
    ds_read_b64_tr_b16 v[50:51], v10 offset:20480
    ds_read_b64_tr_b16 v[52:53], v11 offset:16384
    ds_read_b64_tr_b16 v[54:55], v11 offset:20480
    s_waitcnt lgkmcnt(14)
    v_mfma_f32_16x16x32_bf16 v[56:59], v[24:27], v[232:235], v[56:59]
    s_waitcnt lgkmcnt(12)
    v_mfma_f32_16x16x32_bf16 v[60:63], v[28:31], v[232:235], v[60:63]
    s_waitcnt lgkmcnt(10)
    v_mfma_f32_16x16x32_bf16 v[64:67], v[32:35], v[232:235], v[64:67]
    s_waitcnt lgkmcnt(8)
    v_mfma_f32_16x16x32_bf16 v[68:71], v[36:39], v[232:235], v[68:71]
    s_waitcnt lgkmcnt(6)
    v_mfma_f32_16x16x32_bf16 v[72:75], v[40:43], v[232:235], v[72:75]
    s_waitcnt lgkmcnt(4)
    v_mfma_f32_16x16x32_bf16 v[76:79], v[44:47], v[232:235], v[76:79]
    s_waitcnt lgkmcnt(2)
    v_mfma_f32_16x16x32_bf16 v[80:83], v[48:51], v[232:235], v[80:83]
    s_waitcnt lgkmcnt(0)
    v_mfma_f32_16x16x32_bf16 v[84:87], v[52:55], v[232:235], v[84:87]
    s_waitcnt lgkmcnt(0)
    s_barrier
    s_add_u32 s3, s98, 1
    s_and_b32 s3, s3, 3
    s_lshl_b32 s3, s3, 1
    s_lshl_b32 s63, s97, 3
    s_add_u32 s3, s3, s63
    s_lshl_b32 s3, s3, 17
    s_add_u32 m0, s56, 155648
    s_add_u32 s60, s3, 98304
    buffer_load_dwordx4 v16, s[8:11], s60 offen lds
    s_add_u32 m0, s56, 156672
    s_add_u32 s60, s3, 102400
    buffer_load_dwordx4 v17, s[8:11], s60 offen lds
    v_mfma_f32_16x16x32_bf16 v[88:91], v[24:27], v[236:239], v[88:91]
    v_mfma_f32_16x16x32_bf16 v[92:95], v[28:31], v[236:239], v[92:95]
    v_mfma_f32_16x16x32_bf16 v[96:99], v[32:35], v[236:239], v[96:99]
    v_mfma_f32_16x16x32_bf16 v[100:103], v[36:39], v[236:239], v[100:103]
    v_mfma_f32_16x16x32_bf16 v[104:107], v[40:43], v[236:239], v[104:107]
    v_mfma_f32_16x16x32_bf16 v[108:111], v[44:47], v[236:239], v[108:111]
    v_mfma_f32_16x16x32_bf16 v[112:115], v[48:51], v[236:239], v[112:115]
    v_mfma_f32_16x16x32_bf16 v[116:119], v[52:55], v[236:239], v[116:119]
    s_waitcnt vmcnt(8) lgkmcnt(0)
    s_barrier
    s_lshr_b32 s3, s55, 1
    s_lshl_b32 s63, s97, 2
    s_add_u32 s3, s3, s63
    s_lshl_b32 s3, s3, 2
    s_and_b32 s63, s55, 1
    s_add_u32 s3, s3, s63
    s_lshl_b32 s3, s3, 16
    s_add_u32 s3, s3, 163840
    buffer_load_dwordx4 v[224:227], v16, s[8:11], s3 offen
    ds_read_b64_tr_b16 v[24:25], v4 offset:24576
    ds_read_b64_tr_b16 v[26:27], v4 offset:28672
    ds_read_b64_tr_b16 v[28:29], v5 offset:24576
    ds_read_b64_tr_b16 v[30:31], v5 offset:28672
    ds_read_b64_tr_b16 v[32:33], v6 offset:24576
    ds_read_b64_tr_b16 v[34:35], v6 offset:28672
    ds_read_b64_tr_b16 v[36:37], v7 offset:24576
    ds_read_b64_tr_b16 v[38:39], v7 offset:28672
    ds_read_b64_tr_b16 v[40:41], v8 offset:24576
    ds_read_b64_tr_b16 v[42:43], v8 offset:28672
    ds_read_b64_tr_b16 v[44:45], v9 offset:24576
    ds_read_b64_tr_b16 v[46:47], v9 offset:28672
    ds_read_b64_tr_b16 v[48:49], v10 offset:24576
    ds_read_b64_tr_b16 v[50:51], v10 offset:28672
    ds_read_b64_tr_b16 v[52:53], v11 offset:24576
    ds_read_b64_tr_b16 v[54:55], v11 offset:28672
    s_waitcnt lgkmcnt(14)
    v_mfma_f32_16x16x32_bf16 v[56:59], v[24:27], v[240:243], v[56:59]
    s_waitcnt lgkmcnt(12)
    v_mfma_f32_16x16x32_bf16 v[60:63], v[28:31], v[240:243], v[60:63]
    s_waitcnt lgkmcnt(10)
    v_mfma_f32_16x16x32_bf16 v[64:67], v[32:35], v[240:243], v[64:67]
    s_waitcnt lgkmcnt(8)
    v_mfma_f32_16x16x32_bf16 v[68:71], v[36:39], v[240:243], v[68:71]
    s_waitcnt lgkmcnt(6)
    v_mfma_f32_16x16x32_bf16 v[72:75], v[40:43], v[240:243], v[72:75]
    s_waitcnt lgkmcnt(4)
    v_mfma_f32_16x16x32_bf16 v[76:79], v[44:47], v[240:243], v[76:79]
    s_waitcnt lgkmcnt(2)
    v_mfma_f32_16x16x32_bf16 v[80:83], v[48:51], v[240:243], v[80:83]
    s_waitcnt lgkmcnt(0)
    v_mfma_f32_16x16x32_bf16 v[84:87], v[52:55], v[240:243], v[84:87]
    v_and_b32 v18, 3, v22
    v_lshlrev_b32 v18, 7, v18
    buffer_load_dwordx2 v[20:21], v18, s[16:19], s7 offen sc1
    s_waitcnt lgkmcnt(0)
    s_barrier
    v_mfma_f32_16x16x32_bf16 v[88:91], v[24:27], v[244:247], v[88:91]
    v_mfma_f32_16x16x32_bf16 v[92:95], v[28:31], v[244:247], v[92:95]
    v_mfma_f32_16x16x32_bf16 v[96:99], v[32:35], v[244:247], v[96:99]
    v_mfma_f32_16x16x32_bf16 v[100:103], v[36:39], v[244:247], v[100:103]
    v_mfma_f32_16x16x32_bf16 v[104:107], v[40:43], v[244:247], v[104:107]
    v_mfma_f32_16x16x32_bf16 v[108:111], v[44:47], v[244:247], v[108:111]
    v_mfma_f32_16x16x32_bf16 v[112:115], v[48:51], v[244:247], v[112:115]
    v_mfma_f32_16x16x32_bf16 v[116:119], v[52:55], v[244:247], v[116:119]
    s_waitcnt vmcnt(4) lgkmcnt(0)
    s_barrier
    s_lshr_b32 s3, s55, 1
    s_lshl_b32 s63, s97, 2
    s_add_u32 s3, s3, s63
    s_lshl_b32 s3, s3, 2
    s_and_b32 s63, s55, 1
    s_add_u32 s3, s3, s63
    s_lshl_b32 s3, s3, 16
    s_add_u32 s3, s3, 167936
    buffer_load_dwordx4 v[224:227], v16, s[8:11], s3 offen
    s_nop 5
    ds_read_b128 v[152:155], v0 offset:57344
    ds_read_b128 v[156:159], v0 offset:61440
    ds_read_b128 v[160:163], v1 offset:57344
    ds_read_b128 v[164:167], v1 offset:61440
    ds_read_b128 v[168:171], v2 offset:57344
    ds_read_b128 v[172:175], v2 offset:61440
    ds_read_b128 v[176:179], v3 offset:57344
    ds_read_b128 v[180:183], v3 offset:61440
    v_mul_f32 v56, s62, v56
    v_mul_f32 v57, s62, v57
    v_mul_f32 v58, s62, v58
    v_mul_f32 v59, s62, v59
    v_mul_f32 v60, s62, v60
    v_mul_f32 v61, s62, v61
    v_mul_f32 v62, s62, v62
    v_mul_f32 v63, s62, v63
    v_cvt_pk_bf16_f32 v120, v56, v57
    v_cvt_pk_bf16_f32 v121, v58, v59
    v_cvt_pk_bf16_f32 v122, v60, v61
    v_cvt_pk_bf16_f32 v123, v62, v63
    v_mul_f32 v64, s62, v64
    v_mul_f32 v65, s62, v65
    v_mul_f32 v66, s62, v66
    v_mul_f32 v67, s62, v67
    v_mul_f32 v68, s62, v68
    v_mul_f32 v69, s62, v69
    v_mul_f32 v70, s62, v70
    v_mul_f32 v71, s62, v71
    v_cvt_pk_bf16_f32 v124, v64, v65
    v_cvt_pk_bf16_f32 v125, v66, v67
    v_cvt_pk_bf16_f32 v126, v68, v69
    v_cvt_pk_bf16_f32 v127, v70, v71
    v_mul_f32 v72, s62, v72
    v_mul_f32 v73, s62, v73
    v_mul_f32 v74, s62, v74
    v_mul_f32 v75, s62, v75
    v_mul_f32 v76, s62, v76
    v_mul_f32 v77, s62, v77
    v_mul_f32 v78, s62, v78
    v_mul_f32 v79, s62, v79
    v_cvt_pk_bf16_f32 v128, v72, v73
    v_cvt_pk_bf16_f32 v129, v74, v75
    v_cvt_pk_bf16_f32 v130, v76, v77
    v_cvt_pk_bf16_f32 v131, v78, v79
    v_mul_f32 v80, s62, v80
    v_mul_f32 v81, s62, v81
    v_mul_f32 v82, s62, v82
    v_mul_f32 v83, s62, v83
    v_mul_f32 v84, s62, v84
    v_mul_f32 v85, s62, v85
    v_mul_f32 v86, s62, v86
    v_mul_f32 v87, s62, v87
    v_cvt_pk_bf16_f32 v132, v80, v81
    v_cvt_pk_bf16_f32 v133, v82, v83
    v_cvt_pk_bf16_f32 v134, v84, v85
    v_cvt_pk_bf16_f32 v135, v86, v87
    v_mul_f32 v88, s62, v88
    v_mul_f32 v89, s62, v89
    v_mul_f32 v90, s62, v90
    v_mul_f32 v91, s62, v91
    v_mul_f32 v92, s62, v92
    v_mul_f32 v93, s62, v93
    v_mul_f32 v94, s62, v94
    v_mul_f32 v95, s62, v95
    v_cvt_pk_bf16_f32 v136, v88, v89
    v_cvt_pk_bf16_f32 v137, v90, v91
    v_cvt_pk_bf16_f32 v138, v92, v93
    v_cvt_pk_bf16_f32 v139, v94, v95
    v_mul_f32 v96, s62, v96
    v_mul_f32 v97, s62, v97
    v_mul_f32 v98, s62, v98
    v_mul_f32 v99, s62, v99
    v_mul_f32 v100, s62, v100
    v_mul_f32 v101, s62, v101
    v_mul_f32 v102, s62, v102
    v_mul_f32 v103, s62, v103
    v_cvt_pk_bf16_f32 v140, v96, v97
    v_cvt_pk_bf16_f32 v141, v98, v99
    v_cvt_pk_bf16_f32 v142, v100, v101
    v_cvt_pk_bf16_f32 v143, v102, v103
    v_mul_f32 v104, s62, v104
    v_mul_f32 v105, s62, v105
    v_mul_f32 v106, s62, v106
    v_mul_f32 v107, s62, v107
    v_mul_f32 v108, s62, v108
    v_mul_f32 v109, s62, v109
    v_mul_f32 v110, s62, v110
    v_mul_f32 v111, s62, v111
    v_cvt_pk_bf16_f32 v144, v104, v105
    v_cvt_pk_bf16_f32 v145, v106, v107
    v_cvt_pk_bf16_f32 v146, v108, v109
    v_cvt_pk_bf16_f32 v147, v110, v111
    v_mul_f32 v112, s62, v112
    v_mul_f32 v113, s62, v113
    v_mul_f32 v114, s62, v114
    v_mul_f32 v115, s62, v115
    v_mul_f32 v116, s62, v116
    v_mul_f32 v117, s62, v117
    v_mul_f32 v118, s62, v118
    v_mul_f32 v119, s62, v119
    v_cvt_pk_bf16_f32 v148, v112, v113
    v_cvt_pk_bf16_f32 v149, v114, v115
    v_cvt_pk_bf16_f32 v150, v116, v117
    v_cvt_pk_bf16_f32 v151, v118, v119
    s_nop 1
    v_permlane32_swap_b32 v120, v122
    v_permlane32_swap_b32 v121, v123
    v_permlane32_swap_b32 v124, v126
    v_permlane32_swap_b32 v125, v127
    v_permlane32_swap_b32 v128, v130
    v_permlane32_swap_b32 v129, v131
    v_permlane32_swap_b32 v132, v134
    v_permlane32_swap_b32 v133, v135
    v_permlane32_swap_b32 v136, v138
    v_permlane32_swap_b32 v137, v139
    v_permlane32_swap_b32 v140, v142
    v_permlane32_swap_b32 v141, v143
    v_permlane32_swap_b32 v144, v146
    v_permlane32_swap_b32 v145, v147
    v_permlane32_swap_b32 v148, v150
    v_permlane32_swap_b32 v149, v151
    s_nop 1
    v_permlane16_swap_b32 v120, v122
    v_permlane16_swap_b32 v121, v123
    v_permlane16_swap_b32 v124, v126
    v_permlane16_swap_b32 v125, v127
    v_permlane16_swap_b32 v128, v130
    v_permlane16_swap_b32 v129, v131
    v_permlane16_swap_b32 v132, v134
    v_permlane16_swap_b32 v133, v135
    v_permlane16_swap_b32 v136, v138
    v_permlane16_swap_b32 v137, v139
    v_permlane16_swap_b32 v140, v142
    v_permlane16_swap_b32 v141, v143
    v_permlane16_swap_b32 v144, v146
    v_permlane16_swap_b32 v145, v147
    v_permlane16_swap_b32 v148, v150
    v_permlane16_swap_b32 v149, v151
    s_nop 1
    v_add_u32 v4, 0xffff0000, v4
    v_add_u32 v5, 0xffff0000, v5
    v_add_u32 v6, 0xffff0000, v6
    v_add_u32 v7, 0xffff0000, v7
    v_add_u32 v8, 0xffff0000, v8
    v_add_u32 v9, 0xffff0000, v9
    v_add_u32 v10, 0xffff0000, v10
    v_add_u32 v11, 0xffff0000, v11
    s_waitcnt vmcnt(1) lgkmcnt(0)
    s_barrier
    s_getreg_b32 s63, hwreg(HW_REG_XCC_ID, 0, 4)
    s_add_u32 s63, s63, s100
    v_cmp_ne_u32 vcc, s99, v20
    v_cmp_ne_u32 s[4:5], s63, v21
    s_or_b64 vcc, vcc, s[4:5]
    s_cselect_b32 s6, 0, 1
    s_add_u32 s57, s56, 294912
    s_add_u32 s58, s56, 278528
L_att:
    s_waitcnt lgkmcnt(7)
    v_mfma_f32_16x16x32_bf16 v[184:187], v[152:155], v[120:123], 0
    v_mov_b64 v[56:57], 0
    v_mov_b64 v[58:59], 0
    v_mfma_f32_16x16x32_bf16 v[192:195], v[152:155], v[136:139], 0
    v_mov_b64 v[60:61], 0
    v_mov_b64 v[62:63], 0
    s_waitcnt lgkmcnt(6)
    v_mfma_f32_16x16x32_bf16 v[188:191], v[156:159], v[120:123], 0
    v_mov_b64 v[64:65], 0
    v_mov_b64 v[66:67], 0
    v_mfma_f32_16x16x32_bf16 v[196:199], v[156:159], v[136:139], 0
    v_mov_b64 v[68:69], 0
    v_mov_b64 v[70:71], 0
    s_waitcnt lgkmcnt(5)
    v_mfma_f32_16x16x32_bf16 v[184:187], v[160:163], v[124:127], v[184:187]
    v_mov_b64 v[72:73], 0
    v_mov_b64 v[74:75], 0
    v_mfma_f32_16x16x32_bf16 v[192:195], v[160:163], v[140:143], v[192:195]
    v_mov_b64 v[76:77], 0
    v_mov_b64 v[78:79], 0
    s_waitcnt lgkmcnt(4)
    v_mfma_f32_16x16x32_bf16 v[188:191], v[164:167], v[124:127], v[188:191]
    v_mov_b64 v[80:81], 0
    v_mov_b64 v[82:83], 0
    v_mfma_f32_16x16x32_bf16 v[196:199], v[164:167], v[140:143], v[196:199]
    v_mov_b64 v[84:85], 0
    v_mov_b64 v[86:87], 0
    s_waitcnt lgkmcnt(3)
    v_mfma_f32_16x16x32_bf16 v[184:187], v[168:171], v[128:131], v[184:187]
    v_mov_b64 v[88:89], 0
    v_mov_b64 v[90:91], 0
    v_mfma_f32_16x16x32_bf16 v[192:195], v[168:171], v[144:147], v[192:195]
    v_mov_b64 v[92:93], 0
    v_mov_b64 v[94:95], 0
    s_waitcnt lgkmcnt(2)
    v_mfma_f32_16x16x32_bf16 v[188:191], v[172:175], v[128:131], v[188:191]
    v_mov_b64 v[96:97], 0
    v_mov_b64 v[98:99], 0
    v_mfma_f32_16x16x32_bf16 v[196:199], v[172:175], v[144:147], v[196:199]
    v_mov_b64 v[100:101], 0
    v_mov_b64 v[102:103], 0
    s_waitcnt lgkmcnt(1)
    v_mfma_f32_16x16x32_bf16 v[184:187], v[176:179], v[132:135], v[184:187]
    v_mov_b64 v[104:105], 0
    v_mov_b64 v[106:107], 0
    v_mfma_f32_16x16x32_bf16 v[192:195], v[176:179], v[148:151], v[192:195]
    v_mov_b64 v[108:109], 0
    v_mov_b64 v[110:111], 0
    s_waitcnt lgkmcnt(0)
    v_mfma_f32_16x16x32_bf16 v[188:191], v[180:183], v[132:135], v[188:191]
    v_mov_b64 v[112:113], 0
    v_mov_b64 v[114:115], 0
    v_mfma_f32_16x16x32_bf16 v[196:199], v[180:183], v[148:151], v[196:199]
    v_mov_b64 v[116:117], 0
    v_mov_b64 v[118:119], 0
    v_mov_b32 v16, 0
    v_mov_b32 v17, 0
    ds_read_b128 v[152:155], v0 offset:8192
    ds_read_b128 v[156:159], v0 offset:12288
    ds_read_b128 v[160:163], v1 offset:8192
    ds_read_b128 v[164:167], v1 offset:12288
    ds_read_b128 v[168:171], v2 offset:8192
    ds_read_b128 v[172:175], v2 offset:12288
    ds_read_b128 v[176:179], v3 offset:8192
    ds_read_b128 v[180:183], v3 offset:12288
    v_max3_f32 v18, v184, v185, v186
    v_max3_f32 v18, v18, v187, v188
    v_max3_f32 v18, v18, v189, v190
    v_max_f32 v18, v18, v191
    v_mov_b32 v19, v18
    s_nop 1
    v_permlane32_swap_b32 v19, v18
    s_nop 1
    v_max_f32 v18, v18, v19
    v_mov_b32 v19, v18
    s_nop 1
    v_permlane16_swap_b32 v19, v18
    s_nop 1
    v_max_f32 v18, v18, v19
    v_sub_f32 v184, v184, v18
    v_sub_f32 v185, v185, v18
    v_sub_f32 v186, v186, v18
    v_sub_f32 v187, v187, v18
    v_sub_f32 v188, v188, v18
    v_sub_f32 v189, v189, v18
    v_sub_f32 v190, v190, v18
    v_sub_f32 v191, v191, v18
    v_sub_f32 v216, 0, v18
    v_sub_f32 v217, 0, v18
    v_sub_f32 v218, 0, v18
    v_sub_f32 v219, 0, v18
    v_max3_f32 v18, v192, v193, v194
    v_max3_f32 v18, v18, v195, v196
    v_max3_f32 v18, v18, v197, v198
    v_max_f32 v18, v18, v199
    v_mov_b32 v19, v18
    s_nop 1
    v_permlane32_swap_b32 v19, v18
    s_nop 1
    v_max_f32 v18, v18, v19
    v_mov_b32 v19, v18
    s_nop 1
    v_permlane16_swap_b32 v19, v18
    s_nop 1
    v_max_f32 v18, v18, v19
    v_sub_f32 v192, v192, v18
    v_sub_f32 v193, v193, v18
    v_sub_f32 v194, v194, v18
    v_sub_f32 v195, v195, v18
    v_sub_f32 v196, v196, v18
    v_sub_f32 v197, v197, v18
    v_sub_f32 v198, v198, v18
    v_sub_f32 v199, v199, v18
    v_sub_f32 v220, 0, v18
    v_sub_f32 v221, 0, v18
    v_sub_f32 v222, 0, v18
    v_sub_f32 v223, 0, v18
    s_setprio 2
    s_mov_b32 s59, 8
.p2align 3
L_loop:
    s_waitcnt vmcnt(4) lgkmcnt(0)
    s_barrier
    v_mfma_f32_16x16x32_bf16 v[200:203], v[152:155], v[120:123], v[216:219]
    ds_read_b64_tr_b16 v[24:25], v4 offset:16384
    ds_read_b64_tr_b16 v[26:27], v4 offset:20480
    v_exp_f32 v184, v184
    v_mfma_f32_16x16x32_bf16 v[208:211], v[152:155], v[136:139], v[220:223]
    ds_read_b64_tr_b16 v[28:29], v5 offset:16384
    v_exp_f32 v185, v185
    v_mfma_f32_16x16x32_bf16 v[204:207], v[156:159], v[120:123], v[216:219]
    ds_read_b64_tr_b16 v[30:31], v5 offset:20480
    v_exp_f32 v186, v186
    v_mfma_f32_16x16x32_bf16 v[212:215], v[156:159], v[136:139], v[220:223]
    ds_read_b64_tr_b16 v[32:33], v6 offset:16384
    ds_read_b64_tr_b16 v[34:35], v6 offset:20480
    v_exp_f32 v187, v187
    v_mfma_f32_16x16x32_bf16 v[200:203], v[160:163], v[124:127], v[200:203]
    ds_read_b64_tr_b16 v[36:37], v7 offset:16384
    v_exp_f32 v188, v188
    v_cvt_pk_bf16_f32 v232, v184, v185
    v_mfma_f32_16x16x32_bf16 v[208:211], v[160:163], v[140:143], v[208:211]
    ds_read_b64_tr_b16 v[38:39], v7 offset:20480
    v_exp_f32 v189, v189
    v_mfma_f32_16x16x32_bf16 v[204:207], v[164:167], v[124:127], v[204:207]
    ds_read_b64_tr_b16 v[40:41], v8 offset:16384
    ds_read_b64_tr_b16 v[42:43], v8 offset:20480
    v_exp_f32 v190, v190
    v_mfma_f32_16x16x32_bf16 v[212:215], v[164:167], v[140:143], v[212:215]
    ds_read_b64_tr_b16 v[44:45], v9 offset:16384
    v_exp_f32 v191, v191
    v_cvt_pk_bf16_f32 v233, v186, v187
    v_mfma_f32_16x16x32_bf16 v[200:203], v[168:171], v[128:131], v[200:203]
    ds_read_b64_tr_b16 v[46:47], v9 offset:20480
    v_exp_f32 v192, v192
    v_mfma_f32_16x16x32_bf16 v[208:211], v[168:171], v[144:147], v[208:211]
    ds_read_b64_tr_b16 v[48:49], v10 offset:16384
    ds_read_b64_tr_b16 v[50:51], v10 offset:20480
    v_exp_f32 v193, v193
    v_mfma_f32_16x16x32_bf16 v[204:207], v[172:175], v[128:131], v[204:207]
    ds_read_b64_tr_b16 v[52:53], v11 offset:16384
    v_exp_f32 v194, v194
    v_cvt_pk_bf16_f32 v234, v188, v189
    v_mfma_f32_16x16x32_bf16 v[212:215], v[172:175], v[144:147], v[212:215]
    ds_read_b64_tr_b16 v[54:55], v11 offset:20480
    v_exp_f32 v195, v195
    v_mfma_f32_16x16x32_bf16 v[200:203], v[176:179], v[132:135], v[200:203]
    v_exp_f32 v196, v196
    v_mfma_f32_16x16x32_bf16 v[208:211], v[176:179], v[148:151], v[208:211]
    v_exp_f32 v197, v197
    v_cvt_pk_bf16_f32 v235, v190, v191
    v_mfma_f32_16x16x32_bf16 v[204:207], v[180:183], v[132:135], v[204:207]
    v_exp_f32 v198, v198
    v_mfma_f32_16x16x32_bf16 v[212:215], v[180:183], v[148:151], v[212:215]
    v_exp_f32 v199, v199
    s_waitcnt lgkmcnt(14)
    v_mfma_f32_16x16x32_bf16 v[56:59], v[24:27], v[232:235], v[56:59]
    ds_read_b128 v[152:155], v0 offset:24576
    v_add_f32 v16, v16, v184
    s_waitcnt lgkmcnt(13)
    v_mfma_f32_16x16x32_bf16 v[60:63], v[28:31], v[232:235], v[60:63]
    ds_read_b128 v[156:159], v0 offset:28672
    v_add_f32 v16, v16, v185
    v_cvt_pk_bf16_f32 v236, v192, v193
    s_waitcnt lgkmcnt(12)
    v_mfma_f32_16x16x32_bf16 v[64:67], v[32:35], v[232:235], v[64:67]
    ds_read_b128 v[160:163], v1 offset:24576
    v_add_f32 v16, v16, v186
    v_cvt_pk_bf16_f32 v237, v194, v195
    s_waitcnt lgkmcnt(11)
    v_mfma_f32_16x16x32_bf16 v[68:71], v[36:39], v[232:235], v[68:71]
    ds_read_b128 v[164:167], v1 offset:28672
    v_add_f32 v16, v16, v187
    v_cvt_pk_bf16_f32 v238, v196, v197
    s_waitcnt lgkmcnt(10)
    v_mfma_f32_16x16x32_bf16 v[72:75], v[40:43], v[232:235], v[72:75]
    ds_read_b128 v[168:171], v2 offset:24576
    v_add_f32 v16, v16, v188
    v_cvt_pk_bf16_f32 v239, v198, v199
    s_waitcnt lgkmcnt(9)
    v_mfma_f32_16x16x32_bf16 v[76:79], v[44:47], v[232:235], v[76:79]
    ds_read_b128 v[172:175], v2 offset:28672
    v_add_f32 v16, v16, v189
    s_waitcnt lgkmcnt(8)
    v_mfma_f32_16x16x32_bf16 v[80:83], v[48:51], v[232:235], v[80:83]
    ds_read_b128 v[176:179], v3 offset:24576
    v_add_f32 v16, v16, v190
    s_waitcnt lgkmcnt(7)
    v_mfma_f32_16x16x32_bf16 v[84:87], v[52:55], v[232:235], v[84:87]
    ds_read_b128 v[180:183], v3 offset:28672
    v_add_f32 v16, v16, v191
    v_mfma_f32_16x16x32_bf16 v[88:91], v[24:27], v[236:239], v[88:91]
    s_add_u32 m0, s56, 49152
    s_nop 0
    buffer_load_dwordx4 v14, s[36:39], s58 offen nt lds
    v_max3_f32 v18, v200, v201, v202
    v_add_f32 v17, v17, v192
    v_mfma_f32_16x16x32_bf16 v[92:95], v[28:31], v[236:239], v[92:95]
    v_max3_f32 v18, v18, v203, v204
    v_add_f32 v17, v17, v193
    v_mfma_f32_16x16x32_bf16 v[96:99], v[32:35], v[236:239], v[96:99]
    buffer_load_dwordx4 v15, s[36:39], s58 offen offset:1024 nt lds
    s_add_u32 s58, s58, 8192
    v_max3_f32 v18, v18, v205, v206
    v_add_f32 v17, v17, v194
    v_mfma_f32_16x16x32_bf16 v[100:103], v[36:39], v[236:239], v[100:103]
    v_max3_f32 v18, v18, v207, v208
    v_add_f32 v17, v17, v195
    v_mfma_f32_16x16x32_bf16 v[104:107], v[40:43], v[236:239], v[104:107]
    s_add_u32 m0, s56, 57344
    s_nop 0
    buffer_load_dwordx4 v12, s[32:35], s57 offen nt lds
    v_max3_f32 v18, v18, v209, v210
    v_add_f32 v17, v17, v196
    v_mfma_f32_16x16x32_bf16 v[108:111], v[44:47], v[236:239], v[108:111]
    v_max3_f32 v18, v18, v211, v212
    v_add_f32 v17, v17, v197
    v_mfma_f32_16x16x32_bf16 v[112:115], v[48:51], v[236:239], v[112:115]
    buffer_load_dwordx4 v13, s[32:35], s57 offen offset:1024 nt lds
    s_add_u32 s57, s57, 8192
    v_max3_f32 v18, v18, v213, v214
    v_add_f32 v17, v17, v198
    v_mfma_f32_16x16x32_bf16 v[116:119], v[52:55], v[236:239], v[116:119]
    v_max_f32 v18, v18, v215
    v_add_f32 v17, v17, v199
    v_cmp_lt_f32 vcc, s61, v18
    s_cbranch_vccnz L_rare0
L_back0:
    s_waitcnt vmcnt(4) lgkmcnt(0)
    s_barrier
    v_mfma_f32_16x16x32_bf16 v[184:187], v[152:155], v[120:123], v[216:219]
    ds_read_b64_tr_b16 v[24:25], v4 offset:32768
    ds_read_b64_tr_b16 v[26:27], v4 offset:36864
    v_exp_f32 v200, v200
    v_mfma_f32_16x16x32_bf16 v[192:195], v[152:155], v[136:139], v[220:223]
    ds_read_b64_tr_b16 v[28:29], v5 offset:32768
    v_exp_f32 v201, v201
    v_mfma_f32_16x16x32_bf16 v[188:191], v[156:159], v[120:123], v[216:219]
    ds_read_b64_tr_b16 v[30:31], v5 offset:36864
    v_exp_f32 v202, v202
    v_mfma_f32_16x16x32_bf16 v[196:199], v[156:159], v[136:139], v[220:223]
    ds_read_b64_tr_b16 v[32:33], v6 offset:32768
    ds_read_b64_tr_b16 v[34:35], v6 offset:36864
    v_exp_f32 v203, v203
    v_mfma_f32_16x16x32_bf16 v[184:187], v[160:163], v[124:127], v[184:187]
    ds_read_b64_tr_b16 v[36:37], v7 offset:32768
    v_exp_f32 v204, v204
    v_cvt_pk_bf16_f32 v232, v200, v201
    v_mfma_f32_16x16x32_bf16 v[192:195], v[160:163], v[140:143], v[192:195]
    ds_read_b64_tr_b16 v[38:39], v7 offset:36864
    v_exp_f32 v205, v205
    v_mfma_f32_16x16x32_bf16 v[188:191], v[164:167], v[124:127], v[188:191]
    ds_read_b64_tr_b16 v[40:41], v8 offset:32768
    ds_read_b64_tr_b16 v[42:43], v8 offset:36864
    v_exp_f32 v206, v206
    v_mfma_f32_16x16x32_bf16 v[196:199], v[164:167], v[140:143], v[196:199]
    ds_read_b64_tr_b16 v[44:45], v9 offset:32768
    v_exp_f32 v207, v207
    v_cvt_pk_bf16_f32 v233, v202, v203
    v_mfma_f32_16x16x32_bf16 v[184:187], v[168:171], v[128:131], v[184:187]
    ds_read_b64_tr_b16 v[46:47], v9 offset:36864
    v_exp_f32 v208, v208
    v_mfma_f32_16x16x32_bf16 v[192:195], v[168:171], v[144:147], v[192:195]
    ds_read_b64_tr_b16 v[48:49], v10 offset:32768
    ds_read_b64_tr_b16 v[50:51], v10 offset:36864
    v_exp_f32 v209, v209
    v_mfma_f32_16x16x32_bf16 v[188:191], v[172:175], v[128:131], v[188:191]
    ds_read_b64_tr_b16 v[52:53], v11 offset:32768
    v_exp_f32 v210, v210
    v_cvt_pk_bf16_f32 v234, v204, v205
    v_mfma_f32_16x16x32_bf16 v[196:199], v[172:175], v[144:147], v[196:199]
    ds_read_b64_tr_b16 v[54:55], v11 offset:36864
    v_exp_f32 v211, v211
    v_mfma_f32_16x16x32_bf16 v[184:187], v[176:179], v[132:135], v[184:187]
    v_exp_f32 v212, v212
    v_mfma_f32_16x16x32_bf16 v[192:195], v[176:179], v[148:151], v[192:195]
    v_exp_f32 v213, v213
    v_cvt_pk_bf16_f32 v235, v206, v207
    v_mfma_f32_16x16x32_bf16 v[188:191], v[180:183], v[132:135], v[188:191]
    v_exp_f32 v214, v214
    v_mfma_f32_16x16x32_bf16 v[196:199], v[180:183], v[148:151], v[196:199]
    v_exp_f32 v215, v215
    s_waitcnt lgkmcnt(14)
    v_mfma_f32_16x16x32_bf16 v[56:59], v[24:27], v[232:235], v[56:59]
    ds_read_b128 v[152:155], v0 offset:40960
    v_add_f32 v16, v16, v200
    s_waitcnt lgkmcnt(13)
    v_mfma_f32_16x16x32_bf16 v[60:63], v[28:31], v[232:235], v[60:63]
    ds_read_b128 v[156:159], v0 offset:45056
    v_add_f32 v16, v16, v201
    v_cvt_pk_bf16_f32 v236, v208, v209
    s_waitcnt lgkmcnt(12)
    v_mfma_f32_16x16x32_bf16 v[64:67], v[32:35], v[232:235], v[64:67]
    ds_read_b128 v[160:163], v1 offset:40960
    v_add_f32 v16, v16, v202
    v_cvt_pk_bf16_f32 v237, v210, v211
    s_waitcnt lgkmcnt(11)
    v_mfma_f32_16x16x32_bf16 v[68:71], v[36:39], v[232:235], v[68:71]
    ds_read_b128 v[164:167], v1 offset:45056
    v_add_f32 v16, v16, v203
    v_cvt_pk_bf16_f32 v238, v212, v213
    s_waitcnt lgkmcnt(10)
    v_mfma_f32_16x16x32_bf16 v[72:75], v[40:43], v[232:235], v[72:75]
    ds_read_b128 v[168:171], v2 offset:40960
    v_add_f32 v16, v16, v204
    v_cvt_pk_bf16_f32 v239, v214, v215
    s_waitcnt lgkmcnt(9)
    v_mfma_f32_16x16x32_bf16 v[76:79], v[44:47], v[232:235], v[76:79]
    ds_read_b128 v[172:175], v2 offset:45056
    v_add_f32 v16, v16, v205
    s_waitcnt lgkmcnt(8)
    v_mfma_f32_16x16x32_bf16 v[80:83], v[48:51], v[232:235], v[80:83]
    ds_read_b128 v[176:179], v3 offset:40960
    v_add_f32 v16, v16, v206
    s_waitcnt lgkmcnt(7)
    v_mfma_f32_16x16x32_bf16 v[84:87], v[52:55], v[232:235], v[84:87]
    ds_read_b128 v[180:183], v3 offset:45056
    v_add_f32 v16, v16, v207
    v_mfma_f32_16x16x32_bf16 v[88:91], v[24:27], v[236:239], v[88:91]
    s_add_u32 m0, s56, 0
    s_nop 0
    buffer_load_dwordx4 v14, s[36:39], s58 offen nt lds
    v_max3_f32 v18, v184, v185, v186
    v_add_f32 v17, v17, v208
    v_mfma_f32_16x16x32_bf16 v[92:95], v[28:31], v[236:239], v[92:95]
    v_max3_f32 v18, v18, v187, v188
    v_add_f32 v17, v17, v209
    v_mfma_f32_16x16x32_bf16 v[96:99], v[32:35], v[236:239], v[96:99]
    buffer_load_dwordx4 v15, s[36:39], s58 offen offset:1024 nt lds
    s_add_u32 s58, s58, 8192
    v_max3_f32 v18, v18, v189, v190
    v_add_f32 v17, v17, v210
    v_mfma_f32_16x16x32_bf16 v[100:103], v[36:39], v[236:239], v[100:103]
    v_max3_f32 v18, v18, v191, v192
    v_add_f32 v17, v17, v211
    v_mfma_f32_16x16x32_bf16 v[104:107], v[40:43], v[236:239], v[104:107]
    s_add_u32 m0, s56, 8192
    s_nop 0
    buffer_load_dwordx4 v12, s[32:35], s57 offen nt lds
    v_max3_f32 v18, v18, v193, v194
    v_add_f32 v17, v17, v212
    v_mfma_f32_16x16x32_bf16 v[108:111], v[44:47], v[236:239], v[108:111]
    v_max3_f32 v18, v18, v195, v196
    v_add_f32 v17, v17, v213
    v_mfma_f32_16x16x32_bf16 v[112:115], v[48:51], v[236:239], v[112:115]
    buffer_load_dwordx4 v13, s[32:35], s57 offen offset:1024 nt lds
    s_add_u32 s57, s57, 8192
    v_max3_f32 v18, v18, v197, v198
    v_add_f32 v17, v17, v214
    v_mfma_f32_16x16x32_bf16 v[116:119], v[52:55], v[236:239], v[116:119]
    v_max_f32 v18, v18, v199
    v_add_f32 v17, v17, v215
    v_cmp_lt_f32 vcc, s61, v18
    s_cbranch_vccnz L_rare1
L_back1:
    s_waitcnt vmcnt(4) lgkmcnt(0)
    s_barrier
    v_mfma_f32_16x16x32_bf16 v[200:203], v[152:155], v[120:123], v[216:219]
    ds_read_b64_tr_b16 v[24:25], v4 offset:49152
    ds_read_b64_tr_b16 v[26:27], v4 offset:53248
    v_exp_f32 v184, v184
    v_mfma_f32_16x16x32_bf16 v[208:211], v[152:155], v[136:139], v[220:223]
    ds_read_b64_tr_b16 v[28:29], v5 offset:49152
    v_exp_f32 v185, v185
    v_mfma_f32_16x16x32_bf16 v[204:207], v[156:159], v[120:123], v[216:219]
    ds_read_b64_tr_b16 v[30:31], v5 offset:53248
    v_exp_f32 v186, v186
    v_mfma_f32_16x16x32_bf16 v[212:215], v[156:159], v[136:139], v[220:223]
    ds_read_b64_tr_b16 v[32:33], v6 offset:49152
    ds_read_b64_tr_b16 v[34:35], v6 offset:53248
    v_exp_f32 v187, v187
    v_mfma_f32_16x16x32_bf16 v[200:203], v[160:163], v[124:127], v[200:203]
    ds_read_b64_tr_b16 v[36:37], v7 offset:49152
    v_exp_f32 v188, v188
    v_cvt_pk_bf16_f32 v232, v184, v185
    v_mfma_f32_16x16x32_bf16 v[208:211], v[160:163], v[140:143], v[208:211]
    ds_read_b64_tr_b16 v[38:39], v7 offset:53248
    v_exp_f32 v189, v189
    v_mfma_f32_16x16x32_bf16 v[204:207], v[164:167], v[124:127], v[204:207]
    ds_read_b64_tr_b16 v[40:41], v8 offset:49152
    ds_read_b64_tr_b16 v[42:43], v8 offset:53248
    v_exp_f32 v190, v190
    v_mfma_f32_16x16x32_bf16 v[212:215], v[164:167], v[140:143], v[212:215]
    ds_read_b64_tr_b16 v[44:45], v9 offset:49152
    v_exp_f32 v191, v191
    v_cvt_pk_bf16_f32 v233, v186, v187
    v_mfma_f32_16x16x32_bf16 v[200:203], v[168:171], v[128:131], v[200:203]
    ds_read_b64_tr_b16 v[46:47], v9 offset:53248
    v_exp_f32 v192, v192
    v_mfma_f32_16x16x32_bf16 v[208:211], v[168:171], v[144:147], v[208:211]
    ds_read_b64_tr_b16 v[48:49], v10 offset:49152
    ds_read_b64_tr_b16 v[50:51], v10 offset:53248
    v_exp_f32 v193, v193
    v_mfma_f32_16x16x32_bf16 v[204:207], v[172:175], v[128:131], v[204:207]
    ds_read_b64_tr_b16 v[52:53], v11 offset:49152
    v_exp_f32 v194, v194
    v_cvt_pk_bf16_f32 v234, v188, v189
    v_mfma_f32_16x16x32_bf16 v[212:215], v[172:175], v[144:147], v[212:215]
    ds_read_b64_tr_b16 v[54:55], v11 offset:53248
    v_exp_f32 v195, v195
    v_mfma_f32_16x16x32_bf16 v[200:203], v[176:179], v[132:135], v[200:203]
    v_exp_f32 v196, v196
    v_mfma_f32_16x16x32_bf16 v[208:211], v[176:179], v[148:151], v[208:211]
    v_exp_f32 v197, v197
    v_cvt_pk_bf16_f32 v235, v190, v191
    v_mfma_f32_16x16x32_bf16 v[204:207], v[180:183], v[132:135], v[204:207]
    v_exp_f32 v198, v198
    v_mfma_f32_16x16x32_bf16 v[212:215], v[180:183], v[148:151], v[212:215]
    v_exp_f32 v199, v199
    s_waitcnt lgkmcnt(14)
    v_mfma_f32_16x16x32_bf16 v[56:59], v[24:27], v[232:235], v[56:59]
    ds_read_b128 v[152:155], v0 offset:57344
    v_add_f32 v16, v16, v184
    s_waitcnt lgkmcnt(13)
    v_mfma_f32_16x16x32_bf16 v[60:63], v[28:31], v[232:235], v[60:63]
    ds_read_b128 v[156:159], v0 offset:61440
    v_add_f32 v16, v16, v185
    v_cvt_pk_bf16_f32 v236, v192, v193
    s_waitcnt lgkmcnt(12)
    v_mfma_f32_16x16x32_bf16 v[64:67], v[32:35], v[232:235], v[64:67]
    ds_read_b128 v[160:163], v1 offset:57344
    v_add_f32 v16, v16, v186
    v_cvt_pk_bf16_f32 v237, v194, v195
    s_waitcnt lgkmcnt(11)
    v_mfma_f32_16x16x32_bf16 v[68:71], v[36:39], v[232:235], v[68:71]
    ds_read_b128 v[164:167], v1 offset:61440
    v_add_f32 v16, v16, v187
    v_cvt_pk_bf16_f32 v238, v196, v197
    s_waitcnt lgkmcnt(10)
    v_mfma_f32_16x16x32_bf16 v[72:75], v[40:43], v[232:235], v[72:75]
    ds_read_b128 v[168:171], v2 offset:57344
    v_add_f32 v16, v16, v188
    v_cvt_pk_bf16_f32 v239, v198, v199
    s_waitcnt lgkmcnt(9)
    v_mfma_f32_16x16x32_bf16 v[76:79], v[44:47], v[232:235], v[76:79]
    ds_read_b128 v[172:175], v2 offset:61440
    v_add_f32 v16, v16, v189
    s_waitcnt lgkmcnt(8)
    v_mfma_f32_16x16x32_bf16 v[80:83], v[48:51], v[232:235], v[80:83]
    ds_read_b128 v[176:179], v3 offset:57344
    v_add_f32 v16, v16, v190
    s_waitcnt lgkmcnt(7)
    v_mfma_f32_16x16x32_bf16 v[84:87], v[52:55], v[232:235], v[84:87]
    ds_read_b128 v[180:183], v3 offset:61440
    v_add_f32 v16, v16, v191
    v_mfma_f32_16x16x32_bf16 v[88:91], v[24:27], v[236:239], v[88:91]
    s_add_u32 m0, s56, 16384
    s_nop 0
    buffer_load_dwordx4 v14, s[36:39], s58 offen nt lds
    v_max3_f32 v18, v200, v201, v202
    v_add_f32 v17, v17, v192
    v_mfma_f32_16x16x32_bf16 v[92:95], v[28:31], v[236:239], v[92:95]
    v_max3_f32 v18, v18, v203, v204
    v_add_f32 v17, v17, v193
    v_mfma_f32_16x16x32_bf16 v[96:99], v[32:35], v[236:239], v[96:99]
    buffer_load_dwordx4 v15, s[36:39], s58 offen offset:1024 nt lds
    s_add_u32 s58, s58, 8192
    v_max3_f32 v18, v18, v205, v206
    v_add_f32 v17, v17, v194
    v_mfma_f32_16x16x32_bf16 v[100:103], v[36:39], v[236:239], v[100:103]
    v_max3_f32 v18, v18, v207, v208
    v_add_f32 v17, v17, v195
    v_mfma_f32_16x16x32_bf16 v[104:107], v[40:43], v[236:239], v[104:107]
    s_add_u32 m0, s56, 24576
    s_nop 0
    buffer_load_dwordx4 v12, s[32:35], s57 offen nt lds
    v_max3_f32 v18, v18, v209, v210
    v_add_f32 v17, v17, v196
    v_mfma_f32_16x16x32_bf16 v[108:111], v[44:47], v[236:239], v[108:111]
    v_max3_f32 v18, v18, v211, v212
    v_add_f32 v17, v17, v197
    v_mfma_f32_16x16x32_bf16 v[112:115], v[48:51], v[236:239], v[112:115]
    buffer_load_dwordx4 v13, s[32:35], s57 offen offset:1024 nt lds
    s_add_u32 s57, s57, 8192
    v_max3_f32 v18, v18, v213, v214
    v_add_f32 v17, v17, v198
    v_mfma_f32_16x16x32_bf16 v[116:119], v[52:55], v[236:239], v[116:119]
    v_max_f32 v18, v18, v215
    v_add_f32 v17, v17, v199
    v_cmp_lt_f32 vcc, s61, v18
    s_cbranch_vccnz L_rare2
L_back2:
    s_cmp_eq_u32 s59, 1
    s_cbranch_scc1 L_last
    s_waitcnt vmcnt(4) lgkmcnt(0)
    s_barrier
    v_mfma_f32_16x16x32_bf16 v[184:187], v[152:155], v[120:123], v[216:219]
    ds_read_b64_tr_b16 v[24:25], v4 offset:0
    ds_read_b64_tr_b16 v[26:27], v4 offset:4096
    v_exp_f32 v200, v200
    v_mfma_f32_16x16x32_bf16 v[192:195], v[152:155], v[136:139], v[220:223]
    ds_read_b64_tr_b16 v[28:29], v5 offset:0
    v_exp_f32 v201, v201
    v_mfma_f32_16x16x32_bf16 v[188:191], v[156:159], v[120:123], v[216:219]
    ds_read_b64_tr_b16 v[30:31], v5 offset:4096
    v_exp_f32 v202, v202
    v_mfma_f32_16x16x32_bf16 v[196:199], v[156:159], v[136:139], v[220:223]
    ds_read_b64_tr_b16 v[32:33], v6 offset:0
    ds_read_b64_tr_b16 v[34:35], v6 offset:4096
    v_exp_f32 v203, v203
    v_mfma_f32_16x16x32_bf16 v[184:187], v[160:163], v[124:127], v[184:187]
    ds_read_b64_tr_b16 v[36:37], v7 offset:0
    v_exp_f32 v204, v204
    v_cvt_pk_bf16_f32 v232, v200, v201
    v_mfma_f32_16x16x32_bf16 v[192:195], v[160:163], v[140:143], v[192:195]
    ds_read_b64_tr_b16 v[38:39], v7 offset:4096
    v_exp_f32 v205, v205
    v_mfma_f32_16x16x32_bf16 v[188:191], v[164:167], v[124:127], v[188:191]
    ds_read_b64_tr_b16 v[40:41], v8 offset:0
    ds_read_b64_tr_b16 v[42:43], v8 offset:4096
    v_exp_f32 v206, v206
    v_mfma_f32_16x16x32_bf16 v[196:199], v[164:167], v[140:143], v[196:199]
    ds_read_b64_tr_b16 v[44:45], v9 offset:0
    v_exp_f32 v207, v207
    v_cvt_pk_bf16_f32 v233, v202, v203
    v_mfma_f32_16x16x32_bf16 v[184:187], v[168:171], v[128:131], v[184:187]
    ds_read_b64_tr_b16 v[46:47], v9 offset:4096
    v_exp_f32 v208, v208
    v_mfma_f32_16x16x32_bf16 v[192:195], v[168:171], v[144:147], v[192:195]
    ds_read_b64_tr_b16 v[48:49], v10 offset:0
    ds_read_b64_tr_b16 v[50:51], v10 offset:4096
    v_exp_f32 v209, v209
    v_mfma_f32_16x16x32_bf16 v[188:191], v[172:175], v[128:131], v[188:191]
    ds_read_b64_tr_b16 v[52:53], v11 offset:0
    v_exp_f32 v210, v210
    v_cvt_pk_bf16_f32 v234, v204, v205
    v_mfma_f32_16x16x32_bf16 v[196:199], v[172:175], v[144:147], v[196:199]
    ds_read_b64_tr_b16 v[54:55], v11 offset:4096
    v_exp_f32 v211, v211
    v_mfma_f32_16x16x32_bf16 v[184:187], v[176:179], v[132:135], v[184:187]
    v_exp_f32 v212, v212
    v_mfma_f32_16x16x32_bf16 v[192:195], v[176:179], v[148:151], v[192:195]
    v_exp_f32 v213, v213
    v_cvt_pk_bf16_f32 v235, v206, v207
    v_mfma_f32_16x16x32_bf16 v[188:191], v[180:183], v[132:135], v[188:191]
    v_exp_f32 v214, v214
    v_mfma_f32_16x16x32_bf16 v[196:199], v[180:183], v[148:151], v[196:199]
    v_exp_f32 v215, v215
    s_waitcnt lgkmcnt(14)
    v_mfma_f32_16x16x32_bf16 v[56:59], v[24:27], v[232:235], v[56:59]
    ds_read_b128 v[152:155], v0 offset:8192
    v_add_f32 v16, v16, v200
    s_waitcnt lgkmcnt(13)
    v_mfma_f32_16x16x32_bf16 v[60:63], v[28:31], v[232:235], v[60:63]
    ds_read_b128 v[156:159], v0 offset:12288
    v_add_f32 v16, v16, v201
    v_cvt_pk_bf16_f32 v236, v208, v209
    s_waitcnt lgkmcnt(12)
    v_mfma_f32_16x16x32_bf16 v[64:67], v[32:35], v[232:235], v[64:67]
    ds_read_b128 v[160:163], v1 offset:8192
    v_add_f32 v16, v16, v202
    v_cvt_pk_bf16_f32 v237, v210, v211
    s_waitcnt lgkmcnt(11)
    v_mfma_f32_16x16x32_bf16 v[68:71], v[36:39], v[232:235], v[68:71]
    ds_read_b128 v[164:167], v1 offset:12288
    v_add_f32 v16, v16, v203
    v_cvt_pk_bf16_f32 v238, v212, v213
    s_waitcnt lgkmcnt(10)
    v_mfma_f32_16x16x32_bf16 v[72:75], v[40:43], v[232:235], v[72:75]
    ds_read_b128 v[168:171], v2 offset:8192
    v_add_f32 v16, v16, v204
    v_cvt_pk_bf16_f32 v239, v214, v215
    s_waitcnt lgkmcnt(9)
    v_mfma_f32_16x16x32_bf16 v[76:79], v[44:47], v[232:235], v[76:79]
    ds_read_b128 v[172:175], v2 offset:12288
    v_add_f32 v16, v16, v205
    s_waitcnt lgkmcnt(8)
    v_mfma_f32_16x16x32_bf16 v[80:83], v[48:51], v[232:235], v[80:83]
    ds_read_b128 v[176:179], v3 offset:8192
    v_add_f32 v16, v16, v206
    s_waitcnt lgkmcnt(7)
    v_mfma_f32_16x16x32_bf16 v[84:87], v[52:55], v[232:235], v[84:87]
    ds_read_b128 v[180:183], v3 offset:12288
    v_add_f32 v16, v16, v207
    v_mfma_f32_16x16x32_bf16 v[88:91], v[24:27], v[236:239], v[88:91]
    s_add_u32 m0, s56, 32768
    s_nop 0
    buffer_load_dwordx4 v14, s[36:39], s58 offen nt lds
    v_max3_f32 v18, v184, v185, v186
    v_add_f32 v17, v17, v208
    v_mfma_f32_16x16x32_bf16 v[92:95], v[28:31], v[236:239], v[92:95]
    v_max3_f32 v18, v18, v187, v188
    v_add_f32 v17, v17, v209
    v_mfma_f32_16x16x32_bf16 v[96:99], v[32:35], v[236:239], v[96:99]
    buffer_load_dwordx4 v15, s[36:39], s58 offen offset:1024 nt lds
    s_add_u32 s58, s58, 8192
    v_max3_f32 v18, v18, v189, v190
    v_add_f32 v17, v17, v210
    v_mfma_f32_16x16x32_bf16 v[100:103], v[36:39], v[236:239], v[100:103]
    v_max3_f32 v18, v18, v191, v192
    v_add_f32 v17, v17, v211
    v_mfma_f32_16x16x32_bf16 v[104:107], v[40:43], v[236:239], v[104:107]
    s_add_u32 m0, s56, 40960
    s_nop 0
    buffer_load_dwordx4 v12, s[32:35], s57 offen nt lds
    v_max3_f32 v18, v18, v193, v194
    v_add_f32 v17, v17, v212
    v_mfma_f32_16x16x32_bf16 v[108:111], v[44:47], v[236:239], v[108:111]
    v_max3_f32 v18, v18, v195, v196
    v_add_f32 v17, v17, v213
    v_mfma_f32_16x16x32_bf16 v[112:115], v[48:51], v[236:239], v[112:115]
    buffer_load_dwordx4 v13, s[32:35], s57 offen offset:1024 nt lds
    s_add_u32 s57, s57, 8192
    v_max3_f32 v18, v18, v197, v198
    v_add_f32 v17, v17, v214
    v_mfma_f32_16x16x32_bf16 v[116:119], v[52:55], v[236:239], v[116:119]
    v_max_f32 v18, v18, v199
    v_add_f32 v17, v17, v215
    v_cmp_lt_f32 vcc, s61, v18
    s_cbranch_vccnz L_rare3
L_back3:
    s_sub_u32 s59, s59, 1
    s_branch L_loop
L_last:
    s_waitcnt vmcnt(4) lgkmcnt(0)
    s_barrier
    ds_read_b64_tr_b16 v[24:25], v4 offset:0
    ds_read_b64_tr_b16 v[26:27], v4 offset:4096
    ds_read_b64_tr_b16 v[28:29], v5 offset:0
    ds_read_b64_tr_b16 v[30:31], v5 offset:4096
    ds_read_b64_tr_b16 v[32:33], v6 offset:0
    ds_read_b64_tr_b16 v[34:35], v6 offset:4096
    ds_read_b64_tr_b16 v[36:37], v7 offset:0
    ds_read_b64_tr_b16 v[38:39], v7 offset:4096
    ds_read_b64_tr_b16 v[40:41], v8 offset:0
    ds_read_b64_tr_b16 v[42:43], v8 offset:4096
    ds_read_b64_tr_b16 v[44:45], v9 offset:0
    ds_read_b64_tr_b16 v[46:47], v9 offset:4096
    ds_read_b64_tr_b16 v[48:49], v10 offset:0
    ds_read_b64_tr_b16 v[50:51], v10 offset:4096
    ds_read_b64_tr_b16 v[52:53], v11 offset:0
    ds_read_b64_tr_b16 v[54:55], v11 offset:4096
    s_cmp_lg_u32 s96, 0
    s_cbranch_scc1 L_nodma
    s_add_u32 m0, s56, 32768
    s_nop 0
    buffer_load_dwordx4 v14, s[36:39], s58 offen nt lds
    buffer_load_dwordx4 v15, s[36:39], s58 offen offset:1024 nt lds
    s_add_u32 s58, s58, 8192
    s_add_u32 m0, s56, 40960
    s_nop 0
    buffer_load_dwordx4 v12, s[32:35], s57 offen nt lds
    buffer_load_dwordx4 v13, s[32:35], s57 offen offset:1024 nt lds
    s_add_u32 s57, s57, 8192
L_nodma:
    v_exp_f32 v200, v200
    v_exp_f32 v201, v201
    v_exp_f32 v202, v202
    v_exp_f32 v203, v203
    v_exp_f32 v204, v204
    v_exp_f32 v205, v205
    v_exp_f32 v206, v206
    v_exp_f32 v207, v207
    v_exp_f32 v208, v208
    v_exp_f32 v209, v209
    v_exp_f32 v210, v210
    v_exp_f32 v211, v211
    v_exp_f32 v212, v212
    v_exp_f32 v213, v213
    v_exp_f32 v214, v214
    v_exp_f32 v215, v215
    s_nop 0
    v_cvt_pk_bf16_f32 v232, v200, v201
    v_cvt_pk_bf16_f32 v233, v202, v203
    v_cvt_pk_bf16_f32 v234, v204, v205
    v_cvt_pk_bf16_f32 v235, v206, v207
    v_cvt_pk_bf16_f32 v236, v208, v209
    v_cvt_pk_bf16_f32 v237, v210, v211
    v_cvt_pk_bf16_f32 v238, v212, v213
    v_cvt_pk_bf16_f32 v239, v214, v215
    s_nop 1
    s_waitcnt lgkmcnt(14)
    v_mfma_f32_16x16x32_bf16 v[56:59], v[24:27], v[232:235], v[56:59]
    v_add_f32 v16, v16, v200
    s_waitcnt lgkmcnt(12)
    v_mfma_f32_16x16x32_bf16 v[60:63], v[28:31], v[232:235], v[60:63]
    v_add_f32 v16, v16, v201
    s_waitcnt lgkmcnt(10)
    v_mfma_f32_16x16x32_bf16 v[64:67], v[32:35], v[232:235], v[64:67]
    v_add_f32 v16, v16, v202
    s_waitcnt lgkmcnt(8)
    v_mfma_f32_16x16x32_bf16 v[68:71], v[36:39], v[232:235], v[68:71]
    v_add_f32 v16, v16, v203
    s_waitcnt lgkmcnt(6)
    v_mfma_f32_16x16x32_bf16 v[72:75], v[40:43], v[232:235], v[72:75]
    v_add_f32 v16, v16, v204
    s_waitcnt lgkmcnt(4)
    v_mfma_f32_16x16x32_bf16 v[76:79], v[44:47], v[232:235], v[76:79]
    v_add_f32 v16, v16, v205
    s_waitcnt lgkmcnt(2)
    v_mfma_f32_16x16x32_bf16 v[80:83], v[48:51], v[232:235], v[80:83]
    v_add_f32 v16, v16, v206
    s_waitcnt lgkmcnt(0)
    v_mfma_f32_16x16x32_bf16 v[84:87], v[52:55], v[232:235], v[84:87]
    v_add_f32 v16, v16, v207
    v_mfma_f32_16x16x32_bf16 v[88:91], v[24:27], v[236:239], v[88:91]
    v_add_f32 v17, v17, v208
    v_mfma_f32_16x16x32_bf16 v[92:95], v[28:31], v[236:239], v[92:95]
    v_add_f32 v17, v17, v209
    v_mfma_f32_16x16x32_bf16 v[96:99], v[32:35], v[236:239], v[96:99]
    v_add_f32 v17, v17, v210
    v_mfma_f32_16x16x32_bf16 v[100:103], v[36:39], v[236:239], v[100:103]
    v_add_f32 v17, v17, v211
    v_mfma_f32_16x16x32_bf16 v[104:107], v[40:43], v[236:239], v[104:107]
    v_add_f32 v17, v17, v212
    v_mfma_f32_16x16x32_bf16 v[108:111], v[44:47], v[236:239], v[108:111]
    v_add_f32 v17, v17, v213
    v_mfma_f32_16x16x32_bf16 v[112:115], v[48:51], v[236:239], v[112:115]
    v_add_f32 v17, v17, v214
    v_mfma_f32_16x16x32_bf16 v[116:119], v[52:55], v[236:239], v[116:119]
    v_add_f32 v17, v17, v215
    s_cmp_lg_u32 s96, 0
    s_cbranch_scc1 L_g1fin
    s_setprio 0
    s_waitcnt vmcnt(4) lgkmcnt(0)
    s_barrier
    s_mov_b32 s40, s26
    s_mov_b32 s41, s27
    s_mov_b32 s42, 256
    s_mov_b32 s43, 0x20000
    v_mov_b32 v19, v16
    s_nop 1
    v_permlane32_swap_b32 v19, v16
    s_nop 1
    v_add_f32 v16, v16, v19
    v_mov_b32 v19, v16
    s_nop 1
    v_permlane16_swap_b32 v19, v16
    s_nop 1
    v_add_f32 v16, v16, v19
    v_mov_b32 v19, v17
    s_nop 1
    v_permlane32_swap_b32 v19, v17
    s_nop 1
    v_add_f32 v17, v17, v19
    v_mov_b32 v19, v17
    s_nop 1
    v_permlane16_swap_b32 v19, v17
    s_nop 1
    v_add_f32 v17, v17, v19
    v_rcp_f32 v16, v16
    v_rcp_f32 v17, v17
    s_nop 0
    v_mul_f32 v56, v56, v16
    v_mul_f32 v57, v57, v16
    v_mul_f32 v58, v58, v16
    v_mul_f32 v59, v59, v16
    v_mul_f32 v60, v60, v16
    v_mul_f32 v61, v61, v16
    v_mul_f32 v62, v62, v16
    v_mul_f32 v63, v63, v16
    v_cvt_pk_bf16_f32 v120, v56, v57
    v_cvt_pk_bf16_f32 v121, v58, v59
    v_cvt_pk_bf16_f32 v122, v60, v61
    v_cvt_pk_bf16_f32 v123, v62, v63
    v_mul_f32 v88, v88, v17
    v_mul_f32 v89, v89, v17
    v_mul_f32 v90, v90, v17
    v_mul_f32 v91, v91, v17
    v_mul_f32 v92, v92, v17
    v_mul_f32 v93, v93, v17
    v_mul_f32 v94, v94, v17
    v_mul_f32 v95, v95, v17
    v_cvt_pk_bf16_f32 v124, v88, v89
    v_cvt_pk_bf16_f32 v125, v90, v91
    v_cvt_pk_bf16_f32 v126, v92, v93
    v_cvt_pk_bf16_f32 v127, v94, v95
    v_mul_f32 v64, v64, v16
    v_mul_f32 v65, v65, v16
    v_mul_f32 v66, v66, v16
    v_mul_f32 v67, v67, v16
    v_mul_f32 v68, v68, v16
    v_mul_f32 v69, v69, v16
    v_mul_f32 v70, v70, v16
    v_mul_f32 v71, v71, v16
    v_cvt_pk_bf16_f32 v128, v64, v65
    v_cvt_pk_bf16_f32 v129, v66, v67
    v_cvt_pk_bf16_f32 v130, v68, v69
    v_cvt_pk_bf16_f32 v131, v70, v71
    v_mul_f32 v96, v96, v17
    v_mul_f32 v97, v97, v17
    v_mul_f32 v98, v98, v17
    v_mul_f32 v99, v99, v17
    v_mul_f32 v100, v100, v17
    v_mul_f32 v101, v101, v17
    v_mul_f32 v102, v102, v17
    v_mul_f32 v103, v103, v17
    v_cvt_pk_bf16_f32 v132, v96, v97
    v_cvt_pk_bf16_f32 v133, v98, v99
    v_cvt_pk_bf16_f32 v134, v100, v101
    v_cvt_pk_bf16_f32 v135, v102, v103
    v_mul_f32 v72, v72, v16
    v_mul_f32 v73, v73, v16
    v_mul_f32 v74, v74, v16
    v_mul_f32 v75, v75, v16
    v_mul_f32 v76, v76, v16
    v_mul_f32 v77, v77, v16
    v_mul_f32 v78, v78, v16
    v_mul_f32 v79, v79, v16
    v_cvt_pk_bf16_f32 v136, v72, v73
    v_cvt_pk_bf16_f32 v137, v74, v75
    v_cvt_pk_bf16_f32 v138, v76, v77
    v_cvt_pk_bf16_f32 v139, v78, v79
    v_mul_f32 v104, v104, v17
    v_mul_f32 v105, v105, v17
    v_mul_f32 v106, v106, v17
    v_mul_f32 v107, v107, v17
    v_mul_f32 v108, v108, v17
    v_mul_f32 v109, v109, v17
    v_mul_f32 v110, v110, v17
    v_mul_f32 v111, v111, v17
    v_cvt_pk_bf16_f32 v140, v104, v105
    v_cvt_pk_bf16_f32 v141, v106, v107
    v_cvt_pk_bf16_f32 v142, v108, v109
    v_cvt_pk_bf16_f32 v143, v110, v111
    v_mul_f32 v80, v80, v16
    v_mul_f32 v81, v81, v16
    v_mul_f32 v82, v82, v16
    v_mul_f32 v83, v83, v16
    v_mul_f32 v84, v84, v16
    v_mul_f32 v85, v85, v16
    v_mul_f32 v86, v86, v16
    v_mul_f32 v87, v87, v16
    v_cvt_pk_bf16_f32 v144, v80, v81
    v_cvt_pk_bf16_f32 v145, v82, v83
    v_cvt_pk_bf16_f32 v146, v84, v85
    v_cvt_pk_bf16_f32 v147, v86, v87
    v_mul_f32 v112, v112, v17
    v_mul_f32 v113, v113, v17
    v_mul_f32 v114, v114, v17
    v_mul_f32 v115, v115, v17
    v_mul_f32 v116, v116, v17
    v_mul_f32 v117, v117, v17
    v_mul_f32 v118, v118, v17
    v_mul_f32 v119, v119, v17
    v_cvt_pk_bf16_f32 v148, v112, v113
    v_cvt_pk_bf16_f32 v149, v114, v115
    v_cvt_pk_bf16_f32 v150, v116, v117
    v_cvt_pk_bf16_f32 v151, v118, v119
    s_lshl_b32 s60, s98, 8
    s_add_u32 s8, s12, s60
    s_addc_u32 s9, s13, 0
    s_mov_b32 s10, 0
    s_mov_b32 s11, 0x20000
    s_sub_u32 s10, 4194304, s60
    v_lshrrev_b32 v248, 4, v22
    v_mul_u32_u24 v248, 768, v248
    v_add_u32 v248, v14, v248
    s_lshl_b32 s60, s52, 13
    v_add_u32 v248, s60, v248
    v_xor_b32 v249, 0x80, v248
    s_lshl_b32 s60, s97, 6
    v_xor_b32 v4, s60, v4
    v_xor_b32 v5, s60, v5
    v_xor_b32 v6, s60, v6
    v_xor_b32 v7, s60, v7
    v_xor_b32 v8, s60, v8
    v_xor_b32 v9, s60, v9
    v_xor_b32 v10, s60, v10
    v_xor_b32 v11, s60, v11
    v_and_b32 v12, 3, v22
    v_lshlrev_b32 v12, 7, v12
    s_mul_i32 s60, s98, 8192
    s_sub_u32 s32, s48, s60
    s_subb_u32 s33, s49, 0
    s_mov_b32 s34, 32768
    s_mov_b32 s35, 0x20000
    s_waitcnt vmcnt(0) lgkmcnt(0)
    s_barrier
    s_add_u32 s3, s98, 2
    s_and_b32 s3, s3, 3
    s_lshl_b32 s3, s3, 1
    s_lshl_b32 s63, s97, 3
    s_add_u32 s3, s3, s63
    s_lshl_b32 s3, s3, 17
    s_add_u32 m0, s56, 65536
    s_add_u32 s60, s3, 0
    buffer_load_dwordx4 v248, s[8:11], s60 offen lds
    s_add_u32 m0, s56, 66560
    s_add_u32 s60, s3, 4096
    buffer_load_dwordx4 v249, s[8:11], s60 offen lds
    s_waitcnt lgkmcnt(0)
    s_barrier
    v_add_u32 v4, 0x10000, v4
    v_add_u32 v5, 0x10000, v5
    v_add_u32 v6, 0x10000, v6
    v_add_u32 v7, 0x10000, v7
    v_add_u32 v8, 0x10000, v8
    v_add_u32 v9, 0x10000, v9
    v_add_u32 v10, 0x10000, v10
    v_add_u32 v11, 0x10000, v11
    ds_read_b64_tr_b16 v[24:25], v4 offset:32768
    ds_read_b64_tr_b16 v[26:27], v4 offset:36864
    ds_read_b64_tr_b16 v[28:29], v5 offset:32768
    ds_read_b64_tr_b16 v[30:31], v5 offset:36864
    ds_read_b64_tr_b16 v[32:33], v6 offset:32768
    ds_read_b64_tr_b16 v[34:35], v6 offset:36864
    ds_read_b64_tr_b16 v[36:37], v7 offset:32768
    ds_read_b64_tr_b16 v[38:39], v7 offset:36864
    ds_read_b64_tr_b16 v[40:41], v8 offset:32768
    ds_read_b64_tr_b16 v[42:43], v8 offset:36864
    ds_read_b64_tr_b16 v[44:45], v9 offset:32768
    ds_read_b64_tr_b16 v[46:47], v9 offset:36864
    ds_read_b64_tr_b16 v[48:49], v10 offset:32768
    ds_read_b64_tr_b16 v[50:51], v10 offset:36864
    ds_read_b64_tr_b16 v[52:53], v11 offset:32768
    ds_read_b64_tr_b16 v[54:55], v11 offset:36864
    s_waitcnt lgkmcnt(14)
    v_mfma_f32_16x16x32_bf16 v[56:59], v[24:27], v[120:123], 0
    s_waitcnt lgkmcnt(12)
    v_mfma_f32_16x16x32_bf16 v[60:63], v[28:31], v[120:123], 0
    s_waitcnt lgkmcnt(10)
    v_mfma_f32_16x16x32_bf16 v[64:67], v[32:35], v[120:123], 0
    s_waitcnt lgkmcnt(8)
    v_mfma_f32_16x16x32_bf16 v[68:71], v[36:39], v[120:123], 0
    s_waitcnt lgkmcnt(6)
    v_mfma_f32_16x16x32_bf16 v[72:75], v[40:43], v[120:123], 0
    s_waitcnt lgkmcnt(4)
    v_mfma_f32_16x16x32_bf16 v[76:79], v[44:47], v[120:123], 0
    s_waitcnt lgkmcnt(2)
    v_mfma_f32_16x16x32_bf16 v[80:83], v[48:51], v[120:123], 0
    s_waitcnt lgkmcnt(0)
    v_mfma_f32_16x16x32_bf16 v[84:87], v[52:55], v[120:123], 0
    s_waitcnt lgkmcnt(0)
    s_barrier
    s_add_u32 s3, s98, 0
    s_and_b32 s3, s3, 3
    s_lshl_b32 s3, s3, 1
    s_lshl_b32 s63, s97, 3
    s_add_u32 s3, s3, s63
    s_add_u32 s3, s3, 1
    s_lshl_b32 s3, s3, 17
    s_add_u32 m0, s56, 98304
    s_add_u32 s60, s3, 0
    buffer_load_dwordx4 v248, s[8:11], s60 offen lds
    s_add_u32 m0, s56, 99328
    s_add_u32 s60, s3, 4096
    buffer_load_dwordx4 v249, s[8:11], s60 offen lds
    s_waitcnt lgkmcnt(0)
    s_barrier
    buffer_load_dword v250, v254, s[40:43], 0 offen sc1
    v_and_b32 v18, 3, v22
    v_lshlrev_b32 v18, 7, v18
    buffer_load_dwordx2 v[20:21], v18, s[16:19], s7 offen sc1
    v_mfma_f32_16x16x32_bf16 v[88:91], v[24:27], v[124:127], 0
    v_mfma_f32_16x16x32_bf16 v[92:95], v[28:31], v[124:127], 0
    v_mfma_f32_16x16x32_bf16 v[96:99], v[32:35], v[124:127], 0
    v_mfma_f32_16x16x32_bf16 v[100:103], v[36:39], v[124:127], 0
    v_mfma_f32_16x16x32_bf16 v[104:107], v[40:43], v[124:127], 0
    v_mfma_f32_16x16x32_bf16 v[108:111], v[44:47], v[124:127], 0
    v_mfma_f32_16x16x32_bf16 v[112:115], v[48:51], v[124:127], 0
    v_mfma_f32_16x16x32_bf16 v[116:119], v[52:55], v[124:127], 0
    s_waitcnt lgkmcnt(0)
    s_barrier
    s_add_u32 s3, s98, 2
    s_and_b32 s3, s3, 3
    s_lshl_b32 s3, s3, 1
    s_lshl_b32 s63, s97, 3
    s_add_u32 s3, s3, s63
    s_lshl_b32 s3, s3, 17
    s_add_u32 m0, s56, 73728
    s_add_u32 s60, s3, 32768
    buffer_load_dwordx4 v248, s[8:11], s60 offen lds
    s_add_u32 m0, s56, 74752
    s_add_u32 s60, s3, 36864
    buffer_load_dwordx4 v249, s[8:11], s60 offen lds
    s_waitcnt lgkmcnt(0)
    s_barrier
    ds_read_b64_tr_b16 v[24:25], v4 offset:40960
    ds_read_b64_tr_b16 v[26:27], v4 offset:45056
    ds_read_b64_tr_b16 v[28:29], v5 offset:40960
    ds_read_b64_tr_b16 v[30:31], v5 offset:45056
    ds_read_b64_tr_b16 v[32:33], v6 offset:40960
    ds_read_b64_tr_b16 v[34:35], v6 offset:45056
    ds_read_b64_tr_b16 v[36:37], v7 offset:40960
    ds_read_b64_tr_b16 v[38:39], v7 offset:45056
    ds_read_b64_tr_b16 v[40:41], v8 offset:40960
    ds_read_b64_tr_b16 v[42:43], v8 offset:45056
    ds_read_b64_tr_b16 v[44:45], v9 offset:40960
    ds_read_b64_tr_b16 v[46:47], v9 offset:45056
    ds_read_b64_tr_b16 v[48:49], v10 offset:40960
    ds_read_b64_tr_b16 v[50:51], v10 offset:45056
    ds_read_b64_tr_b16 v[52:53], v11 offset:40960
    ds_read_b64_tr_b16 v[54:55], v11 offset:45056
    s_waitcnt lgkmcnt(14)
    v_mfma_f32_16x16x32_bf16 v[56:59], v[24:27], v[128:131], v[56:59]
    s_waitcnt lgkmcnt(12)
    v_mfma_f32_16x16x32_bf16 v[60:63], v[28:31], v[128:131], v[60:63]
    s_waitcnt lgkmcnt(10)
    v_mfma_f32_16x16x32_bf16 v[64:67], v[32:35], v[128:131], v[64:67]
    s_waitcnt lgkmcnt(8)
    v_mfma_f32_16x16x32_bf16 v[68:71], v[36:39], v[128:131], v[68:71]
    s_waitcnt lgkmcnt(6)
    v_mfma_f32_16x16x32_bf16 v[72:75], v[40:43], v[128:131], v[72:75]
    s_waitcnt lgkmcnt(4)
    v_mfma_f32_16x16x32_bf16 v[76:79], v[44:47], v[128:131], v[76:79]
    s_waitcnt lgkmcnt(2)
    v_mfma_f32_16x16x32_bf16 v[80:83], v[48:51], v[128:131], v[80:83]
    s_waitcnt lgkmcnt(0)
    v_mfma_f32_16x16x32_bf16 v[84:87], v[52:55], v[128:131], v[84:87]
    s_waitcnt lgkmcnt(0)
    s_barrier
    s_add_u32 s3, s98, 0
    s_and_b32 s3, s3, 3
    s_lshl_b32 s3, s3, 1
    s_lshl_b32 s63, s97, 3
    s_add_u32 s3, s3, s63
    s_add_u32 s3, s3, 1
    s_lshl_b32 s3, s3, 17
    s_add_u32 m0, s56, 106496
    s_add_u32 s60, s3, 32768
    buffer_load_dwordx4 v248, s[8:11], s60 offen lds
    s_add_u32 m0, s56, 107520
    s_add_u32 s60, s3, 36864
    buffer_load_dwordx4 v249, s[8:11], s60 offen lds
    s_waitcnt vmcnt(4) lgkmcnt(0)
    s_barrier
    v_readfirstlane_b32 s99, v250
    s_nop 0
    s_cmp_lg_u32 s99, 0
    s_cbranch_scc1 L_havenonceh
    s_mov_b32 s60, 557056
    buffer_load_dword v252, v254, s[16:19], s60 offen sc1
    s_waitcnt vmcnt(0)
    v_readfirstlane_b32 s99, v252
    s_nop 0
    s_add_u32 s99, s99, 1
    s_max_u32 s99, s99, 1
    v_mov_b32 v252, s99
    v_mov_b32 v253, 0
    s_mov_b64 exec, 1
    buffer_atomic_cmpswap v[252:253], v254, s[40:43], 0 offen sc0 sc1
    s_mov_b64 exec, -1
    s_waitcnt vmcnt(0)
    v_readfirstlane_b32 s63, v252
    s_nop 0
    s_cmp_eq_u32 s63, 0
    s_cbranch_scc0 L_losth
    v_mov_b32 v252, s99
    s_mov_b32 s60, 557056
    s_mov_b64 exec, 1
    buffer_store_dword v252, v254, s[16:19], s60 offen sc1
    s_mov_b64 exec, -1
    s_branch L_goth
L_losth:
    s_mov_b32 s99, s63
L_goth:
L_havenonceh:
    s_xor_b32 s100, s99, 1540483477
    v_mov_b32 v252, s99
    v_mov_b32 v253, s100
    s_getreg_b32 s63, hwreg(HW_REG_XCC_ID, 0, 4)
    s_add_u32 s63, s63, s100
    v_cmp_ne_u32 vcc, s99, v20
    v_cmp_ne_u32 s[4:5], s63, v21
    s_or_b64 vcc, vcc, s[4:5]
    s_cselect_b32 s6, 0, 1
    v_mfma_f32_16x16x32_bf16 v[88:91], v[24:27], v[132:135], v[88:91]
    v_mfma_f32_16x16x32_bf16 v[92:95], v[28:31], v[132:135], v[92:95]
    v_mfma_f32_16x16x32_bf16 v[96:99], v[32:35], v[132:135], v[96:99]
    v_mfma_f32_16x16x32_bf16 v[100:103], v[36:39], v[132:135], v[100:103]
    v_mfma_f32_16x16x32_bf16 v[104:107], v[40:43], v[132:135], v[104:107]
    v_mfma_f32_16x16x32_bf16 v[108:111], v[44:47], v[132:135], v[108:111]
    v_mfma_f32_16x16x32_bf16 v[112:115], v[48:51], v[132:135], v[112:115]
    v_mfma_f32_16x16x32_bf16 v[116:119], v[52:55], v[132:135], v[116:119]
    s_waitcnt lgkmcnt(0)
    s_barrier
    s_add_u32 s3, s98, 2
    s_and_b32 s3, s3, 3
    s_lshl_b32 s3, s3, 1
    s_lshl_b32 s63, s97, 3
    s_add_u32 s3, s3, s63
    s_lshl_b32 s3, s3, 17
    s_add_u32 m0, s56, 81920
    s_add_u32 s60, s3, 65536
    buffer_load_dwordx4 v248, s[8:11], s60 offen lds
    s_add_u32 m0, s56, 82944
    s_add_u32 s60, s3, 69632
    buffer_load_dwordx4 v249, s[8:11], s60 offen lds
    s_waitcnt lgkmcnt(0)
    s_barrier
    ds_read_b64_tr_b16 v[24:25], v4 offset:49152
    ds_read_b64_tr_b16 v[26:27], v4 offset:53248
    ds_read_b64_tr_b16 v[28:29], v5 offset:49152
    ds_read_b64_tr_b16 v[30:31], v5 offset:53248
    ds_read_b64_tr_b16 v[32:33], v6 offset:49152
    ds_read_b64_tr_b16 v[34:35], v6 offset:53248
    ds_read_b64_tr_b16 v[36:37], v7 offset:49152
    ds_read_b64_tr_b16 v[38:39], v7 offset:53248
    ds_read_b64_tr_b16 v[40:41], v8 offset:49152
    ds_read_b64_tr_b16 v[42:43], v8 offset:53248
    ds_read_b64_tr_b16 v[44:45], v9 offset:49152
    ds_read_b64_tr_b16 v[46:47], v9 offset:53248
    ds_read_b64_tr_b16 v[48:49], v10 offset:49152
    ds_read_b64_tr_b16 v[50:51], v10 offset:53248
    ds_read_b64_tr_b16 v[52:53], v11 offset:49152
    ds_read_b64_tr_b16 v[54:55], v11 offset:53248
    s_waitcnt lgkmcnt(14)
    v_mfma_f32_16x16x32_bf16 v[56:59], v[24:27], v[136:139], v[56:59]
    s_waitcnt lgkmcnt(12)
    v_mfma_f32_16x16x32_bf16 v[60:63], v[28:31], v[136:139], v[60:63]
    s_waitcnt lgkmcnt(10)
    v_mfma_f32_16x16x32_bf16 v[64:67], v[32:35], v[136:139], v[64:67]
    s_waitcnt lgkmcnt(8)
    v_mfma_f32_16x16x32_bf16 v[68:71], v[36:39], v[136:139], v[68:71]
    s_waitcnt lgkmcnt(6)
    v_mfma_f32_16x16x32_bf16 v[72:75], v[40:43], v[136:139], v[72:75]
    s_waitcnt lgkmcnt(4)
    v_mfma_f32_16x16x32_bf16 v[76:79], v[44:47], v[136:139], v[76:79]
    s_waitcnt lgkmcnt(2)
    v_mfma_f32_16x16x32_bf16 v[80:83], v[48:51], v[136:139], v[80:83]
    s_waitcnt lgkmcnt(0)
    v_mfma_f32_16x16x32_bf16 v[84:87], v[52:55], v[136:139], v[84:87]
    s_waitcnt lgkmcnt(0)
    s_barrier
    s_add_u32 s3, s98, 0
    s_and_b32 s3, s3, 3
    s_lshl_b32 s3, s3, 1
    s_lshl_b32 s63, s97, 3
    s_add_u32 s3, s3, s63
    s_add_u32 s3, s3, 1
    s_lshl_b32 s3, s3, 17
    s_add_u32 m0, s56, 114688
    s_add_u32 s60, s3, 65536
    buffer_load_dwordx4 v248, s[8:11], s60 offen lds
    s_add_u32 m0, s56, 115712
    s_add_u32 s60, s3, 69632
    buffer_load_dwordx4 v249, s[8:11], s60 offen lds
    s_waitcnt lgkmcnt(0)
    s_barrier
    v_mfma_f32_16x16x32_bf16 v[88:91], v[24:27], v[140:143], v[88:91]
    v_mfma_f32_16x16x32_bf16 v[92:95], v[28:31], v[140:143], v[92:95]
    v_mfma_f32_16x16x32_bf16 v[96:99], v[32:35], v[140:143], v[96:99]
    v_mfma_f32_16x16x32_bf16 v[100:103], v[36:39], v[140:143], v[100:103]
    v_mfma_f32_16x16x32_bf16 v[104:107], v[40:43], v[140:143], v[104:107]
    v_mfma_f32_16x16x32_bf16 v[108:111], v[44:47], v[140:143], v[108:111]
    v_mfma_f32_16x16x32_bf16 v[112:115], v[48:51], v[140:143], v[112:115]
    v_mfma_f32_16x16x32_bf16 v[116:119], v[52:55], v[140:143], v[116:119]
    s_waitcnt lgkmcnt(0)
    s_barrier
    s_add_u32 s3, s98, 2
    s_and_b32 s3, s3, 3
    s_lshl_b32 s3, s3, 1
    s_lshl_b32 s63, s97, 3
    s_add_u32 s3, s3, s63
    s_lshl_b32 s3, s3, 17
    s_add_u32 m0, s56, 90112
    s_add_u32 s60, s3, 98304
    buffer_load_dwordx4 v248, s[8:11], s60 offen lds
    s_add_u32 m0, s56, 91136
    s_add_u32 s60, s3, 102400
    buffer_load_dwordx4 v249, s[8:11], s60 offen lds
    s_waitcnt lgkmcnt(0)
    s_barrier
    ds_read_b64_tr_b16 v[24:25], v4 offset:57344
    ds_read_b64_tr_b16 v[26:27], v4 offset:61440
    ds_read_b64_tr_b16 v[28:29], v5 offset:57344
    ds_read_b64_tr_b16 v[30:31], v5 offset:61440
    ds_read_b64_tr_b16 v[32:33], v6 offset:57344
    ds_read_b64_tr_b16 v[34:35], v6 offset:61440
    ds_read_b64_tr_b16 v[36:37], v7 offset:57344
    ds_read_b64_tr_b16 v[38:39], v7 offset:61440
    ds_read_b64_tr_b16 v[40:41], v8 offset:57344
    ds_read_b64_tr_b16 v[42:43], v8 offset:61440
    ds_read_b64_tr_b16 v[44:45], v9 offset:57344
    ds_read_b64_tr_b16 v[46:47], v9 offset:61440
    ds_read_b64_tr_b16 v[48:49], v10 offset:57344
    ds_read_b64_tr_b16 v[50:51], v10 offset:61440
    ds_read_b64_tr_b16 v[52:53], v11 offset:57344
    ds_read_b64_tr_b16 v[54:55], v11 offset:61440
    s_waitcnt lgkmcnt(14)
    v_mfma_f32_16x16x32_bf16 v[56:59], v[24:27], v[144:147], v[56:59]
    s_waitcnt lgkmcnt(12)
    v_mfma_f32_16x16x32_bf16 v[60:63], v[28:31], v[144:147], v[60:63]
    s_waitcnt lgkmcnt(10)
    v_mfma_f32_16x16x32_bf16 v[64:67], v[32:35], v[144:147], v[64:67]
    s_waitcnt lgkmcnt(8)
    v_mfma_f32_16x16x32_bf16 v[68:71], v[36:39], v[144:147], v[68:71]
    s_waitcnt lgkmcnt(6)
    v_mfma_f32_16x16x32_bf16 v[72:75], v[40:43], v[144:147], v[72:75]
    s_waitcnt lgkmcnt(4)
    v_mfma_f32_16x16x32_bf16 v[76:79], v[44:47], v[144:147], v[76:79]
    s_waitcnt lgkmcnt(2)
    v_mfma_f32_16x16x32_bf16 v[80:83], v[48:51], v[144:147], v[80:83]
    s_waitcnt lgkmcnt(0)
    v_mfma_f32_16x16x32_bf16 v[84:87], v[52:55], v[144:147], v[84:87]
    s_waitcnt lgkmcnt(0)
    s_barrier
    s_add_u32 s3, s98, 0
    s_and_b32 s3, s3, 3
    s_lshl_b32 s3, s3, 1
    s_lshl_b32 s63, s97, 3
    s_add_u32 s3, s3, s63
    s_add_u32 s3, s3, 1
    s_lshl_b32 s3, s3, 17
    s_add_u32 m0, s56, 122880
    s_add_u32 s60, s3, 98304
    buffer_load_dwordx4 v248, s[8:11], s60 offen lds
    s_add_u32 m0, s56, 123904
    s_add_u32 s60, s3, 102400
    buffer_load_dwordx4 v249, s[8:11], s60 offen lds
    s_waitcnt lgkmcnt(0)
    s_barrier
    v_mfma_f32_16x16x32_bf16 v[88:91], v[24:27], v[148:151], v[88:91]
    v_mfma_f32_16x16x32_bf16 v[92:95], v[28:31], v[148:151], v[92:95]
    v_mfma_f32_16x16x32_bf16 v[96:99], v[32:35], v[148:151], v[96:99]
    v_mfma_f32_16x16x32_bf16 v[100:103], v[36:39], v[148:151], v[100:103]
    v_mfma_f32_16x16x32_bf16 v[104:107], v[40:43], v[148:151], v[104:107]
    v_mfma_f32_16x16x32_bf16 v[108:111], v[44:47], v[148:151], v[108:111]
    v_mfma_f32_16x16x32_bf16 v[112:115], v[48:51], v[148:151], v[112:115]
    v_mfma_f32_16x16x32_bf16 v[116:119], v[52:55], v[148:151], v[116:119]
    s_waitcnt lgkmcnt(0)
    s_barrier
    s_waitcnt lgkmcnt(0)
    s_barrier
    s_add_u32 s3, s98, 3
    s_and_b32 s3, s3, 3
    s_lshl_b32 s3, s3, 1
    s_lshl_b32 s63, s97, 3
    s_add_u32 s3, s3, s63
    s_lshl_b32 s3, s3, 17
    s_lshr_b32 s63, s55, 1
    s_lshl_b32 s63, s63, 15
    s_add_u32 s3, s3, s63
    s_and_b32 s63, s55, 1
    s_lshl_b32 s63, s63, 12
    s_add_u32 s3, s3, s63
    buffer_load_dwordx4 v[240:243], v248, s[8:11], s3 offen
    s_waitcnt lgkmcnt(0)
    s_barrier
    s_waitcnt lgkmcnt(0)
    s_barrier
    s_waitcnt lgkmcnt(0)
    s_barrier
    s_waitcnt vmcnt(0) lgkmcnt(0)
    s_barrier
    s_waitcnt lgkmcnt(0)
    s_barrier
    s_cmp_eq_u32 s6, 0
    s_cbranch_scc1 L_far1
    s_movk_i32 s60, 4096
    buffer_store_dwordx4 v[120:123], v23, s[48:51], 0 offen offset:0
    buffer_store_dwordx4 v[124:127], v23, s[48:51], 0 offen offset:1024
    buffer_store_dwordx4 v[128:131], v23, s[48:51], 0 offen offset:2048
    buffer_store_dwordx4 v[132:135], v23, s[48:51], 0 offen offset:3072
    buffer_store_dwordx4 v[136:139], v23, s[48:51], s60 offen offset:0
    buffer_store_dwordx4 v[140:143], v23, s[48:51], s60 offen offset:1024
    buffer_store_dwordx4 v[144:147], v23, s[48:51], s60 offen offset:2048
    buffer_store_dwordx4 v[148:151], v23, s[48:51], s60 offen offset:3072
    s_branch L_near1
L_far1:
    s_movk_i32 s60, 4096
    buffer_store_dwordx4 v[120:123], v23, s[48:51], 0 offen offset:0 sc1
    buffer_store_dwordx4 v[124:127], v23, s[48:51], 0 offen offset:1024 sc1
    buffer_store_dwordx4 v[128:131], v23, s[48:51], 0 offen offset:2048 sc1
    buffer_store_dwordx4 v[132:135], v23, s[48:51], 0 offen offset:3072 sc1
    buffer_store_dwordx4 v[136:139], v23, s[48:51], s60 offen offset:0 sc1
    buffer_store_dwordx4 v[140:143], v23, s[48:51], s60 offen offset:1024 sc1
    buffer_store_dwordx4 v[144:147], v23, s[48:51], s60 offen offset:2048 sc1
    buffer_store_dwordx4 v[148:151], v23, s[48:51], s60 offen offset:3072 sc1
L_near1:
    s_waitcnt lgkmcnt(0)
    s_barrier
    s_add_u32 s31, s21, s98
    s_lshl_b32 s60, s31, 18
    s_add_u32 s60, s60, 16777216
    s_add_u32 s36, s28, s60
    s_addc_u32 s37, s29, 0
    s_mov_b32 s38, 262144
    s_mov_b32 s39, 0x20000
    s_lshl_b32 s3, s52, 12
    s_lshl_b32 s59, s97, 14
    s_add_u32 s59, s59, s3
    s_lshl_b32 s58, s97, 16
    s_add_u32 s58, s58, s3
    s_lshl_b32 s63, s55, 2
    s_add_u32 s63, s63, s52
    s_lshl_b32 s63, s63, 16
    s_lshl_b32 s60, s53, 10
    s_add_u32 s63, s63, s60
    s_lshl_b32 s60, s98, 8
    s_add_u32 s63, s63, s60
    s_lshl_b32 s60, s97, 6
    s_add_u32 s63, s63, s60
    s_add_u32 s48, s24, s63
    s_addc_u32 s49, s25, 0
    s_mov_b32 s50, 0
    s_mov_b32 s51, 0x20000
    s_sub_u32 s50, 2097152, s63
    v_and_b32 v20, 15, v22
    v_lshlrev_b32 v13, 11, v20
    v_lshrrev_b32 v20, 4, v22
    v_lshl_add_u32 v13, v20, 4, v13
    s_waitcnt vmcnt(0) lgkmcnt(0)
    s_barrier
    s_mov_b64 exec, 1
    s_cmp_eq_u32 s6, 0
    s_cbranch_scc1 L_far2
    buffer_store_dwordx2 v[252:253], v254, s[16:19], s20 offen
    s_branch L_near2
L_far2:
    buffer_store_dwordx2 v[252:253], v254, s[16:19], s20 offen sc1
L_near2:
    s_mov_b64 exec, -1
    s_waitcnt lgkmcnt(0)
    s_barrier
    buffer_load_dwordx2 v[20:21], v12, s[16:19], s23 offen sc1
    s_waitcnt lgkmcnt(0)
    s_barrier
    s_waitcnt vmcnt(0) lgkmcnt(0)
    s_barrier
    v_cmp_ne_u32 vcc, s99, v20
    v_cmp_ne_u32 s[4:5], s100, v21
    s_or_b64 vcc, vcc, s[4:5]
    s_cbranch_scc0 L_polldo1
    s_mov_b32 s63, 0x200000
    s_mov_b64 exec, 15
L_pollo1:
    buffer_load_dwordx2 v[20:21], v12, s[16:19], s23 offen sc1
    s_waitcnt vmcnt(0)
    v_cmp_ne_u32 vcc, s99, v20
    v_cmp_ne_u32 s[4:5], s100, v21
    s_or_b64 vcc, vcc, s[4:5]
    s_cbranch_scc0 L_polldo1
    s_sleep 2
    s_sub_u32 s63, s63, 1
    s_cmp_lg_u32 s63, 0
    s_cbranch_scc1 L_pollo1
    s_branch L_end
L_polldo1:
    s_mov_b64 exec, -1
    s_add_u32 s61, s98, 1
    s_and_b32 s61, s61, 3
    s_mul_i32 s61, s61, 8192
    buffer_load_dwordx4 v[184:187], v23, s[32:35], s61 offen offset:0 sc1
    buffer_load_dwordx4 v[188:191], v23, s[32:35], s61 offen offset:1024 sc1
    buffer_load_dwordx4 v[192:195], v23, s[32:35], s61 offen offset:2048 sc1
    buffer_load_dwordx4 v[196:199], v23, s[32:35], s61 offen offset:3072 sc1
    s_add_u32 s61, s61, 4096
    buffer_load_dwordx4 v[200:203], v23, s[32:35], s61 offen offset:0 sc1
    buffer_load_dwordx4 v[204:207], v23, s[32:35], s61 offen offset:1024 sc1
    buffer_load_dwordx4 v[208:211], v23, s[32:35], s61 offen offset:2048 sc1
    buffer_load_dwordx4 v[212:215], v23, s[32:35], s61 offen offset:3072 sc1
    s_waitcnt lgkmcnt(0)
    s_barrier
    s_add_u32 s61, s98, 2
    s_and_b32 s61, s61, 3
    s_mul_i32 s61, s61, 8192
    buffer_load_dwordx4 v[216:219], v23, s[32:35], s61 offen offset:0 sc1
    buffer_load_dwordx4 v[220:223], v23, s[32:35], s61 offen offset:1024 sc1
    buffer_load_dwordx4 v[224:227], v23, s[32:35], s61 offen offset:2048 sc1
    buffer_load_dwordx4 v[228:231], v23, s[32:35], s61 offen offset:3072 sc1
    s_add_u32 s61, s61, 4096
    buffer_load_dwordx4 v[232:235], v23, s[32:35], s61 offen offset:0 sc1
    buffer_load_dwordx4 v[236:239], v23, s[32:35], s61 offen offset:1024 sc1
    buffer_load_dwordx4 v[240:243], v23, s[32:35], s61 offen offset:2048 sc1
    buffer_load_dwordx4 v[244:247], v23, s[32:35], s61 offen offset:3072 sc1
    s_add_u32 s61, s98, 3
    s_and_b32 s61, s61, 3
    s_mul_i32 s61, s61, 8192
    buffer_load_dwordx4 v[120:123], v23, s[32:35], s61 offen offset:0 sc1
    buffer_load_dwordx4 v[124:127], v23, s[32:35], s61 offen offset:1024 sc1
    buffer_load_dwordx4 v[128:131], v23, s[32:35], s61 offen offset:2048 sc1
    buffer_load_dwordx4 v[132:135], v23, s[32:35], s61 offen offset:3072 sc1
    s_add_u32 s61, s61, 4096
    buffer_load_dwordx4 v[136:139], v23, s[32:35], s61 offen offset:0 sc1
    buffer_load_dwordx4 v[140:143], v23, s[32:35], s61 offen offset:1024 sc1
    buffer_load_dwordx4 v[144:147], v23, s[32:35], s61 offen offset:2048 sc1
    buffer_load_dwordx4 v[148:151], v23, s[32:35], s61 offen offset:3072 sc1
    s_waitcnt lgkmcnt(0)
    s_barrier
    v_add_u32 v4, 0x10000, v4
    v_add_u32 v5, 0x10000, v5
    v_add_u32 v6, 0x10000, v6
    v_add_u32 v7, 0x10000, v7
    v_add_u32 v8, 0x10000, v8
    v_add_u32 v9, 0x10000, v9
    v_add_u32 v10, 0x10000, v10
    v_add_u32 v11, 0x10000, v11
    ds_read_b64_tr_b16 v[24:25], v4 offset:0
    ds_read_b64_tr_b16 v[26:27], v4 offset:4096
    ds_read_b64_tr_b16 v[28:29], v5 offset:0
    ds_read_b64_tr_b16 v[30:31], v5 offset:4096
    ds_read_b64_tr_b16 v[32:33], v6 offset:0
    ds_read_b64_tr_b16 v[34:35], v6 offset:4096
    ds_read_b64_tr_b16 v[36:37], v7 offset:0
    ds_read_b64_tr_b16 v[38:39], v7 offset:4096
    ds_read_b64_tr_b16 v[40:41], v8 offset:0
    ds_read_b64_tr_b16 v[42:43], v8 offset:4096
    ds_read_b64_tr_b16 v[44:45], v9 offset:0
    ds_read_b64_tr_b16 v[46:47], v9 offset:4096
    ds_read_b64_tr_b16 v[48:49], v10 offset:0
    ds_read_b64_tr_b16 v[50:51], v10 offset:4096
    ds_read_b64_tr_b16 v[52:53], v11 offset:0
    ds_read_b64_tr_b16 v[54:55], v11 offset:4096
    s_waitcnt vmcnt(0) lgkmcnt(0)
    s_barrier
    s_add_u32 s20, s20, 294912
    s_add_u32 s23, s23, 294912
    s_mov_b64 exec, 1
    s_cmp_eq_u32 s6, 0
    s_cbranch_scc1 L_far3
    buffer_store_dwordx2 v[252:253], v254, s[16:19], s20 offen
    s_branch L_near3
L_far3:
    buffer_store_dwordx2 v[252:253], v254, s[16:19], s20 offen sc1
L_near3:
    s_mov_b64 exec, -1
    s_add_u32 s3, s98, 3
    s_and_b32 s3, s3, 3
    s_lshl_b32 s3, s3, 1
    s_lshl_b32 s63, s97, 3
    s_add_u32 s3, s3, s63
    s_lshl_b32 s3, s3, 17
    s_add_u32 m0, s56, 32768
    s_add_u32 s60, s3, 0
    buffer_load_dwordx4 v248, s[8:11], s60 offen lds
    s_add_u32 m0, s56, 33792
    s_add_u32 s60, s3, 4096
    buffer_load_dwordx4 v249, s[8:11], s60 offen lds
    s_add_u32 s3, s98, 3
    s_and_b32 s3, s3, 3
    s_lshl_b32 s3, s3, 1
    s_lshl_b32 s63, s97, 3
    s_add_u32 s3, s3, s63
    s_lshl_b32 s3, s3, 17
    s_add_u32 m0, s56, 40960
    s_add_u32 s60, s3, 32768
    buffer_load_dwordx4 v248, s[8:11], s60 offen lds
    s_add_u32 m0, s56, 41984
    s_add_u32 s60, s3, 36864
    buffer_load_dwordx4 v249, s[8:11], s60 offen lds
    s_add_u32 s3, s98, 3
    s_and_b32 s3, s3, 3
    s_lshl_b32 s3, s3, 1
    s_lshl_b32 s63, s97, 3
    s_add_u32 s3, s3, s63
    s_lshl_b32 s3, s3, 17
    s_add_u32 m0, s56, 49152
    s_add_u32 s60, s3, 65536
    buffer_load_dwordx4 v248, s[8:11], s60 offen lds
    s_add_u32 m0, s56, 50176
    s_add_u32 s60, s3, 69632
    buffer_load_dwordx4 v249, s[8:11], s60 offen lds
    s_add_u32 s3, s98, 3
    s_and_b32 s3, s3, 3
    s_lshl_b32 s3, s3, 1
    s_lshl_b32 s63, s97, 3
    s_add_u32 s3, s3, s63
    s_lshl_b32 s3, s3, 17
    s_add_u32 m0, s56, 57344
    s_add_u32 s60, s3, 98304
    buffer_load_dwordx4 v248, s[8:11], s60 offen lds
    s_add_u32 m0, s56, 58368
    s_add_u32 s60, s3, 102400
    buffer_load_dwordx4 v249, s[8:11], s60 offen lds
    buffer_load_dwordx2 v[20:21], v12, s[16:19], s23 offen sc1
    v_add_u32 v19, s56, v23
    s_setprio 1
    v_mfma_f32_16x16x32_bf16 v[56:59], v[24:27], v[184:187], v[56:59]
    ds_read_b64_tr_b16 v[152:153], v4 offset:8192
    v_mfma_f32_16x16x32_bf16 v[88:91], v[24:27], v[188:191], v[88:91]
    ds_read_b64_tr_b16 v[154:155], v4 offset:12288
    v_mfma_f32_16x16x32_bf16 v[60:63], v[28:31], v[184:187], v[60:63]
    ds_read_b64_tr_b16 v[156:157], v5 offset:8192
    v_mfma_f32_16x16x32_bf16 v[92:95], v[28:31], v[188:191], v[92:95]
    ds_read_b64_tr_b16 v[158:159], v5 offset:12288
    v_mfma_f32_16x16x32_bf16 v[64:67], v[32:35], v[184:187], v[64:67]
    ds_read_b64_tr_b16 v[160:161], v6 offset:8192
    v_mfma_f32_16x16x32_bf16 v[96:99], v[32:35], v[188:191], v[96:99]
    ds_read_b64_tr_b16 v[162:163], v6 offset:12288
    v_mfma_f32_16x16x32_bf16 v[68:71], v[36:39], v[184:187], v[68:71]
    ds_read_b64_tr_b16 v[164:165], v7 offset:8192
    v_mfma_f32_16x16x32_bf16 v[100:103], v[36:39], v[188:191], v[100:103]
    ds_read_b64_tr_b16 v[166:167], v7 offset:12288
    v_mfma_f32_16x16x32_bf16 v[72:75], v[40:43], v[184:187], v[72:75]
    ds_read_b64_tr_b16 v[168:169], v8 offset:8192
    v_mfma_f32_16x16x32_bf16 v[104:107], v[40:43], v[188:191], v[104:107]
    ds_read_b64_tr_b16 v[170:171], v8 offset:12288
    v_mfma_f32_16x16x32_bf16 v[76:79], v[44:47], v[184:187], v[76:79]
    ds_read_b64_tr_b16 v[172:173], v9 offset:8192
    v_mfma_f32_16x16x32_bf16 v[108:111], v[44:47], v[188:191], v[108:111]
    ds_read_b64_tr_b16 v[174:175], v9 offset:12288
    v_mfma_f32_16x16x32_bf16 v[80:83], v[48:51], v[184:187], v[80:83]
    ds_read_b64_tr_b16 v[176:177], v10 offset:8192
    v_mfma_f32_16x16x32_bf16 v[112:115], v[48:51], v[188:191], v[112:115]
    ds_read_b64_tr_b16 v[178:179], v10 offset:12288
    v_mfma_f32_16x16x32_bf16 v[84:87], v[52:55], v[184:187], v[84:87]
    ds_read_b64_tr_b16 v[180:181], v11 offset:8192
    v_mfma_f32_16x16x32_bf16 v[116:119], v[52:55], v[188:191], v[116:119]
    ds_read_b64_tr_b16 v[182:183], v11 offset:12288
    s_waitcnt lgkmcnt(8)
    v_mfma_f32_16x16x32_bf16 v[56:59], v[152:155], v[192:195], v[56:59]
    ds_read_b64_tr_b16 v[24:25], v4 offset:16384
    v_mfma_f32_16x16x32_bf16 v[88:91], v[152:155], v[196:199], v[88:91]
    ds_read_b64_tr_b16 v[26:27], v4 offset:20480
    v_mfma_f32_16x16x32_bf16 v[60:63], v[156:159], v[192:195], v[60:63]
    ds_read_b64_tr_b16 v[28:29], v5 offset:16384
    v_mfma_f32_16x16x32_bf16 v[92:95], v[156:159], v[196:199], v[92:95]
    ds_read_b64_tr_b16 v[30:31], v5 offset:20480
    v_mfma_f32_16x16x32_bf16 v[64:67], v[160:163], v[192:195], v[64:67]
    ds_read_b64_tr_b16 v[32:33], v6 offset:16384
    v_mfma_f32_16x16x32_bf16 v[96:99], v[160:163], v[196:199], v[96:99]
    ds_read_b64_tr_b16 v[34:35], v6 offset:20480
    v_mfma_f32_16x16x32_bf16 v[68:71], v[164:167], v[192:195], v[68:71]
    ds_read_b64_tr_b16 v[36:37], v7 offset:16384
    v_mfma_f32_16x16x32_bf16 v[100:103], v[164:167], v[196:199], v[100:103]
    ds_read_b64_tr_b16 v[38:39], v7 offset:20480
    s_waitcnt lgkmcnt(8)
    v_mfma_f32_16x16x32_bf16 v[72:75], v[168:171], v[192:195], v[72:75]
    ds_read_b64_tr_b16 v[40:41], v8 offset:16384
    v_mfma_f32_16x16x32_bf16 v[104:107], v[168:171], v[196:199], v[104:107]
    ds_read_b64_tr_b16 v[42:43], v8 offset:20480
    v_mfma_f32_16x16x32_bf16 v[76:79], v[172:175], v[192:195], v[76:79]
    ds_read_b64_tr_b16 v[44:45], v9 offset:16384
    v_mfma_f32_16x16x32_bf16 v[108:111], v[172:175], v[196:199], v[108:111]
    ds_read_b64_tr_b16 v[46:47], v9 offset:20480
    v_mfma_f32_16x16x32_bf16 v[80:83], v[176:179], v[192:195], v[80:83]
    ds_read_b64_tr_b16 v[48:49], v10 offset:16384
    v_mfma_f32_16x16x32_bf16 v[112:115], v[176:179], v[196:199], v[112:115]
    ds_read_b64_tr_b16 v[50:51], v10 offset:20480
    v_mfma_f32_16x16x32_bf16 v[84:87], v[180:183], v[192:195], v[84:87]
    ds_read_b64_tr_b16 v[52:53], v11 offset:16384
    v_mfma_f32_16x16x32_bf16 v[116:119], v[180:183], v[196:199], v[116:119]
    ds_read_b64_tr_b16 v[54:55], v11 offset:20480
    s_waitcnt lgkmcnt(8)
    v_mfma_f32_16x16x32_bf16 v[56:59], v[24:27], v[200:203], v[56:59]
    ds_read_b64_tr_b16 v[152:153], v4 offset:24576
    v_mfma_f32_16x16x32_bf16 v[88:91], v[24:27], v[204:207], v[88:91]
    ds_read_b64_tr_b16 v[154:155], v4 offset:28672
    v_mfma_f32_16x16x32_bf16 v[60:63], v[28:31], v[200:203], v[60:63]
    ds_read_b64_tr_b16 v[156:157], v5 offset:24576
    v_mfma_f32_16x16x32_bf16 v[92:95], v[28:31], v[204:207], v[92:95]
    ds_read_b64_tr_b16 v[158:159], v5 offset:28672
    v_mfma_f32_16x16x32_bf16 v[64:67], v[32:35], v[200:203], v[64:67]
    ds_read_b64_tr_b16 v[160:161], v6 offset:24576
    v_mfma_f32_16x16x32_bf16 v[96:99], v[32:35], v[204:207], v[96:99]
    ds_read_b64_tr_b16 v[162:163], v6 offset:28672
    v_mfma_f32_16x16x32_bf16 v[68:71], v[36:39], v[200:203], v[68:71]
    ds_read_b64_tr_b16 v[164:165], v7 offset:24576
    v_mfma_f32_16x16x32_bf16 v[100:103], v[36:39], v[204:207], v[100:103]
    ds_read_b64_tr_b16 v[166:167], v7 offset:28672
    s_waitcnt lgkmcnt(8)
    v_mfma_f32_16x16x32_bf16 v[72:75], v[40:43], v[200:203], v[72:75]
    ds_read_b64_tr_b16 v[168:169], v8 offset:24576
    v_mfma_f32_16x16x32_bf16 v[104:107], v[40:43], v[204:207], v[104:107]
    ds_read_b64_tr_b16 v[170:171], v8 offset:28672
    v_mfma_f32_16x16x32_bf16 v[76:79], v[44:47], v[200:203], v[76:79]
    ds_read_b64_tr_b16 v[172:173], v9 offset:24576
    v_mfma_f32_16x16x32_bf16 v[108:111], v[44:47], v[204:207], v[108:111]
    ds_read_b64_tr_b16 v[174:175], v9 offset:28672
    v_mfma_f32_16x16x32_bf16 v[80:83], v[48:51], v[200:203], v[80:83]
    ds_read_b64_tr_b16 v[176:177], v10 offset:24576
    v_mfma_f32_16x16x32_bf16 v[112:115], v[48:51], v[204:207], v[112:115]
    ds_read_b64_tr_b16 v[178:179], v10 offset:28672
    v_mfma_f32_16x16x32_bf16 v[84:87], v[52:55], v[200:203], v[84:87]
    ds_read_b64_tr_b16 v[180:181], v11 offset:24576
    v_mfma_f32_16x16x32_bf16 v[116:119], v[52:55], v[204:207], v[116:119]
    ds_read_b64_tr_b16 v[182:183], v11 offset:28672
    s_waitcnt lgkmcnt(8)
    v_mfma_f32_16x16x32_bf16 v[56:59], v[152:155], v[208:211], v[56:59]
    v_add_u32 v4, 0xffff0000, v4
    v_add_u32 v5, 0xffff0000, v5
    v_add_u32 v6, 0xffff0000, v6
    v_add_u32 v7, 0xffff0000, v7
    v_add_u32 v8, 0xffff0000, v8
    v_add_u32 v9, 0xffff0000, v9
    v_add_u32 v10, 0xffff0000, v10
    v_add_u32 v11, 0xffff0000, v11
    ds_read_b64_tr_b16 v[24:25], v4 offset:0
    v_mfma_f32_16x16x32_bf16 v[88:91], v[152:155], v[212:215], v[88:91]
    ds_read_b64_tr_b16 v[26:27], v4 offset:4096
    v_mfma_f32_16x16x32_bf16 v[60:63], v[156:159], v[208:211], v[60:63]
    ds_read_b64_tr_b16 v[28:29], v5 offset:0
    v_mfma_f32_16x16x32_bf16 v[92:95], v[156:159], v[212:215], v[92:95]
    ds_read_b64_tr_b16 v[30:31], v5 offset:4096
    v_mfma_f32_16x16x32_bf16 v[64:67], v[160:163], v[208:211], v[64:67]
    ds_read_b64_tr_b16 v[32:33], v6 offset:0
    v_mfma_f32_16x16x32_bf16 v[96:99], v[160:163], v[212:215], v[96:99]
    ds_read_b64_tr_b16 v[34:35], v6 offset:4096
    v_mfma_f32_16x16x32_bf16 v[68:71], v[164:167], v[208:211], v[68:71]
    ds_read_b64_tr_b16 v[36:37], v7 offset:0
    v_mfma_f32_16x16x32_bf16 v[100:103], v[164:167], v[212:215], v[100:103]
    ds_read_b64_tr_b16 v[38:39], v7 offset:4096
    s_waitcnt lgkmcnt(8)
    v_mfma_f32_16x16x32_bf16 v[72:75], v[168:171], v[208:211], v[72:75]
    ds_read_b64_tr_b16 v[40:41], v8 offset:0
    v_mfma_f32_16x16x32_bf16 v[104:107], v[168:171], v[212:215], v[104:107]
    ds_read_b64_tr_b16 v[42:43], v8 offset:4096
    v_mfma_f32_16x16x32_bf16 v[76:79], v[172:175], v[208:211], v[76:79]
    ds_read_b64_tr_b16 v[44:45], v9 offset:0
    v_mfma_f32_16x16x32_bf16 v[108:111], v[172:175], v[212:215], v[108:111]
    ds_read_b64_tr_b16 v[46:47], v9 offset:4096
    v_mfma_f32_16x16x32_bf16 v[80:83], v[176:179], v[208:211], v[80:83]
    ds_read_b64_tr_b16 v[48:49], v10 offset:0
    v_mfma_f32_16x16x32_bf16 v[112:115], v[176:179], v[212:215], v[112:115]
    ds_read_b64_tr_b16 v[50:51], v10 offset:4096
    v_mfma_f32_16x16x32_bf16 v[84:87], v[180:183], v[208:211], v[84:87]
    ds_read_b64_tr_b16 v[52:53], v11 offset:0
    v_mfma_f32_16x16x32_bf16 v[116:119], v[180:183], v[212:215], v[116:119]
    ds_read_b64_tr_b16 v[54:55], v11 offset:4096
    s_waitcnt vmcnt(0)
    v_cmp_ne_u32 vcc, s99, v20
    v_cmp_ne_u32 s[4:5], s100, v21
    s_or_b64 vcc, vcc, s[4:5]
    s_cbranch_scc0 L_polldc
    s_mov_b32 s63, 0x200000
    s_mov_b64 exec, 15
L_pollc:
    buffer_load_dwordx2 v[20:21], v12, s[16:19], s23 offen sc1
    s_waitcnt vmcnt(0)
    v_cmp_ne_u32 vcc, s99, v20
    v_cmp_ne_u32 s[4:5], s100, v21
    s_or_b64 vcc, vcc, s[4:5]
    s_cbranch_scc0 L_polldc
    s_sleep 2
    s_sub_u32 s63, s63, 1
    s_cmp_lg_u32 s63, 0
    s_cbranch_scc1 L_pollc
    s_branch L_end
L_polldc:
    s_mov_b64 exec, -1
    s_barrier
    s_setprio 2
    s_waitcnt lgkmcnt(8)
    v_mfma_f32_16x16x32_bf16 v[56:59], v[24:27], v[216:219], v[56:59]
    ds_read_b64_tr_b16 v[152:153], v4 offset:8192
    v_mfma_f32_16x16x32_bf16 v[88:91], v[24:27], v[220:223], v[88:91]
    ds_read_b64_tr_b16 v[154:155], v4 offset:12288
    v_mfma_f32_16x16x32_bf16 v[60:63], v[28:31], v[216:219], v[60:63]
    ds_read_b64_tr_b16 v[156:157], v5 offset:8192
    v_mfma_f32_16x16x32_bf16 v[92:95], v[28:31], v[220:223], v[92:95]
    ds_read_b64_tr_b16 v[158:159], v5 offset:12288
    v_mfma_f32_16x16x32_bf16 v[64:67], v[32:35], v[216:219], v[64:67]
    ds_read_b64_tr_b16 v[160:161], v6 offset:8192
    v_mfma_f32_16x16x32_bf16 v[96:99], v[32:35], v[220:223], v[96:99]
    ds_read_b64_tr_b16 v[162:163], v6 offset:12288
    v_mfma_f32_16x16x32_bf16 v[68:71], v[36:39], v[216:219], v[68:71]
    ds_read_b64_tr_b16 v[164:165], v7 offset:8192
    v_mfma_f32_16x16x32_bf16 v[100:103], v[36:39], v[220:223], v[100:103]
    ds_read_b64_tr_b16 v[166:167], v7 offset:12288
    s_waitcnt lgkmcnt(8)
    v_mfma_f32_16x16x32_bf16 v[72:75], v[40:43], v[216:219], v[72:75]
    ds_read_b64_tr_b16 v[168:169], v8 offset:8192
    v_mfma_f32_16x16x32_bf16 v[104:107], v[40:43], v[220:223], v[104:107]
    ds_read_b64_tr_b16 v[170:171], v8 offset:12288
    v_mfma_f32_16x16x32_bf16 v[76:79], v[44:47], v[216:219], v[76:79]
    ds_read_b64_tr_b16 v[172:173], v9 offset:8192
    v_mfma_f32_16x16x32_bf16 v[108:111], v[44:47], v[220:223], v[108:111]
    ds_read_b64_tr_b16 v[174:175], v9 offset:12288
    v_mfma_f32_16x16x32_bf16 v[80:83], v[48:51], v[216:219], v[80:83]
    ds_read_b64_tr_b16 v[176:177], v10 offset:8192
    v_mfma_f32_16x16x32_bf16 v[112:115], v[48:51], v[220:223], v[112:115]
    ds_read_b64_tr_b16 v[178:179], v10 offset:12288
    v_mfma_f32_16x16x32_bf16 v[84:87], v[52:55], v[216:219], v[84:87]
    ds_read_b64_tr_b16 v[180:181], v11 offset:8192
    v_mfma_f32_16x16x32_bf16 v[116:119], v[52:55], v[220:223], v[116:119]
    ds_read_b64_tr_b16 v[182:183], v11 offset:12288
    s_waitcnt lgkmcnt(8)
    v_mfma_f32_16x16x32_bf16 v[56:59], v[152:155], v[224:227], v[56:59]
    ds_read_b64_tr_b16 v[24:25], v4 offset:16384
    v_mfma_f32_16x16x32_bf16 v[88:91], v[152:155], v[228:231], v[88:91]
    ds_read_b64_tr_b16 v[26:27], v4 offset:20480
    v_mfma_f32_16x16x32_bf16 v[60:63], v[156:159], v[224:227], v[60:63]
    ds_read_b64_tr_b16 v[28:29], v5 offset:16384
    v_mfma_f32_16x16x32_bf16 v[92:95], v[156:159], v[228:231], v[92:95]
    ds_read_b64_tr_b16 v[30:31], v5 offset:20480
    v_mfma_f32_16x16x32_bf16 v[64:67], v[160:163], v[224:227], v[64:67]
    ds_read_b64_tr_b16 v[32:33], v6 offset:16384
    v_mfma_f32_16x16x32_bf16 v[96:99], v[160:163], v[228:231], v[96:99]
    ds_read_b64_tr_b16 v[34:35], v6 offset:20480
    v_mfma_f32_16x16x32_bf16 v[68:71], v[164:167], v[224:227], v[68:71]
    ds_read_b64_tr_b16 v[36:37], v7 offset:16384
    v_mfma_f32_16x16x32_bf16 v[100:103], v[164:167], v[228:231], v[100:103]
    ds_read_b64_tr_b16 v[38:39], v7 offset:20480
    s_waitcnt lgkmcnt(8)
    v_mfma_f32_16x16x32_bf16 v[72:75], v[168:171], v[224:227], v[72:75]
    ds_read_b64_tr_b16 v[40:41], v8 offset:16384
    v_mfma_f32_16x16x32_bf16 v[104:107], v[168:171], v[228:231], v[104:107]
    ds_read_b64_tr_b16 v[42:43], v8 offset:20480
    v_mfma_f32_16x16x32_bf16 v[76:79], v[172:175], v[224:227], v[76:79]
    ds_read_b64_tr_b16 v[44:45], v9 offset:16384
    v_mfma_f32_16x16x32_bf16 v[108:111], v[172:175], v[228:231], v[108:111]
    ds_read_b64_tr_b16 v[46:47], v9 offset:20480
    v_mfma_f32_16x16x32_bf16 v[80:83], v[176:179], v[224:227], v[80:83]
    ds_read_b64_tr_b16 v[48:49], v10 offset:16384
    v_mfma_f32_16x16x32_bf16 v[112:115], v[176:179], v[228:231], v[112:115]
    ds_read_b64_tr_b16 v[50:51], v10 offset:20480
    v_mfma_f32_16x16x32_bf16 v[84:87], v[180:183], v[224:227], v[84:87]
    ds_read_b64_tr_b16 v[52:53], v11 offset:16384
    v_mfma_f32_16x16x32_bf16 v[116:119], v[180:183], v[228:231], v[116:119]
    ds_read_b64_tr_b16 v[54:55], v11 offset:20480
    s_waitcnt lgkmcnt(8)
    v_mfma_f32_16x16x32_bf16 v[56:59], v[24:27], v[232:235], v[56:59]
    ds_read_b64_tr_b16 v[152:153], v4 offset:24576
    v_mfma_f32_16x16x32_bf16 v[88:91], v[24:27], v[236:239], v[88:91]
    ds_read_b64_tr_b16 v[154:155], v4 offset:28672
    v_mfma_f32_16x16x32_bf16 v[60:63], v[28:31], v[232:235], v[60:63]
    ds_read_b64_tr_b16 v[156:157], v5 offset:24576
    v_mfma_f32_16x16x32_bf16 v[92:95], v[28:31], v[236:239], v[92:95]
    ds_read_b64_tr_b16 v[158:159], v5 offset:28672
    v_mfma_f32_16x16x32_bf16 v[64:67], v[32:35], v[232:235], v[64:67]
    ds_read_b64_tr_b16 v[160:161], v6 offset:24576
    v_mfma_f32_16x16x32_bf16 v[96:99], v[32:35], v[236:239], v[96:99]
    ds_read_b64_tr_b16 v[162:163], v6 offset:28672
    v_mfma_f32_16x16x32_bf16 v[68:71], v[36:39], v[232:235], v[68:71]
    ds_read_b64_tr_b16 v[164:165], v7 offset:24576
    v_mfma_f32_16x16x32_bf16 v[100:103], v[36:39], v[236:239], v[100:103]
    ds_read_b64_tr_b16 v[166:167], v7 offset:28672
    s_waitcnt lgkmcnt(8)
    v_mfma_f32_16x16x32_bf16 v[72:75], v[40:43], v[232:235], v[72:75]
    ds_read_b64_tr_b16 v[168:169], v8 offset:24576
    v_mfma_f32_16x16x32_bf16 v[104:107], v[40:43], v[236:239], v[104:107]
    ds_read_b64_tr_b16 v[170:171], v8 offset:28672
    v_mfma_f32_16x16x32_bf16 v[76:79], v[44:47], v[232:235], v[76:79]
    ds_read_b64_tr_b16 v[172:173], v9 offset:24576
    v_mfma_f32_16x16x32_bf16 v[108:111], v[44:47], v[236:239], v[108:111]
    ds_read_b64_tr_b16 v[174:175], v9 offset:28672
    v_mfma_f32_16x16x32_bf16 v[80:83], v[48:51], v[232:235], v[80:83]
    ds_read_b64_tr_b16 v[176:177], v10 offset:24576
    v_mfma_f32_16x16x32_bf16 v[112:115], v[48:51], v[236:239], v[112:115]
    ds_read_b64_tr_b16 v[178:179], v10 offset:28672
    v_mfma_f32_16x16x32_bf16 v[84:87], v[52:55], v[232:235], v[84:87]
    ds_read_b64_tr_b16 v[180:181], v11 offset:24576
    v_mfma_f32_16x16x32_bf16 v[116:119], v[52:55], v[236:239], v[116:119]
    ds_read_b64_tr_b16 v[182:183], v11 offset:28672
    s_waitcnt lgkmcnt(8)
    v_mfma_f32_16x16x32_bf16 v[56:59], v[152:155], v[240:243], v[56:59]
    v_add_u32 v4, 0xffff0000, v4
    v_add_u32 v5, 0xffff0000, v5
    v_add_u32 v6, 0xffff0000, v6
    v_add_u32 v7, 0xffff0000, v7
    v_add_u32 v8, 0xffff0000, v8
    v_add_u32 v9, 0xffff0000, v9
    v_add_u32 v10, 0xffff0000, v10
    v_add_u32 v11, 0xffff0000, v11
    ds_read_b64_tr_b16 v[24:25], v4 offset:32768
    v_mfma_f32_16x16x32_bf16 v[88:91], v[152:155], v[244:247], v[88:91]
    ds_read_b64_tr_b16 v[26:27], v4 offset:36864
    v_mfma_f32_16x16x32_bf16 v[60:63], v[156:159], v[240:243], v[60:63]
    ds_read_b64_tr_b16 v[28:29], v5 offset:32768
    v_mfma_f32_16x16x32_bf16 v[92:95], v[156:159], v[244:247], v[92:95]
    ds_read_b64_tr_b16 v[30:31], v5 offset:36864
    v_mfma_f32_16x16x32_bf16 v[64:67], v[160:163], v[240:243], v[64:67]
    ds_read_b64_tr_b16 v[32:33], v6 offset:32768
    v_mfma_f32_16x16x32_bf16 v[96:99], v[160:163], v[244:247], v[96:99]
    ds_read_b64_tr_b16 v[34:35], v6 offset:36864
    v_mfma_f32_16x16x32_bf16 v[68:71], v[164:167], v[240:243], v[68:71]
    ds_read_b64_tr_b16 v[36:37], v7 offset:32768
    v_mfma_f32_16x16x32_bf16 v[100:103], v[164:167], v[244:247], v[100:103]
    ds_read_b64_tr_b16 v[38:39], v7 offset:36864
    s_waitcnt lgkmcnt(8)
    v_mfma_f32_16x16x32_bf16 v[72:75], v[168:171], v[240:243], v[72:75]
    ds_read_b64_tr_b16 v[40:41], v8 offset:32768
    v_mfma_f32_16x16x32_bf16 v[104:107], v[168:171], v[244:247], v[104:107]
    ds_read_b64_tr_b16 v[42:43], v8 offset:36864
    v_mfma_f32_16x16x32_bf16 v[76:79], v[172:175], v[240:243], v[76:79]
    ds_read_b64_tr_b16 v[44:45], v9 offset:32768
    v_mfma_f32_16x16x32_bf16 v[108:111], v[172:175], v[244:247], v[108:111]
    ds_read_b64_tr_b16 v[46:47], v9 offset:36864
    v_mfma_f32_16x16x32_bf16 v[80:83], v[176:179], v[240:243], v[80:83]
    ds_read_b64_tr_b16 v[48:49], v10 offset:32768
    v_mfma_f32_16x16x32_bf16 v[112:115], v[176:179], v[244:247], v[112:115]
    ds_read_b64_tr_b16 v[50:51], v10 offset:36864
    v_mfma_f32_16x16x32_bf16 v[84:87], v[180:183], v[240:243], v[84:87]
    ds_read_b64_tr_b16 v[52:53], v11 offset:32768
    v_mfma_f32_16x16x32_bf16 v[116:119], v[180:183], v[244:247], v[116:119]
    ds_read_b64_tr_b16 v[54:55], v11 offset:36864
    s_barrier
    s_waitcnt lgkmcnt(8)
    v_mfma_f32_16x16x32_bf16 v[56:59], v[24:27], v[120:123], v[56:59]
    ds_read_b64_tr_b16 v[152:153], v4 offset:40960
    ds_read_b128 v[184:187], v19 offset:0
    v_mfma_f32_16x16x32_bf16 v[88:91], v[24:27], v[124:127], v[88:91]
    ds_read_b64_tr_b16 v[154:155], v4 offset:45056
    v_mfma_f32_16x16x32_bf16 v[60:63], v[28:31], v[120:123], v[60:63]
    ds_read_b64_tr_b16 v[156:157], v5 offset:40960
    v_mfma_f32_16x16x32_bf16 v[92:95], v[28:31], v[124:127], v[92:95]
    ds_read_b64_tr_b16 v[158:159], v5 offset:45056
    v_mfma_f32_16x16x32_bf16 v[64:67], v[32:35], v[120:123], v[64:67]
    ds_read_b64_tr_b16 v[160:161], v6 offset:40960
    v_mfma_f32_16x16x32_bf16 v[96:99], v[32:35], v[124:127], v[96:99]
    ds_read_b64_tr_b16 v[162:163], v6 offset:45056
    v_mfma_f32_16x16x32_bf16 v[68:71], v[36:39], v[120:123], v[68:71]
    ds_read_b64_tr_b16 v[164:165], v7 offset:40960
    v_mfma_f32_16x16x32_bf16 v[100:103], v[36:39], v[124:127], v[100:103]
    ds_read_b64_tr_b16 v[166:167], v7 offset:45056
    s_waitcnt lgkmcnt(9)
    v_mfma_f32_16x16x32_bf16 v[72:75], v[40:43], v[120:123], v[72:75]
    ds_read_b64_tr_b16 v[168:169], v8 offset:40960
    ds_read_b128 v[188:191], v19 offset:1024
    v_mfma_f32_16x16x32_bf16 v[104:107], v[40:43], v[124:127], v[104:107]
    ds_read_b64_tr_b16 v[170:171], v8 offset:45056
    v_mfma_f32_16x16x32_bf16 v[76:79], v[44:47], v[120:123], v[76:79]
    ds_read_b64_tr_b16 v[172:173], v9 offset:40960
    v_mfma_f32_16x16x32_bf16 v[108:111], v[44:47], v[124:127], v[108:111]
    ds_read_b64_tr_b16 v[174:175], v9 offset:45056
    v_mfma_f32_16x16x32_bf16 v[80:83], v[48:51], v[120:123], v[80:83]
    ds_read_b64_tr_b16 v[176:177], v10 offset:40960
    v_mfma_f32_16x16x32_bf16 v[112:115], v[48:51], v[124:127], v[112:115]
    ds_read_b64_tr_b16 v[178:179], v10 offset:45056
    v_mfma_f32_16x16x32_bf16 v[84:87], v[52:55], v[120:123], v[84:87]
    ds_read_b64_tr_b16 v[180:181], v11 offset:40960
    v_mfma_f32_16x16x32_bf16 v[116:119], v[52:55], v[124:127], v[116:119]
    ds_read_b64_tr_b16 v[182:183], v11 offset:45056
    s_waitcnt lgkmcnt(9)
    v_mfma_f32_16x16x32_bf16 v[56:59], v[152:155], v[128:131], v[56:59]
    ds_read_b64_tr_b16 v[24:25], v4 offset:49152
    ds_read_b128 v[192:195], v19 offset:8192
    v_mfma_f32_16x16x32_bf16 v[88:91], v[152:155], v[132:135], v[88:91]
    ds_read_b64_tr_b16 v[26:27], v4 offset:53248
    v_mfma_f32_16x16x32_bf16 v[60:63], v[156:159], v[128:131], v[60:63]
    ds_read_b64_tr_b16 v[28:29], v5 offset:49152
    v_mfma_f32_16x16x32_bf16 v[92:95], v[156:159], v[132:135], v[92:95]
    ds_read_b64_tr_b16 v[30:31], v5 offset:53248
    v_mfma_f32_16x16x32_bf16 v[64:67], v[160:163], v[128:131], v[64:67]
    ds_read_b64_tr_b16 v[32:33], v6 offset:49152
    v_mfma_f32_16x16x32_bf16 v[96:99], v[160:163], v[132:135], v[96:99]
    ds_read_b64_tr_b16 v[34:35], v6 offset:53248
    v_mfma_f32_16x16x32_bf16 v[68:71], v[164:167], v[128:131], v[68:71]
    ds_read_b64_tr_b16 v[36:37], v7 offset:49152
    v_mfma_f32_16x16x32_bf16 v[100:103], v[164:167], v[132:135], v[100:103]
    ds_read_b64_tr_b16 v[38:39], v7 offset:53248
    s_waitcnt lgkmcnt(9)
    v_mfma_f32_16x16x32_bf16 v[72:75], v[168:171], v[128:131], v[72:75]
    ds_read_b64_tr_b16 v[40:41], v8 offset:49152
    ds_read_b128 v[196:199], v19 offset:9216
    v_mfma_f32_16x16x32_bf16 v[104:107], v[168:171], v[132:135], v[104:107]
    ds_read_b64_tr_b16 v[42:43], v8 offset:53248
    v_mfma_f32_16x16x32_bf16 v[76:79], v[172:175], v[128:131], v[76:79]
    ds_read_b64_tr_b16 v[44:45], v9 offset:49152
    v_mfma_f32_16x16x32_bf16 v[108:111], v[172:175], v[132:135], v[108:111]
    ds_read_b64_tr_b16 v[46:47], v9 offset:53248
    v_mfma_f32_16x16x32_bf16 v[80:83], v[176:179], v[128:131], v[80:83]
    ds_read_b64_tr_b16 v[48:49], v10 offset:49152
    v_mfma_f32_16x16x32_bf16 v[112:115], v[176:179], v[132:135], v[112:115]
    ds_read_b64_tr_b16 v[50:51], v10 offset:53248
    v_mfma_f32_16x16x32_bf16 v[84:87], v[180:183], v[128:131], v[84:87]
    ds_read_b64_tr_b16 v[52:53], v11 offset:49152
    v_mfma_f32_16x16x32_bf16 v[116:119], v[180:183], v[132:135], v[116:119]
    ds_read_b64_tr_b16 v[54:55], v11 offset:53248
    s_waitcnt lgkmcnt(9)
    v_mfma_f32_16x16x32_bf16 v[56:59], v[24:27], v[136:139], v[56:59]
    ds_read_b64_tr_b16 v[152:153], v4 offset:57344
    ds_read_b128 v[200:203], v19 offset:16384
    v_mfma_f32_16x16x32_bf16 v[88:91], v[24:27], v[140:143], v[88:91]
    ds_read_b64_tr_b16 v[154:155], v4 offset:61440
    v_mfma_f32_16x16x32_bf16 v[60:63], v[28:31], v[136:139], v[60:63]
    ds_read_b64_tr_b16 v[156:157], v5 offset:57344
    v_mfma_f32_16x16x32_bf16 v[92:95], v[28:31], v[140:143], v[92:95]
    ds_read_b64_tr_b16 v[158:159], v5 offset:61440
    v_mfma_f32_16x16x32_bf16 v[64:67], v[32:35], v[136:139], v[64:67]
    ds_read_b64_tr_b16 v[160:161], v6 offset:57344
    v_mfma_f32_16x16x32_bf16 v[96:99], v[32:35], v[140:143], v[96:99]
    ds_read_b64_tr_b16 v[162:163], v6 offset:61440
    v_mfma_f32_16x16x32_bf16 v[68:71], v[36:39], v[136:139], v[68:71]
    ds_read_b64_tr_b16 v[164:165], v7 offset:57344
    v_mfma_f32_16x16x32_bf16 v[100:103], v[36:39], v[140:143], v[100:103]
    ds_read_b64_tr_b16 v[166:167], v7 offset:61440
    s_waitcnt lgkmcnt(9)
    v_mfma_f32_16x16x32_bf16 v[72:75], v[40:43], v[136:139], v[72:75]
    ds_read_b64_tr_b16 v[168:169], v8 offset:57344
    ds_read_b128 v[204:207], v19 offset:17408
    v_mfma_f32_16x16x32_bf16 v[104:107], v[40:43], v[140:143], v[104:107]
    ds_read_b64_tr_b16 v[170:171], v8 offset:61440
    v_mfma_f32_16x16x32_bf16 v[76:79], v[44:47], v[136:139], v[76:79]
    ds_read_b64_tr_b16 v[172:173], v9 offset:57344
    v_mfma_f32_16x16x32_bf16 v[108:111], v[44:47], v[140:143], v[108:111]
    ds_read_b64_tr_b16 v[174:175], v9 offset:61440
    v_mfma_f32_16x16x32_bf16 v[80:83], v[48:51], v[136:139], v[80:83]
    ds_read_b64_tr_b16 v[176:177], v10 offset:57344
    v_mfma_f32_16x16x32_bf16 v[112:115], v[48:51], v[140:143], v[112:115]
    ds_read_b64_tr_b16 v[178:179], v10 offset:61440
    v_mfma_f32_16x16x32_bf16 v[84:87], v[52:55], v[136:139], v[84:87]
    ds_read_b64_tr_b16 v[180:181], v11 offset:57344
    v_mfma_f32_16x16x32_bf16 v[116:119], v[52:55], v[140:143], v[116:119]
    ds_read_b64_tr_b16 v[182:183], v11 offset:61440
    s_waitcnt lgkmcnt(9)
    v_mfma_f32_16x16x32_bf16 v[56:59], v[152:155], v[144:147], v[56:59]
    v_add_u32 v4, 0x10000, v4
    v_add_u32 v5, 0x10000, v5
    v_add_u32 v6, 0x10000, v6
    v_add_u32 v7, 0x10000, v7
    v_add_u32 v8, 0x10000, v8
    v_add_u32 v9, 0x10000, v9
    v_add_u32 v10, 0x10000, v10
    v_add_u32 v11, 0x10000, v11
    ds_read_b64_tr_b16 v[24:25], v4 offset:32768
    ds_read_b128 v[208:211], v19 offset:24576
    v_mfma_f32_16x16x32_bf16 v[88:91], v[152:155], v[148:151], v[88:91]
    ds_read_b64_tr_b16 v[26:27], v4 offset:36864
    v_mfma_f32_16x16x32_bf16 v[60:63], v[156:159], v[144:147], v[60:63]
    ds_read_b64_tr_b16 v[28:29], v5 offset:32768
    v_mfma_f32_16x16x32_bf16 v[92:95], v[156:159], v[148:151], v[92:95]
    ds_read_b64_tr_b16 v[30:31], v5 offset:36864
    v_mfma_f32_16x16x32_bf16 v[64:67], v[160:163], v[144:147], v[64:67]
    ds_read_b64_tr_b16 v[32:33], v6 offset:32768
    v_mfma_f32_16x16x32_bf16 v[96:99], v[160:163], v[148:151], v[96:99]
    ds_read_b64_tr_b16 v[34:35], v6 offset:36864
    v_mfma_f32_16x16x32_bf16 v[68:71], v[164:167], v[144:147], v[68:71]
    ds_read_b64_tr_b16 v[36:37], v7 offset:32768
    v_mfma_f32_16x16x32_bf16 v[100:103], v[164:167], v[148:151], v[100:103]
    ds_read_b64_tr_b16 v[38:39], v7 offset:36864
    s_waitcnt lgkmcnt(9)
    v_mfma_f32_16x16x32_bf16 v[72:75], v[168:171], v[144:147], v[72:75]
    ds_read_b64_tr_b16 v[40:41], v8 offset:32768
    ds_read_b128 v[212:215], v19 offset:25600
    v_mfma_f32_16x16x32_bf16 v[104:107], v[168:171], v[148:151], v[104:107]
    ds_read_b64_tr_b16 v[42:43], v8 offset:36864
    v_mfma_f32_16x16x32_bf16 v[76:79], v[172:175], v[144:147], v[76:79]
    ds_read_b64_tr_b16 v[44:45], v9 offset:32768
    v_mfma_f32_16x16x32_bf16 v[108:111], v[172:175], v[148:151], v[108:111]
    ds_read_b64_tr_b16 v[46:47], v9 offset:36864
    v_mfma_f32_16x16x32_bf16 v[80:83], v[176:179], v[144:147], v[80:83]
    ds_read_b64_tr_b16 v[48:49], v10 offset:32768
    v_mfma_f32_16x16x32_bf16 v[112:115], v[176:179], v[148:151], v[112:115]
    ds_read_b64_tr_b16 v[50:51], v10 offset:36864
    v_mfma_f32_16x16x32_bf16 v[84:87], v[180:183], v[144:147], v[84:87]
    ds_read_b64_tr_b16 v[52:53], v11 offset:32768
    v_mfma_f32_16x16x32_bf16 v[116:119], v[180:183], v[148:151], v[116:119]
    ds_read_b64_tr_b16 v[54:55], v11 offset:36864
    s_barrier
    s_waitcnt lgkmcnt(9)
    v_mfma_f32_16x16x32_bf16 v[56:59], v[24:27], v[184:187], v[56:59]
    ds_read_b64_tr_b16 v[152:153], v4 offset:40960
    s_add_u32 s61, s98, 1
    s_and_b32 s61, s61, 3
    s_mul_i32 s61, s61, 8192
    buffer_load_dwordx4 v[216:219], v23, s[32:35], s61 offen offset:0 sc1
    v_mfma_f32_16x16x32_bf16 v[88:91], v[24:27], v[188:191], v[88:91]
    ds_read_b64_tr_b16 v[154:155], v4 offset:45056
    v_mfma_f32_16x16x32_bf16 v[60:63], v[28:31], v[184:187], v[60:63]
    ds_read_b64_tr_b16 v[156:157], v5 offset:40960
    v_mfma_f32_16x16x32_bf16 v[92:95], v[28:31], v[188:191], v[92:95]
    ds_read_b64_tr_b16 v[158:159], v5 offset:45056
    v_mfma_f32_16x16x32_bf16 v[64:67], v[32:35], v[184:187], v[64:67]
    ds_read_b64_tr_b16 v[160:161], v6 offset:40960
    buffer_load_dwordx4 v[220:223], v23, s[32:35], s61 offen offset:1024 sc1
    v_mfma_f32_16x16x32_bf16 v[96:99], v[32:35], v[188:191], v[96:99]
    ds_read_b64_tr_b16 v[162:163], v6 offset:45056
    v_mfma_f32_16x16x32_bf16 v[68:71], v[36:39], v[184:187], v[68:71]
    ds_read_b64_tr_b16 v[164:165], v7 offset:40960
    v_mfma_f32_16x16x32_bf16 v[100:103], v[36:39], v[188:191], v[100:103]
    ds_read_b64_tr_b16 v[166:167], v7 offset:45056
    s_waitcnt lgkmcnt(8)
    v_mfma_f32_16x16x32_bf16 v[72:75], v[40:43], v[184:187], v[72:75]
    ds_read_b64_tr_b16 v[168:169], v8 offset:40960
    buffer_load_dwordx4 v[224:227], v23, s[32:35], s61 offen offset:2048 sc1
    v_mfma_f32_16x16x32_bf16 v[104:107], v[40:43], v[188:191], v[104:107]
    ds_read_b64_tr_b16 v[170:171], v8 offset:45056
    v_mfma_f32_16x16x32_bf16 v[76:79], v[44:47], v[184:187], v[76:79]
    ds_read_b64_tr_b16 v[172:173], v9 offset:40960
    v_mfma_f32_16x16x32_bf16 v[108:111], v[44:47], v[188:191], v[108:111]
    ds_read_b64_tr_b16 v[174:175], v9 offset:45056
    v_mfma_f32_16x16x32_bf16 v[80:83], v[48:51], v[184:187], v[80:83]
    ds_read_b64_tr_b16 v[176:177], v10 offset:40960
    buffer_load_dwordx4 v[228:231], v23, s[32:35], s61 offen offset:3072 sc1
    v_mfma_f32_16x16x32_bf16 v[112:115], v[48:51], v[188:191], v[112:115]
    ds_read_b64_tr_b16 v[178:179], v10 offset:45056
    v_mfma_f32_16x16x32_bf16 v[84:87], v[52:55], v[184:187], v[84:87]
    ds_read_b64_tr_b16 v[180:181], v11 offset:40960
    v_mfma_f32_16x16x32_bf16 v[116:119], v[52:55], v[188:191], v[116:119]
    ds_read_b64_tr_b16 v[182:183], v11 offset:45056
    s_waitcnt lgkmcnt(8)
    v_mfma_f32_16x16x32_bf16 v[56:59], v[152:155], v[192:195], v[56:59]
    ds_read_b64_tr_b16 v[24:25], v4 offset:49152
    s_add_u32 s61, s61, 4096
    buffer_load_dwordx4 v[232:235], v23, s[32:35], s61 offen offset:0 sc1
    v_mfma_f32_16x16x32_bf16 v[88:91], v[152:155], v[196:199], v[88:91]
    ds_read_b64_tr_b16 v[26:27], v4 offset:53248
    v_mfma_f32_16x16x32_bf16 v[60:63], v[156:159], v[192:195], v[60:63]
    ds_read_b64_tr_b16 v[28:29], v5 offset:49152
    v_mfma_f32_16x16x32_bf16 v[92:95], v[156:159], v[196:199], v[92:95]
    ds_read_b64_tr_b16 v[30:31], v5 offset:53248
    v_mfma_f32_16x16x32_bf16 v[64:67], v[160:163], v[192:195], v[64:67]
    ds_read_b64_tr_b16 v[32:33], v6 offset:49152
    buffer_load_dwordx4 v[236:239], v23, s[32:35], s61 offen offset:1024 sc1
    v_mfma_f32_16x16x32_bf16 v[96:99], v[160:163], v[196:199], v[96:99]
    ds_read_b64_tr_b16 v[34:35], v6 offset:53248
    v_mfma_f32_16x16x32_bf16 v[68:71], v[164:167], v[192:195], v[68:71]
    ds_read_b64_tr_b16 v[36:37], v7 offset:49152
    v_mfma_f32_16x16x32_bf16 v[100:103], v[164:167], v[196:199], v[100:103]
    ds_read_b64_tr_b16 v[38:39], v7 offset:53248
    s_waitcnt lgkmcnt(8)
    v_mfma_f32_16x16x32_bf16 v[72:75], v[168:171], v[192:195], v[72:75]
    ds_read_b64_tr_b16 v[40:41], v8 offset:49152
    buffer_load_dwordx4 v[240:243], v23, s[32:35], s61 offen offset:2048 sc1
    v_mfma_f32_16x16x32_bf16 v[104:107], v[168:171], v[196:199], v[104:107]
    ds_read_b64_tr_b16 v[42:43], v8 offset:53248
    v_mfma_f32_16x16x32_bf16 v[76:79], v[172:175], v[192:195], v[76:79]
    ds_read_b64_tr_b16 v[44:45], v9 offset:49152
    v_mfma_f32_16x16x32_bf16 v[108:111], v[172:175], v[196:199], v[108:111]
    ds_read_b64_tr_b16 v[46:47], v9 offset:53248
    v_mfma_f32_16x16x32_bf16 v[80:83], v[176:179], v[192:195], v[80:83]
    ds_read_b64_tr_b16 v[48:49], v10 offset:49152
    buffer_load_dwordx4 v[244:247], v23, s[32:35], s61 offen offset:3072 sc1
    v_mfma_f32_16x16x32_bf16 v[112:115], v[176:179], v[196:199], v[112:115]
    ds_read_b64_tr_b16 v[50:51], v10 offset:53248
    v_mfma_f32_16x16x32_bf16 v[84:87], v[180:183], v[192:195], v[84:87]
    ds_read_b64_tr_b16 v[52:53], v11 offset:49152
    v_mfma_f32_16x16x32_bf16 v[116:119], v[180:183], v[196:199], v[116:119]
    ds_read_b64_tr_b16 v[54:55], v11 offset:53248
    s_waitcnt lgkmcnt(8)
    v_mfma_f32_16x16x32_bf16 v[56:59], v[24:27], v[200:203], v[56:59]
    ds_read_b64_tr_b16 v[152:153], v4 offset:57344
    s_add_u32 s61, s98, 2
    s_and_b32 s61, s61, 3
    s_mul_i32 s61, s61, 8192
    buffer_load_dwordx4 v[120:123], v23, s[32:35], s61 offen offset:0 sc1
    v_mfma_f32_16x16x32_bf16 v[88:91], v[24:27], v[204:207], v[88:91]
    ds_read_b64_tr_b16 v[154:155], v4 offset:61440
    v_mfma_f32_16x16x32_bf16 v[60:63], v[28:31], v[200:203], v[60:63]
    ds_read_b64_tr_b16 v[156:157], v5 offset:57344
    v_mfma_f32_16x16x32_bf16 v[92:95], v[28:31], v[204:207], v[92:95]
    ds_read_b64_tr_b16 v[158:159], v5 offset:61440
    v_mfma_f32_16x16x32_bf16 v[64:67], v[32:35], v[200:203], v[64:67]
    ds_read_b64_tr_b16 v[160:161], v6 offset:57344
    buffer_load_dwordx4 v[124:127], v23, s[32:35], s61 offen offset:1024 sc1
    v_mfma_f32_16x16x32_bf16 v[96:99], v[32:35], v[204:207], v[96:99]
    ds_read_b64_tr_b16 v[162:163], v6 offset:61440
    v_mfma_f32_16x16x32_bf16 v[68:71], v[36:39], v[200:203], v[68:71]
    ds_read_b64_tr_b16 v[164:165], v7 offset:57344
    v_mfma_f32_16x16x32_bf16 v[100:103], v[36:39], v[204:207], v[100:103]
    ds_read_b64_tr_b16 v[166:167], v7 offset:61440
    s_waitcnt lgkmcnt(8)
    v_mfma_f32_16x16x32_bf16 v[72:75], v[40:43], v[200:203], v[72:75]
    ds_read_b64_tr_b16 v[168:169], v8 offset:57344
    buffer_load_dwordx4 v[128:131], v23, s[32:35], s61 offen offset:2048 sc1
    v_mfma_f32_16x16x32_bf16 v[104:107], v[40:43], v[204:207], v[104:107]
    ds_read_b64_tr_b16 v[170:171], v8 offset:61440
    v_mfma_f32_16x16x32_bf16 v[76:79], v[44:47], v[200:203], v[76:79]
    ds_read_b64_tr_b16 v[172:173], v9 offset:57344
    v_mfma_f32_16x16x32_bf16 v[108:111], v[44:47], v[204:207], v[108:111]
    ds_read_b64_tr_b16 v[174:175], v9 offset:61440
    v_mfma_f32_16x16x32_bf16 v[80:83], v[48:51], v[200:203], v[80:83]
    ds_read_b64_tr_b16 v[176:177], v10 offset:57344
    buffer_load_dwordx4 v[132:135], v23, s[32:35], s61 offen offset:3072 sc1
    v_mfma_f32_16x16x32_bf16 v[112:115], v[48:51], v[204:207], v[112:115]
    ds_read_b64_tr_b16 v[178:179], v10 offset:61440
    v_mfma_f32_16x16x32_bf16 v[84:87], v[52:55], v[200:203], v[84:87]
    ds_read_b64_tr_b16 v[180:181], v11 offset:57344
    v_mfma_f32_16x16x32_bf16 v[116:119], v[52:55], v[204:207], v[116:119]
    ds_read_b64_tr_b16 v[182:183], v11 offset:61440
    s_waitcnt lgkmcnt(8)
    v_mfma_f32_16x16x32_bf16 v[56:59], v[152:155], v[208:211], v[56:59]
    v_add_u32 v4, 0xffff0000, v4
    v_add_u32 v5, 0xffff0000, v5
    v_add_u32 v6, 0xffff0000, v6
    v_add_u32 v7, 0xffff0000, v7
    v_add_u32 v8, 0xffff0000, v8
    v_add_u32 v9, 0xffff0000, v9
    v_add_u32 v10, 0xffff0000, v10
    v_add_u32 v11, 0xffff0000, v11
    s_add_u32 s61, s61, 4096
    buffer_load_dwordx4 v[136:139], v23, s[32:35], s61 offen offset:0 sc1
    v_mfma_f32_16x16x32_bf16 v[88:91], v[152:155], v[212:215], v[88:91]
    buffer_load_dwordx4 v[140:143], v23, s[32:35], s61 offen offset:1024 sc1
    v_mfma_f32_16x16x32_bf16 v[60:63], v[156:159], v[208:211], v[60:63]
    buffer_load_dwordx4 v[144:147], v23, s[32:35], s61 offen offset:2048 sc1
    v_mfma_f32_16x16x32_bf16 v[92:95], v[156:159], v[212:215], v[92:95]
    buffer_load_dwordx4 v[148:151], v23, s[32:35], s61 offen offset:3072 sc1
    v_mfma_f32_16x16x32_bf16 v[64:67], v[160:163], v[208:211], v[64:67]
    v_add_u32 v0, 0x10000, v6
    v_add_u32 v2, 0x20000, v6
    v_add_u32 v1, 0x10000, v7
    v_add_u32 v3, 0x20000, v7
    ds_read_b64_tr_b16 v[24:25], v2 offset:0
    v_mfma_f32_16x16x32_bf16 v[96:99], v[160:163], v[212:215], v[96:99]
    ds_read_b64_tr_b16 v[26:27], v2 offset:4096
    v_mfma_f32_16x16x32_bf16 v[68:71], v[164:167], v[208:211], v[68:71]
    ds_read_b64_tr_b16 v[28:29], v3 offset:0
    v_mfma_f32_16x16x32_bf16 v[100:103], v[164:167], v[212:215], v[100:103]
    ds_read_b64_tr_b16 v[30:31], v3 offset:4096
    s_waitcnt lgkmcnt(4)
    v_mfma_f32_16x16x32_bf16 v[72:75], v[168:171], v[208:211], v[72:75]
    ds_read_b64_tr_b16 v[32:33], v2 offset:8192
    v_mfma_f32_16x16x32_bf16 v[104:107], v[168:171], v[212:215], v[104:107]
    ds_read_b64_tr_b16 v[34:35], v2 offset:12288
    v_mfma_f32_16x16x32_bf16 v[76:79], v[172:175], v[208:211], v[76:79]
    ds_read_b64_tr_b16 v[36:37], v3 offset:8192
    v_mfma_f32_16x16x32_bf16 v[108:111], v[172:175], v[212:215], v[108:111]
    ds_read_b64_tr_b16 v[38:39], v3 offset:12288
    v_mfma_f32_16x16x32_bf16 v[80:83], v[176:179], v[208:211], v[80:83]
    ds_read_b64_tr_b16 v[40:41], v2 offset:16384
    v_mfma_f32_16x16x32_bf16 v[112:115], v[176:179], v[212:215], v[112:115]
    ds_read_b64_tr_b16 v[42:43], v2 offset:20480
    v_mfma_f32_16x16x32_bf16 v[84:87], v[180:183], v[208:211], v[84:87]
    ds_read_b64_tr_b16 v[44:45], v3 offset:16384
    v_mfma_f32_16x16x32_bf16 v[116:119], v[180:183], v[212:215], v[116:119]
    ds_read_b64_tr_b16 v[46:47], v3 offset:20480
    s_waitcnt vmcnt(14)
    s_waitcnt lgkmcnt(8)
    v_mfma_f32_16x16x32_bf16 v[64:67], v[24:27], v[216:219], v[64:67]
    ds_read_b64_tr_b16 v[48:49], v2 offset:24576
    s_add_u32 s61, s98, 3
    s_and_b32 s61, s61, 3
    s_mul_i32 s61, s61, 8192
    buffer_load_dwordx4 v[184:187], v23, s[32:35], s61 offen offset:0 sc1
    v_mfma_f32_16x16x32_bf16 v[96:99], v[24:27], v[220:223], v[96:99]
    ds_read_b64_tr_b16 v[50:51], v2 offset:28672
    v_mfma_f32_16x16x32_bf16 v[68:71], v[28:31], v[216:219], v[68:71]
    ds_read_b64_tr_b16 v[52:53], v3 offset:24576
    buffer_load_dwordx4 v[188:191], v23, s[32:35], s61 offen offset:1024 sc1
    v_mfma_f32_16x16x32_bf16 v[100:103], v[28:31], v[220:223], v[100:103]
    ds_read_b64_tr_b16 v[54:55], v3 offset:28672
    s_waitcnt vmcnt(14)
    s_waitcnt lgkmcnt(8)
    v_mfma_f32_16x16x32_bf16 v[64:67], v[32:35], v[224:227], v[64:67]
    ds_read_b64_tr_b16 v[24:25], v0 offset:0
    buffer_load_dwordx4 v[192:195], v23, s[32:35], s61 offen offset:2048 sc1
    v_mfma_f32_16x16x32_bf16 v[96:99], v[32:35], v[228:231], v[96:99]
    ds_read_b64_tr_b16 v[26:27], v0 offset:4096
    v_mfma_f32_16x16x32_bf16 v[68:71], v[36:39], v[224:227], v[68:71]
    ds_read_b64_tr_b16 v[28:29], v1 offset:0
    buffer_load_dwordx4 v[196:199], v23, s[32:35], s61 offen offset:3072 sc1
    v_mfma_f32_16x16x32_bf16 v[100:103], v[36:39], v[228:231], v[100:103]
    ds_read_b64_tr_b16 v[30:31], v1 offset:4096
    s_waitcnt vmcnt(14)
    s_waitcnt lgkmcnt(8)
    v_mfma_f32_16x16x32_bf16 v[64:67], v[40:43], v[232:235], v[64:67]
    ds_read_b64_tr_b16 v[32:33], v0 offset:8192
    s_add_u32 s61, s61, 4096
    buffer_load_dwordx4 v[200:203], v23, s[32:35], s61 offen offset:0 sc1
    v_mfma_f32_16x16x32_bf16 v[96:99], v[40:43], v[236:239], v[96:99]
    ds_read_b64_tr_b16 v[34:35], v0 offset:12288
    v_mfma_f32_16x16x32_bf16 v[68:71], v[44:47], v[232:235], v[68:71]
    ds_read_b64_tr_b16 v[36:37], v1 offset:8192
    buffer_load_dwordx4 v[204:207], v23, s[32:35], s61 offen offset:1024 sc1
    v_mfma_f32_16x16x32_bf16 v[100:103], v[44:47], v[236:239], v[100:103]
    ds_read_b64_tr_b16 v[38:39], v1 offset:12288
    s_waitcnt vmcnt(14)
    s_waitcnt lgkmcnt(8)
    v_mfma_f32_16x16x32_bf16 v[64:67], v[48:51], v[240:243], v[64:67]
    ds_read_b64_tr_b16 v[40:41], v0 offset:16384
    buffer_load_dwordx4 v[208:211], v23, s[32:35], s61 offen offset:2048 sc1
    v_mfma_f32_16x16x32_bf16 v[96:99], v[48:51], v[244:247], v[96:99]
    ds_read_b64_tr_b16 v[42:43], v0 offset:20480
    v_mfma_f32_16x16x32_bf16 v[68:71], v[52:55], v[240:243], v[68:71]
    ds_read_b64_tr_b16 v[44:45], v1 offset:16384
    buffer_load_dwordx4 v[212:215], v23, s[32:35], s61 offen offset:3072 sc1
    v_mfma_f32_16x16x32_bf16 v[100:103], v[52:55], v[244:247], v[100:103]
    ds_read_b64_tr_b16 v[46:47], v1 offset:20480
    s_waitcnt vmcnt(14)
    s_waitcnt lgkmcnt(8)
    v_mfma_f32_16x16x32_bf16 v[64:67], v[24:27], v[120:123], v[64:67]
    ds_read_b64_tr_b16 v[48:49], v0 offset:24576
    v_mfma_f32_16x16x32_bf16 v[96:99], v[24:27], v[124:127], v[96:99]
    ds_read_b64_tr_b16 v[50:51], v0 offset:28672
    v_mfma_f32_16x16x32_bf16 v[68:71], v[28:31], v[120:123], v[68:71]
    ds_read_b64_tr_b16 v[52:53], v1 offset:24576
    v_mfma_f32_16x16x32_bf16 v[100:103], v[28:31], v[124:127], v[100:103]
    ds_read_b64_tr_b16 v[54:55], v1 offset:28672
    s_barrier
    s_waitcnt vmcnt(12)
    s_waitcnt lgkmcnt(8)
    v_mfma_f32_16x16x32_bf16 v[64:67], v[32:35], v[128:131], v[64:67]
    ds_read_b64_tr_b16 v[24:25], v6 offset:32768
    v_mfma_f32_16x16x32_bf16 v[96:99], v[32:35], v[132:135], v[96:99]
    ds_read_b64_tr_b16 v[26:27], v6 offset:36864
    v_mfma_f32_16x16x32_bf16 v[68:71], v[36:39], v[128:131], v[68:71]
    ds_read_b64_tr_b16 v[28:29], v7 offset:32768
    v_mfma_f32_16x16x32_bf16 v[100:103], v[36:39], v[132:135], v[100:103]
    ds_read_b64_tr_b16 v[30:31], v7 offset:36864
    s_waitcnt vmcnt(10)
    s_waitcnt lgkmcnt(8)
    v_mfma_f32_16x16x32_bf16 v[64:67], v[40:43], v[136:139], v[64:67]
    ds_read_b64_tr_b16 v[32:33], v6 offset:40960
    v_mfma_f32_16x16x32_bf16 v[96:99], v[40:43], v[140:143], v[96:99]
    ds_read_b64_tr_b16 v[34:35], v6 offset:45056
    v_mfma_f32_16x16x32_bf16 v[68:71], v[44:47], v[136:139], v[68:71]
    ds_read_b64_tr_b16 v[36:37], v7 offset:40960
    v_mfma_f32_16x16x32_bf16 v[100:103], v[44:47], v[140:143], v[100:103]
    ds_read_b64_tr_b16 v[38:39], v7 offset:45056
    s_waitcnt vmcnt(8)
    s_waitcnt lgkmcnt(8)
    v_mfma_f32_16x16x32_bf16 v[64:67], v[48:51], v[144:147], v[64:67]
    ds_read_b64_tr_b16 v[40:41], v6 offset:49152
    v_mfma_f32_16x16x32_bf16 v[96:99], v[48:51], v[148:151], v[96:99]
    ds_read_b64_tr_b16 v[42:43], v6 offset:53248
    v_mfma_f32_16x16x32_bf16 v[68:71], v[52:55], v[144:147], v[68:71]
    ds_read_b64_tr_b16 v[44:45], v7 offset:49152
    v_mfma_f32_16x16x32_bf16 v[100:103], v[52:55], v[148:151], v[100:103]
    ds_read_b64_tr_b16 v[46:47], v7 offset:53248
    s_waitcnt vmcnt(6)
    s_waitcnt lgkmcnt(8)
    v_mfma_f32_16x16x32_bf16 v[64:67], v[24:27], v[184:187], v[64:67]
    ds_read_b64_tr_b16 v[48:49], v6 offset:57344
    v_mfma_f32_16x16x32_bf16 v[96:99], v[24:27], v[188:191], v[96:99]
    ds_read_b64_tr_b16 v[50:51], v6 offset:61440
    v_mfma_f32_16x16x32_bf16 v[68:71], v[28:31], v[184:187], v[68:71]
    ds_read_b64_tr_b16 v[52:53], v7 offset:57344
    v_mfma_f32_16x16x32_bf16 v[100:103], v[28:31], v[188:191], v[100:103]
    ds_read_b64_tr_b16 v[54:55], v7 offset:61440
    s_waitcnt vmcnt(4)
    s_waitcnt lgkmcnt(8)
    v_mfma_f32_16x16x32_bf16 v[64:67], v[32:35], v[192:195], v[64:67]
    v_add_u32 v0, 0x10000, v8
    v_add_u32 v2, 0x20000, v8
    v_add_u32 v1, 0x10000, v9
    v_add_u32 v3, 0x20000, v9
    ds_read_b64_tr_b16 v[24:25], v2 offset:0
    v_mfma_f32_16x16x32_bf16 v[96:99], v[32:35], v[196:199], v[96:99]
    ds_read_b64_tr_b16 v[26:27], v2 offset:4096
    v_mfma_f32_16x16x32_bf16 v[68:71], v[36:39], v[192:195], v[68:71]
    ds_read_b64_tr_b16 v[28:29], v3 offset:0
    v_mfma_f32_16x16x32_bf16 v[100:103], v[36:39], v[196:199], v[100:103]
    ds_read_b64_tr_b16 v[30:31], v3 offset:4096
    s_waitcnt vmcnt(2)
    s_waitcnt lgkmcnt(8)
    v_mfma_f32_16x16x32_bf16 v[64:67], v[40:43], v[200:203], v[64:67]
    ds_read_b64_tr_b16 v[32:33], v2 offset:8192
    v_mfma_f32_16x16x32_bf16 v[96:99], v[40:43], v[204:207], v[96:99]
    ds_read_b64_tr_b16 v[34:35], v2 offset:12288
    v_mfma_f32_16x16x32_bf16 v[68:71], v[44:47], v[200:203], v[68:71]
    ds_read_b64_tr_b16 v[36:37], v3 offset:8192
    v_mfma_f32_16x16x32_bf16 v[100:103], v[44:47], v[204:207], v[100:103]
    ds_read_b64_tr_b16 v[38:39], v3 offset:12288
    s_waitcnt vmcnt(0)
    s_waitcnt lgkmcnt(8)
    v_mfma_f32_16x16x32_bf16 v[64:67], v[48:51], v[208:211], v[64:67]
    ds_read_b64_tr_b16 v[40:41], v2 offset:16384
    v_mfma_f32_16x16x32_bf16 v[96:99], v[48:51], v[212:215], v[96:99]
    ds_read_b64_tr_b16 v[42:43], v2 offset:20480
    v_mfma_f32_16x16x32_bf16 v[68:71], v[52:55], v[208:211], v[68:71]
    ds_read_b64_tr_b16 v[44:45], v3 offset:16384
    v_mfma_f32_16x16x32_bf16 v[100:103], v[52:55], v[212:215], v[100:103]
    ds_read_b64_tr_b16 v[46:47], v3 offset:20480
    s_waitcnt lgkmcnt(8)
    v_mfma_f32_16x16x32_bf16 v[72:75], v[24:27], v[216:219], v[72:75]
    ds_read_b64_tr_b16 v[48:49], v2 offset:24576
    v_mfma_f32_16x16x32_bf16 v[104:107], v[24:27], v[220:223], v[104:107]
    ds_read_b64_tr_b16 v[50:51], v2 offset:28672
    v_mfma_f32_16x16x32_bf16 v[76:79], v[28:31], v[216:219], v[76:79]
    ds_read_b64_tr_b16 v[52:53], v3 offset:24576
    v_mfma_f32_16x16x32_bf16 v[108:111], v[28:31], v[220:223], v[108:111]
    ds_read_b64_tr_b16 v[54:55], v3 offset:28672
    s_waitcnt lgkmcnt(8)
    v_mfma_f32_16x16x32_bf16 v[72:75], v[32:35], v[224:227], v[72:75]
    ds_read_b64_tr_b16 v[24:25], v0 offset:0
    v_mfma_f32_16x16x32_bf16 v[104:107], v[32:35], v[228:231], v[104:107]
    ds_read_b64_tr_b16 v[26:27], v0 offset:4096
    v_mfma_f32_16x16x32_bf16 v[76:79], v[36:39], v[224:227], v[76:79]
    ds_read_b64_tr_b16 v[28:29], v1 offset:0
    v_mfma_f32_16x16x32_bf16 v[108:111], v[36:39], v[228:231], v[108:111]
    ds_read_b64_tr_b16 v[30:31], v1 offset:4096
    s_waitcnt lgkmcnt(8)
    v_mfma_f32_16x16x32_bf16 v[72:75], v[40:43], v[232:235], v[72:75]
    ds_read_b64_tr_b16 v[32:33], v0 offset:8192
    v_mov_b32 v155, s99
    v_mfma_f32_16x16x32_bf16 v[104:107], v[40:43], v[236:239], v[104:107]
    ds_read_b64_tr_b16 v[34:35], v0 offset:12288
    v_cvt_pk_bf16_f32 v152, v64, v65
    v_mfma_f32_16x16x32_bf16 v[76:79], v[44:47], v[232:235], v[76:79]
    ds_read_b64_tr_b16 v[36:37], v1 offset:8192
    v_cvt_pk_bf16_f32 v153, v66, v67
    v_mfma_f32_16x16x32_bf16 v[108:111], v[44:47], v[236:239], v[108:111]
    ds_read_b64_tr_b16 v[38:39], v1 offset:12288
    v_cvt_pk_bf16_f32 v154, v68, v69
    s_waitcnt lgkmcnt(8)
    v_mfma_f32_16x16x32_bf16 v[72:75], v[48:51], v[240:243], v[72:75]
    ds_read_b64_tr_b16 v[40:41], v0 offset:16384
    s_xor_b32 s60, s97, 1
    s_lshl_b32 s60, s60, 16
    s_add_u32 s60, s60, s59
    buffer_store_dwordx4 v[152:155], v23, s[36:39], s60 offen offset:0 sc1
    v_mfma_f32_16x16x32_bf16 v[104:107], v[48:51], v[244:247], v[104:107]
    ds_read_b64_tr_b16 v[42:43], v0 offset:20480
    v_mov_b32 v159, s99
    v_mfma_f32_16x16x32_bf16 v[76:79], v[52:55], v[240:243], v[76:79]
    ds_read_b64_tr_b16 v[44:45], v1 offset:16384
    v_cvt_pk_bf16_f32 v156, v70, v71
    v_mfma_f32_16x16x32_bf16 v[108:111], v[52:55], v[244:247], v[108:111]
    ds_read_b64_tr_b16 v[46:47], v1 offset:20480
    v_cvt_pk_bf16_f32 v157, v96, v97
    s_waitcnt lgkmcnt(8)
    v_mfma_f32_16x16x32_bf16 v[72:75], v[24:27], v[120:123], v[72:75]
    ds_read_b64_tr_b16 v[48:49], v0 offset:24576
    v_cvt_pk_bf16_f32 v158, v98, v99
    v_mfma_f32_16x16x32_bf16 v[104:107], v[24:27], v[124:127], v[104:107]
    ds_read_b64_tr_b16 v[50:51], v0 offset:28672
    buffer_store_dwordx4 v[156:159], v23, s[36:39], s60 offen offset:1024 sc1
    v_mfma_f32_16x16x32_bf16 v[76:79], v[28:31], v[120:123], v[76:79]
    ds_read_b64_tr_b16 v[52:53], v1 offset:24576
    v_mov_b32 v163, s99
    v_mfma_f32_16x16x32_bf16 v[108:111], v[28:31], v[124:127], v[108:111]
    ds_read_b64_tr_b16 v[54:55], v1 offset:28672
    v_cvt_pk_bf16_f32 v160, v100, v101
    s_waitcnt lgkmcnt(8)
    v_mfma_f32_16x16x32_bf16 v[72:75], v[32:35], v[128:131], v[72:75]
    ds_read_b64_tr_b16 v[24:25], v8 offset:32768
    v_cvt_pk_bf16_f32 v161, v102, v103
    v_mfma_f32_16x16x32_bf16 v[104:107], v[32:35], v[132:135], v[104:107]
    ds_read_b64_tr_b16 v[26:27], v8 offset:36864
    v_mov_b32 v162, s100
    v_mfma_f32_16x16x32_bf16 v[76:79], v[36:39], v[128:131], v[76:79]
    ds_read_b64_tr_b16 v[28:29], v9 offset:32768
    buffer_store_dwordx4 v[160:163], v23, s[36:39], s60 offen offset:2048 sc1
    v_mfma_f32_16x16x32_bf16 v[108:111], v[36:39], v[132:135], v[108:111]
    ds_read_b64_tr_b16 v[30:31], v9 offset:36864
    s_waitcnt lgkmcnt(8)
    v_mfma_f32_16x16x32_bf16 v[72:75], v[40:43], v[136:139], v[72:75]
    ds_read_b64_tr_b16 v[32:33], v8 offset:40960
    v_mfma_f32_16x16x32_bf16 v[104:107], v[40:43], v[140:143], v[104:107]
    ds_read_b64_tr_b16 v[34:35], v8 offset:45056
    v_mfma_f32_16x16x32_bf16 v[76:79], v[44:47], v[136:139], v[76:79]
    ds_read_b64_tr_b16 v[36:37], v9 offset:40960
    v_mfma_f32_16x16x32_bf16 v[108:111], v[44:47], v[140:143], v[108:111]
    ds_read_b64_tr_b16 v[38:39], v9 offset:45056
    s_waitcnt lgkmcnt(8)
    v_mfma_f32_16x16x32_bf16 v[72:75], v[48:51], v[144:147], v[72:75]
    ds_read_b64_tr_b16 v[40:41], v8 offset:49152
    v_mfma_f32_16x16x32_bf16 v[104:107], v[48:51], v[148:151], v[104:107]
    ds_read_b64_tr_b16 v[42:43], v8 offset:53248
    v_mfma_f32_16x16x32_bf16 v[76:79], v[52:55], v[144:147], v[76:79]
    ds_read_b64_tr_b16 v[44:45], v9 offset:49152
    v_mfma_f32_16x16x32_bf16 v[108:111], v[52:55], v[148:151], v[108:111]
    ds_read_b64_tr_b16 v[46:47], v9 offset:53248
    s_waitcnt lgkmcnt(8)
    v_mfma_f32_16x16x32_bf16 v[72:75], v[24:27], v[184:187], v[72:75]
    ds_read_b64_tr_b16 v[48:49], v8 offset:57344
    v_mfma_f32_16x16x32_bf16 v[104:107], v[24:27], v[188:191], v[104:107]
    ds_read_b64_tr_b16 v[50:51], v8 offset:61440
    v_mfma_f32_16x16x32_bf16 v[76:79], v[28:31], v[184:187], v[76:79]
    ds_read_b64_tr_b16 v[52:53], v9 offset:57344
    v_mfma_f32_16x16x32_bf16 v[108:111], v[28:31], v[188:191], v[108:111]
    ds_read_b64_tr_b16 v[54:55], v9 offset:61440
    s_waitcnt lgkmcnt(8)
    v_mfma_f32_16x16x32_bf16 v[72:75], v[32:35], v[192:195], v[72:75]
    v_add_u32 v0, 0x10000, v10
    v_add_u32 v2, 0x20000, v10
    v_add_u32 v1, 0x10000, v11
    v_add_u32 v3, 0x20000, v11
    ds_read_b64_tr_b16 v[24:25], v2 offset:0
    v_mfma_f32_16x16x32_bf16 v[104:107], v[32:35], v[196:199], v[104:107]
    ds_read_b64_tr_b16 v[26:27], v2 offset:4096
    v_mfma_f32_16x16x32_bf16 v[76:79], v[36:39], v[192:195], v[76:79]
    ds_read_b64_tr_b16 v[28:29], v3 offset:0
    v_mfma_f32_16x16x32_bf16 v[108:111], v[36:39], v[196:199], v[108:111]
    ds_read_b64_tr_b16 v[30:31], v3 offset:4096
    s_waitcnt lgkmcnt(8)
    v_mfma_f32_16x16x32_bf16 v[72:75], v[40:43], v[200:203], v[72:75]
    ds_read_b64_tr_b16 v[32:33], v2 offset:8192
    v_mfma_f32_16x16x32_bf16 v[104:107], v[40:43], v[204:207], v[104:107]
    ds_read_b64_tr_b16 v[34:35], v2 offset:12288
    v_mfma_f32_16x16x32_bf16 v[76:79], v[44:47], v[200:203], v[76:79]
    ds_read_b64_tr_b16 v[36:37], v3 offset:8192
    v_mfma_f32_16x16x32_bf16 v[108:111], v[44:47], v[204:207], v[108:111]
    ds_read_b64_tr_b16 v[38:39], v3 offset:12288
    s_waitcnt lgkmcnt(8)
    v_mfma_f32_16x16x32_bf16 v[72:75], v[48:51], v[208:211], v[72:75]
    ds_read_b64_tr_b16 v[40:41], v2 offset:16384
    v_mfma_f32_16x16x32_bf16 v[104:107], v[48:51], v[212:215], v[104:107]
    ds_read_b64_tr_b16 v[42:43], v2 offset:20480
    v_mfma_f32_16x16x32_bf16 v[76:79], v[52:55], v[208:211], v[76:79]
    ds_read_b64_tr_b16 v[44:45], v3 offset:16384
    v_mfma_f32_16x16x32_bf16 v[108:111], v[52:55], v[212:215], v[108:111]
    ds_read_b64_tr_b16 v[46:47], v3 offset:20480
    s_waitcnt lgkmcnt(8)
    v_mfma_f32_16x16x32_bf16 v[80:83], v[24:27], v[216:219], v[80:83]
    ds_read_b64_tr_b16 v[48:49], v2 offset:24576
    v_mfma_f32_16x16x32_bf16 v[112:115], v[24:27], v[220:223], v[112:115]
    ds_read_b64_tr_b16 v[50:51], v2 offset:28672
    v_mfma_f32_16x16x32_bf16 v[84:87], v[28:31], v[216:219], v[84:87]
    ds_read_b64_tr_b16 v[52:53], v3 offset:24576
    v_mfma_f32_16x16x32_bf16 v[116:119], v[28:31], v[220:223], v[116:119]
    ds_read_b64_tr_b16 v[54:55], v3 offset:28672
    s_waitcnt lgkmcnt(8)
    v_mfma_f32_16x16x32_bf16 v[80:83], v[32:35], v[224:227], v[80:83]
    ds_read_b64_tr_b16 v[24:25], v0 offset:0
    v_mfma_f32_16x16x32_bf16 v[112:115], v[32:35], v[228:231], v[112:115]
    ds_read_b64_tr_b16 v[26:27], v0 offset:4096
    v_mfma_f32_16x16x32_bf16 v[84:87], v[36:39], v[224:227], v[84:87]
    ds_read_b64_tr_b16 v[28:29], v1 offset:0
    v_mfma_f32_16x16x32_bf16 v[116:119], v[36:39], v[228:231], v[116:119]
    ds_read_b64_tr_b16 v[30:31], v1 offset:4096
    s_waitcnt lgkmcnt(8)
    v_mfma_f32_16x16x32_bf16 v[80:83], v[40:43], v[232:235], v[80:83]
    ds_read_b64_tr_b16 v[32:33], v0 offset:8192
    v_mov_b32 v167, s99
    v_mfma_f32_16x16x32_bf16 v[112:115], v[40:43], v[236:239], v[112:115]
    ds_read_b64_tr_b16 v[34:35], v0 offset:12288
    v_cvt_pk_bf16_f32 v164, v72, v73
    v_mfma_f32_16x16x32_bf16 v[84:87], v[44:47], v[232:235], v[84:87]
    ds_read_b64_tr_b16 v[36:37], v1 offset:8192
    v_cvt_pk_bf16_f32 v165, v74, v75
    v_mfma_f32_16x16x32_bf16 v[116:119], v[44:47], v[236:239], v[116:119]
    ds_read_b64_tr_b16 v[38:39], v1 offset:12288
    v_cvt_pk_bf16_f32 v166, v76, v77
    s_waitcnt lgkmcnt(8)
    v_mfma_f32_16x16x32_bf16 v[80:83], v[48:51], v[240:243], v[80:83]
    ds_read_b64_tr_b16 v[40:41], v0 offset:16384
    s_xor_b32 s60, s97, 2
    s_lshl_b32 s60, s60, 16
    s_add_u32 s60, s60, s59
    buffer_store_dwordx4 v[164:167], v23, s[36:39], s60 offen offset:0 sc1
    v_mfma_f32_16x16x32_bf16 v[112:115], v[48:51], v[244:247], v[112:115]
    ds_read_b64_tr_b16 v[42:43], v0 offset:20480
    v_mov_b32 v171, s99
    v_mfma_f32_16x16x32_bf16 v[84:87], v[52:55], v[240:243], v[84:87]
    ds_read_b64_tr_b16 v[44:45], v1 offset:16384
    v_cvt_pk_bf16_f32 v168, v78, v79
    v_mfma_f32_16x16x32_bf16 v[116:119], v[52:55], v[244:247], v[116:119]
    ds_read_b64_tr_b16 v[46:47], v1 offset:20480
    v_cvt_pk_bf16_f32 v169, v104, v105
    s_waitcnt lgkmcnt(8)
    v_mfma_f32_16x16x32_bf16 v[80:83], v[24:27], v[120:123], v[80:83]
    ds_read_b64_tr_b16 v[48:49], v0 offset:24576
    v_cvt_pk_bf16_f32 v170, v106, v107
    v_mfma_f32_16x16x32_bf16 v[112:115], v[24:27], v[124:127], v[112:115]
    ds_read_b64_tr_b16 v[50:51], v0 offset:28672
    buffer_store_dwordx4 v[168:171], v23, s[36:39], s60 offen offset:1024 sc1
    v_mfma_f32_16x16x32_bf16 v[84:87], v[28:31], v[120:123], v[84:87]
    ds_read_b64_tr_b16 v[52:53], v1 offset:24576
    v_mov_b32 v175, s99
    v_mfma_f32_16x16x32_bf16 v[116:119], v[28:31], v[124:127], v[116:119]
    ds_read_b64_tr_b16 v[54:55], v1 offset:28672
    v_cvt_pk_bf16_f32 v172, v108, v109
    s_waitcnt lgkmcnt(8)
    v_mfma_f32_16x16x32_bf16 v[80:83], v[32:35], v[128:131], v[80:83]
    ds_read_b64_tr_b16 v[24:25], v10 offset:32768
    v_cvt_pk_bf16_f32 v173, v110, v111
    v_mfma_f32_16x16x32_bf16 v[112:115], v[32:35], v[132:135], v[112:115]
    ds_read_b64_tr_b16 v[26:27], v10 offset:36864
    v_mov_b32 v174, s100
    v_mfma_f32_16x16x32_bf16 v[84:87], v[36:39], v[128:131], v[84:87]
    ds_read_b64_tr_b16 v[28:29], v11 offset:32768
    buffer_store_dwordx4 v[172:175], v23, s[36:39], s60 offen offset:2048 sc1
    v_mfma_f32_16x16x32_bf16 v[116:119], v[36:39], v[132:135], v[116:119]
    ds_read_b64_tr_b16 v[30:31], v11 offset:36864
    s_waitcnt lgkmcnt(8)
    v_mfma_f32_16x16x32_bf16 v[80:83], v[40:43], v[136:139], v[80:83]
    ds_read_b64_tr_b16 v[32:33], v10 offset:40960
    v_mfma_f32_16x16x32_bf16 v[112:115], v[40:43], v[140:143], v[112:115]
    ds_read_b64_tr_b16 v[34:35], v10 offset:45056
    v_mfma_f32_16x16x32_bf16 v[84:87], v[44:47], v[136:139], v[84:87]
    ds_read_b64_tr_b16 v[36:37], v11 offset:40960
    v_mfma_f32_16x16x32_bf16 v[116:119], v[44:47], v[140:143], v[116:119]
    ds_read_b64_tr_b16 v[38:39], v11 offset:45056
    s_waitcnt lgkmcnt(8)
    v_mfma_f32_16x16x32_bf16 v[80:83], v[48:51], v[144:147], v[80:83]
    ds_read_b64_tr_b16 v[40:41], v10 offset:49152
    v_mfma_f32_16x16x32_bf16 v[112:115], v[48:51], v[148:151], v[112:115]
    ds_read_b64_tr_b16 v[42:43], v10 offset:53248
    v_mfma_f32_16x16x32_bf16 v[84:87], v[52:55], v[144:147], v[84:87]
    ds_read_b64_tr_b16 v[44:45], v11 offset:49152
    v_mfma_f32_16x16x32_bf16 v[116:119], v[52:55], v[148:151], v[116:119]
    ds_read_b64_tr_b16 v[46:47], v11 offset:53248
    s_waitcnt lgkmcnt(8)
    v_mfma_f32_16x16x32_bf16 v[80:83], v[24:27], v[184:187], v[80:83]
    ds_read_b64_tr_b16 v[48:49], v10 offset:57344
    v_mfma_f32_16x16x32_bf16 v[112:115], v[24:27], v[188:191], v[112:115]
    ds_read_b64_tr_b16 v[50:51], v10 offset:61440
    v_mfma_f32_16x16x32_bf16 v[84:87], v[28:31], v[184:187], v[84:87]
    ds_read_b64_tr_b16 v[52:53], v11 offset:57344
    v_mfma_f32_16x16x32_bf16 v[116:119], v[28:31], v[188:191], v[116:119]
    ds_read_b64_tr_b16 v[54:55], v11 offset:61440
    s_waitcnt lgkmcnt(8)
    v_mfma_f32_16x16x32_bf16 v[80:83], v[32:35], v[192:195], v[80:83]
    v_add_u32 v0, 0x10000, v4
    v_add_u32 v2, 0x20000, v4
    v_add_u32 v1, 0x10000, v5
    v_add_u32 v3, 0x20000, v5
    ds_read_b64_tr_b16 v[24:25], v2 offset:0
    v_mfma_f32_16x16x32_bf16 v[112:115], v[32:35], v[196:199], v[112:115]
    ds_read_b64_tr_b16 v[26:27], v2 offset:4096
    v_mfma_f32_16x16x32_bf16 v[84:87], v[36:39], v[192:195], v[84:87]
    ds_read_b64_tr_b16 v[28:29], v3 offset:0
    v_mfma_f32_16x16x32_bf16 v[116:119], v[36:39], v[196:199], v[116:119]
    ds_read_b64_tr_b16 v[30:31], v3 offset:4096
    s_waitcnt lgkmcnt(8)
    v_mfma_f32_16x16x32_bf16 v[80:83], v[40:43], v[200:203], v[80:83]
    ds_read_b64_tr_b16 v[32:33], v2 offset:8192
    v_mfma_f32_16x16x32_bf16 v[112:115], v[40:43], v[204:207], v[112:115]
    ds_read_b64_tr_b16 v[34:35], v2 offset:12288
    v_mfma_f32_16x16x32_bf16 v[84:87], v[44:47], v[200:203], v[84:87]
    ds_read_b64_tr_b16 v[36:37], v3 offset:8192
    v_mfma_f32_16x16x32_bf16 v[116:119], v[44:47], v[204:207], v[116:119]
    ds_read_b64_tr_b16 v[38:39], v3 offset:12288
    s_waitcnt lgkmcnt(8)
    v_mfma_f32_16x16x32_bf16 v[80:83], v[48:51], v[208:211], v[80:83]
    ds_read_b64_tr_b16 v[40:41], v2 offset:16384
    v_mfma_f32_16x16x32_bf16 v[112:115], v[48:51], v[212:215], v[112:115]
    ds_read_b64_tr_b16 v[42:43], v2 offset:20480
    v_mfma_f32_16x16x32_bf16 v[84:87], v[52:55], v[208:211], v[84:87]
    ds_read_b64_tr_b16 v[44:45], v3 offset:16384
    v_mfma_f32_16x16x32_bf16 v[116:119], v[52:55], v[212:215], v[116:119]
    ds_read_b64_tr_b16 v[46:47], v3 offset:20480
    s_waitcnt lgkmcnt(8)
    v_mfma_f32_16x16x32_bf16 v[56:59], v[24:27], v[216:219], v[56:59]
    ds_read_b64_tr_b16 v[48:49], v2 offset:24576
    v_mfma_f32_16x16x32_bf16 v[88:91], v[24:27], v[220:223], v[88:91]
    ds_read_b64_tr_b16 v[50:51], v2 offset:28672
    v_mfma_f32_16x16x32_bf16 v[60:63], v[28:31], v[216:219], v[60:63]
    ds_read_b64_tr_b16 v[52:53], v3 offset:24576
    v_mfma_f32_16x16x32_bf16 v[92:95], v[28:31], v[220:223], v[92:95]
    ds_read_b64_tr_b16 v[54:55], v3 offset:28672
    s_waitcnt lgkmcnt(8)
    v_mfma_f32_16x16x32_bf16 v[56:59], v[32:35], v[224:227], v[56:59]
    ds_read_b64_tr_b16 v[24:25], v0 offset:0
    v_mfma_f32_16x16x32_bf16 v[88:91], v[32:35], v[228:231], v[88:91]
    ds_read_b64_tr_b16 v[26:27], v0 offset:4096
    v_mfma_f32_16x16x32_bf16 v[60:63], v[36:39], v[224:227], v[60:63]
    ds_read_b64_tr_b16 v[28:29], v1 offset:0
    v_mfma_f32_16x16x32_bf16 v[92:95], v[36:39], v[228:231], v[92:95]
    ds_read_b64_tr_b16 v[30:31], v1 offset:4096
    s_waitcnt lgkmcnt(8)
    v_mfma_f32_16x16x32_bf16 v[56:59], v[40:43], v[232:235], v[56:59]
    ds_read_b64_tr_b16 v[32:33], v0 offset:8192
    v_mov_b32 v179, s99
    v_mfma_f32_16x16x32_bf16 v[88:91], v[40:43], v[236:239], v[88:91]
    ds_read_b64_tr_b16 v[34:35], v0 offset:12288
    v_cvt_pk_bf16_f32 v176, v80, v81
    v_mfma_f32_16x16x32_bf16 v[60:63], v[44:47], v[232:235], v[60:63]
    ds_read_b64_tr_b16 v[36:37], v1 offset:8192
    v_cvt_pk_bf16_f32 v177, v82, v83
    v_mfma_f32_16x16x32_bf16 v[92:95], v[44:47], v[236:239], v[92:95]
    ds_read_b64_tr_b16 v[38:39], v1 offset:12288
    v_cvt_pk_bf16_f32 v178, v84, v85
    s_waitcnt lgkmcnt(8)
    v_mfma_f32_16x16x32_bf16 v[56:59], v[48:51], v[240:243], v[56:59]
    ds_read_b64_tr_b16 v[40:41], v0 offset:16384
    s_xor_b32 s60, s97, 3
    s_lshl_b32 s60, s60, 16
    s_add_u32 s60, s60, s59
    buffer_store_dwordx4 v[176:179], v23, s[36:39], s60 offen offset:0 sc1
    v_mfma_f32_16x16x32_bf16 v[88:91], v[48:51], v[244:247], v[88:91]
    ds_read_b64_tr_b16 v[42:43], v0 offset:20480
    v_mov_b32 v183, s99
    v_mfma_f32_16x16x32_bf16 v[60:63], v[52:55], v[240:243], v[60:63]
    ds_read_b64_tr_b16 v[44:45], v1 offset:16384
    v_cvt_pk_bf16_f32 v180, v86, v87
    v_mfma_f32_16x16x32_bf16 v[92:95], v[52:55], v[244:247], v[92:95]
    ds_read_b64_tr_b16 v[46:47], v1 offset:20480
    v_cvt_pk_bf16_f32 v181, v112, v113
    s_waitcnt lgkmcnt(8)
    v_mfma_f32_16x16x32_bf16 v[56:59], v[24:27], v[120:123], v[56:59]
    ds_read_b64_tr_b16 v[48:49], v0 offset:24576
    v_cvt_pk_bf16_f32 v182, v114, v115
    v_mfma_f32_16x16x32_bf16 v[88:91], v[24:27], v[124:127], v[88:91]
    ds_read_b64_tr_b16 v[50:51], v0 offset:28672
    buffer_store_dwordx4 v[180:183], v23, s[36:39], s60 offen offset:1024 sc1
    v_mfma_f32_16x16x32_bf16 v[60:63], v[28:31], v[120:123], v[60:63]
    ds_read_b64_tr_b16 v[52:53], v1 offset:24576
    v_mov_b32 v67, s99
    v_mfma_f32_16x16x32_bf16 v[92:95], v[28:31], v[124:127], v[92:95]
    ds_read_b64_tr_b16 v[54:55], v1 offset:28672
    v_cvt_pk_bf16_f32 v64, v116, v117
    s_waitcnt lgkmcnt(8)
    v_mfma_f32_16x16x32_bf16 v[56:59], v[32:35], v[128:131], v[56:59]
    ds_read_b64_tr_b16 v[24:25], v4 offset:32768
    v_cvt_pk_bf16_f32 v65, v118, v119
    v_mfma_f32_16x16x32_bf16 v[88:91], v[32:35], v[132:135], v[88:91]
    ds_read_b64_tr_b16 v[26:27], v4 offset:36864
    v_mov_b32 v66, s100
    v_mfma_f32_16x16x32_bf16 v[60:63], v[36:39], v[128:131], v[60:63]
    ds_read_b64_tr_b16 v[28:29], v5 offset:32768
    buffer_store_dwordx4 v[64:67], v23, s[36:39], s60 offen offset:2048 sc1
    v_mfma_f32_16x16x32_bf16 v[92:95], v[36:39], v[132:135], v[92:95]
    ds_read_b64_tr_b16 v[30:31], v5 offset:36864
    s_waitcnt lgkmcnt(8)
    v_mfma_f32_16x16x32_bf16 v[56:59], v[40:43], v[136:139], v[56:59]
    ds_read_b64_tr_b16 v[32:33], v4 offset:40960
    v_mfma_f32_16x16x32_bf16 v[88:91], v[40:43], v[140:143], v[88:91]
    ds_read_b64_tr_b16 v[34:35], v4 offset:45056
    v_mfma_f32_16x16x32_bf16 v[60:63], v[44:47], v[136:139], v[60:63]
    ds_read_b64_tr_b16 v[36:37], v5 offset:40960
    v_mfma_f32_16x16x32_bf16 v[92:95], v[44:47], v[140:143], v[92:95]
    ds_read_b64_tr_b16 v[38:39], v5 offset:45056
    s_waitcnt lgkmcnt(8)
    v_mfma_f32_16x16x32_bf16 v[56:59], v[48:51], v[144:147], v[56:59]
    ds_read_b64_tr_b16 v[40:41], v4 offset:49152
    v_mfma_f32_16x16x32_bf16 v[88:91], v[48:51], v[148:151], v[88:91]
    ds_read_b64_tr_b16 v[42:43], v4 offset:53248
    v_mfma_f32_16x16x32_bf16 v[60:63], v[52:55], v[144:147], v[60:63]
    ds_read_b64_tr_b16 v[44:45], v5 offset:49152
    v_mfma_f32_16x16x32_bf16 v[92:95], v[52:55], v[148:151], v[92:95]
    ds_read_b64_tr_b16 v[46:47], v5 offset:53248
    s_waitcnt lgkmcnt(8)
    v_mfma_f32_16x16x32_bf16 v[56:59], v[24:27], v[184:187], v[56:59]
    ds_read_b64_tr_b16 v[48:49], v4 offset:57344
    v_mfma_f32_16x16x32_bf16 v[88:91], v[24:27], v[188:191], v[88:91]
    ds_read_b64_tr_b16 v[50:51], v4 offset:61440
    v_mfma_f32_16x16x32_bf16 v[60:63], v[28:31], v[184:187], v[60:63]
    ds_read_b64_tr_b16 v[52:53], v5 offset:57344
    v_mfma_f32_16x16x32_bf16 v[92:95], v[28:31], v[188:191], v[92:95]
    ds_read_b64_tr_b16 v[54:55], v5 offset:61440
    s_waitcnt lgkmcnt(8)
    v_mfma_f32_16x16x32_bf16 v[56:59], v[32:35], v[192:195], v[56:59]
    v_mfma_f32_16x16x32_bf16 v[88:91], v[32:35], v[196:199], v[88:91]
    v_mfma_f32_16x16x32_bf16 v[60:63], v[36:39], v[192:195], v[60:63]
    v_mfma_f32_16x16x32_bf16 v[92:95], v[36:39], v[196:199], v[92:95]
    s_waitcnt lgkmcnt(4)
    v_mfma_f32_16x16x32_bf16 v[56:59], v[40:43], v[200:203], v[56:59]
    v_mfma_f32_16x16x32_bf16 v[88:91], v[40:43], v[204:207], v[88:91]
    v_mfma_f32_16x16x32_bf16 v[60:63], v[44:47], v[200:203], v[60:63]
    v_mfma_f32_16x16x32_bf16 v[92:95], v[44:47], v[204:207], v[92:95]
    s_waitcnt lgkmcnt(0)
    v_mfma_f32_16x16x32_bf16 v[56:59], v[48:51], v[208:211], v[56:59]
    v_mfma_f32_16x16x32_bf16 v[88:91], v[48:51], v[212:215], v[88:91]
    v_mfma_f32_16x16x32_bf16 v[60:63], v[52:55], v[208:211], v[60:63]
    v_mfma_f32_16x16x32_bf16 v[92:95], v[52:55], v[212:215], v[92:95]
    s_mov_b32 s63, 0x200000
    s_xor_b32 s60, s97, 1
    s_lshl_b32 s60, s60, 14
    s_add_u32 s60, s60, s58
    buffer_load_dwordx4 v[68:71], v23, s[36:39], s60 offen offset:0 sc1
    buffer_load_dwordx4 v[96:99], v23, s[36:39], s60 offen offset:1024 sc1
    buffer_load_dwordx4 v[100:103], v23, s[36:39], s60 offen offset:2048 sc1
    s_xor_b32 s60, s97, 2
    s_lshl_b32 s60, s60, 14
    s_add_u32 s60, s60, s58
    buffer_load_dwordx4 v[72:75], v23, s[36:39], s60 offen offset:0 sc1
    buffer_load_dwordx4 v[76:79], v23, s[36:39], s60 offen offset:1024 sc1
    buffer_load_dwordx4 v[104:107], v23, s[36:39], s60 offen offset:2048 sc1
    s_waitcnt vmcnt(6)
    s_xor_b32 s60, s97, 3
    s_lshl_b32 s60, s60, 14
    s_add_u32 s60, s60, s58
    buffer_load_dwordx4 v[80:83], v23, s[36:39], s60 offen offset:0 sc1
    buffer_load_dwordx4 v[84:87], v23, s[36:39], s60 offen offset:1024 sc1
    buffer_load_dwordx4 v[112:115], v23, s[36:39], s60 offen offset:2048 sc1
L_pp:
    s_waitcnt vmcnt(0)
    v_xor_b32 v19, s99, v71
    v_xor_b32 v20, s99, v99
    v_or_b32 v19, v19, v20
    v_xor_b32 v20, s99, v103
    v_or_b32 v19, v19, v20
    v_xor_b32 v20, s99, v75
    v_or_b32 v19, v19, v20
    v_xor_b32 v20, s99, v79
    v_or_b32 v19, v19, v20
    v_xor_b32 v20, s99, v107
    v_or_b32 v19, v19, v20
    v_xor_b32 v20, s99, v83
    v_or_b32 v19, v19, v20
    v_xor_b32 v20, s99, v87
    v_or_b32 v19, v19, v20
    v_xor_b32 v20, s99, v115
    v_or_b32 v19, v19, v20
    v_xor_b32 v20, s100, v102
    v_or_b32 v19, v19, v20
    v_xor_b32 v20, s100, v106
    v_or_b32 v19, v19, v20
    v_xor_b32 v20, s100, v114
    v_or_b32 v19, v19, v20
    v_cmp_ne_u32 vcc, 0, v19
    s_cbranch_vccz L_ppd
    s_sleep 2
    s_xor_b32 s60, s97, 1
    s_lshl_b32 s60, s60, 14
    s_add_u32 s60, s60, s58
    buffer_load_dwordx4 v[68:71], v23, s[36:39], s60 offen offset:0 sc1
    buffer_load_dwordx4 v[96:99], v23, s[36:39], s60 offen offset:1024 sc1
    buffer_load_dwordx4 v[100:103], v23, s[36:39], s60 offen offset:2048 sc1
    s_xor_b32 s60, s97, 2
    s_lshl_b32 s60, s60, 14
    s_add_u32 s60, s60, s58
    buffer_load_dwordx4 v[72:75], v23, s[36:39], s60 offen offset:0 sc1
    buffer_load_dwordx4 v[76:79], v23, s[36:39], s60 offen offset:1024 sc1
    buffer_load_dwordx4 v[104:107], v23, s[36:39], s60 offen offset:2048 sc1
    s_xor_b32 s60, s97, 3
    s_lshl_b32 s60, s60, 14
    s_add_u32 s60, s60, s58
    buffer_load_dwordx4 v[80:83], v23, s[36:39], s60 offen offset:0 sc1
    buffer_load_dwordx4 v[84:87], v23, s[36:39], s60 offen offset:1024 sc1
    buffer_load_dwordx4 v[112:115], v23, s[36:39], s60 offen offset:2048 sc1
    s_sub_u32 s63, s63, 1
    s_cmp_lg_u32 s63, 0
    s_cbranch_scc1 L_pp
    s_branch L_end
L_ppd:
    s_mov_b32 s60, 0x8000
    v_lshlrev_b32 v19, 16, v68
    v_and_b32 v20, 0xffff0000, v68
    v_add_f32 v56, v56, v19
    v_add_f32 v57, v57, v20
    v_lshlrev_b32 v19, 16, v69
    v_and_b32 v20, 0xffff0000, v69
    v_add_f32 v58, v58, v19
    v_add_f32 v59, v59, v20
    v_lshlrev_b32 v19, 16, v70
    v_and_b32 v20, 0xffff0000, v70
    v_add_f32 v60, v60, v19
    v_add_f32 v61, v61, v20
    v_lshlrev_b32 v19, 16, v96
    v_and_b32 v20, 0xffff0000, v96
    v_add_f32 v62, v62, v19
    v_add_f32 v63, v63, v20
    v_lshlrev_b32 v19, 16, v97
    v_and_b32 v20, 0xffff0000, v97
    v_add_f32 v88, v88, v19
    v_add_f32 v89, v89, v20
    v_lshlrev_b32 v19, 16, v98
    v_and_b32 v20, 0xffff0000, v98
    v_add_f32 v90, v90, v19
    v_add_f32 v91, v91, v20
    v_lshlrev_b32 v19, 16, v100
    v_and_b32 v20, 0xffff0000, v100
    v_add_f32 v92, v92, v19
    v_add_f32 v93, v93, v20
    v_lshlrev_b32 v19, 16, v101
    v_and_b32 v20, 0xffff0000, v101
    v_add_f32 v94, v94, v19
    v_add_f32 v95, v95, v20
    v_lshlrev_b32 v19, 16, v72
    v_and_b32 v20, 0xffff0000, v72
    v_add_f32 v56, v56, v19
    v_add_f32 v57, v57, v20
    v_lshlrev_b32 v19, 16, v73
    v_and_b32 v20, 0xffff0000, v73
    v_add_f32 v58, v58, v19
    v_add_f32 v59, v59, v20
    v_lshlrev_b32 v19, 16, v74
    v_and_b32 v20, 0xffff0000, v74
    v_add_f32 v60, v60, v19
    v_add_f32 v61, v61, v20
    v_lshlrev_b32 v19, 16, v76
    v_and_b32 v20, 0xffff0000, v76
    v_add_f32 v62, v62, v19
    v_add_f32 v63, v63, v20
    v_lshlrev_b32 v19, 16, v77
    v_and_b32 v20, 0xffff0000, v77
    v_add_f32 v88, v88, v19
    v_add_f32 v89, v89, v20
    v_lshlrev_b32 v19, 16, v78
    v_and_b32 v20, 0xffff0000, v78
    v_add_f32 v90, v90, v19
    v_add_f32 v91, v91, v20
    v_lshlrev_b32 v19, 16, v104
    v_and_b32 v20, 0xffff0000, v104
    v_add_f32 v92, v92, v19
    v_add_f32 v93, v93, v20
    v_lshlrev_b32 v19, 16, v105
    v_and_b32 v20, 0xffff0000, v105
    v_add_f32 v94, v94, v19
    v_add_f32 v95, v95, v20
    v_lshlrev_b32 v19, 16, v80
    v_and_b32 v20, 0xffff0000, v80
    v_add_f32 v56, v56, v19
    v_add_f32 v57, v57, v20
    v_lshlrev_b32 v19, 16, v81
    v_and_b32 v20, 0xffff0000, v81
    v_add_f32 v58, v58, v19
    v_add_f32 v59, v59, v20
    v_lshlrev_b32 v19, 16, v82
    v_and_b32 v20, 0xffff0000, v82
    v_add_f32 v60, v60, v19
    v_add_f32 v61, v61, v20
    v_lshlrev_b32 v19, 16, v84
    v_and_b32 v20, 0xffff0000, v84
    v_add_f32 v62, v62, v19
    v_add_f32 v63, v63, v20
    v_lshlrev_b32 v19, 16, v85
    v_and_b32 v20, 0xffff0000, v85
    v_add_f32 v88, v88, v19
    v_add_f32 v89, v89, v20
    v_lshlrev_b32 v19, 16, v86
    v_and_b32 v20, 0xffff0000, v86
    v_add_f32 v90, v90, v19
    v_add_f32 v91, v91, v20
    v_lshlrev_b32 v19, 16, v112
    v_and_b32 v20, 0xffff0000, v112
    v_add_f32 v92, v92, v19
    v_add_f32 v93, v93, v20
    v_lshlrev_b32 v19, 16, v113
    v_and_b32 v20, 0xffff0000, v113
    v_add_f32 v94, v94, v19
    v_add_f32 v95, v95, v20
    v_cvt_pk_bf16_f32 v24, v56, v57
    v_cvt_pk_bf16_f32 v25, v58, v59
    v_cvt_pk_bf16_f32 v26, v60, v61
    v_cvt_pk_bf16_f32 v27, v62, v63
    v_cvt_pk_bf16_f32 v28, v88, v89
    v_cvt_pk_bf16_f32 v29, v90, v91
    v_cvt_pk_bf16_f32 v30, v92, v93
    v_cvt_pk_bf16_f32 v31, v94, v95
    s_nop 1
    v_permlane32_swap_b32 v24, v26
    v_permlane32_swap_b32 v25, v27
    v_permlane32_swap_b32 v28, v30
    v_permlane32_swap_b32 v29, v31
    s_nop 1
    v_permlane16_swap_b32 v24, v26
    v_permlane16_swap_b32 v25, v27
    v_permlane16_swap_b32 v28, v30
    v_permlane16_swap_b32 v29, v31
    s_nop 1
    buffer_store_dwordx4 v[24:27], v13, s[48:51], 0 offen
    buffer_store_dwordx4 v[28:31], v13, s[48:51], s60 offen
    s_branch L_fin
L_g1fin:
    v_mov_b32 v19, v16
    s_nop 1
    v_permlane32_swap_b32 v19, v16
    s_nop 1
    v_add_f32 v16, v16, v19
    v_mov_b32 v19, v16
    s_nop 1
    v_permlane16_swap_b32 v19, v16
    s_nop 1
    v_add_f32 v16, v16, v19
    v_mov_b32 v19, v17
    s_nop 1
    v_permlane32_swap_b32 v19, v17
    s_nop 1
    v_add_f32 v17, v17, v19
    v_mov_b32 v19, v17
    s_nop 1
    v_permlane16_swap_b32 v19, v17
    s_nop 1
    v_add_f32 v17, v17, v19
    v_rcp_f32 v16, v16
    v_rcp_f32 v17, v17
    s_nop 0
    v_mul_f32 v56, v56, v16
    v_mul_f32 v57, v57, v16
    v_mul_f32 v58, v58, v16
    v_mul_f32 v59, v59, v16
    v_mul_f32 v60, v60, v16
    v_mul_f32 v61, v61, v16
    v_mul_f32 v62, v62, v16
    v_mul_f32 v63, v63, v16
    v_cvt_pk_bf16_f32 v120, v56, v57
    v_cvt_pk_bf16_f32 v121, v58, v59
    v_cvt_pk_bf16_f32 v122, v60, v61
    v_cvt_pk_bf16_f32 v123, v62, v63
    v_mul_f32 v88, v88, v17
    v_mul_f32 v89, v89, v17
    v_mul_f32 v90, v90, v17
    v_mul_f32 v91, v91, v17
    v_mul_f32 v92, v92, v17
    v_mul_f32 v93, v93, v17
    v_mul_f32 v94, v94, v17
    v_mul_f32 v95, v95, v17
    v_cvt_pk_bf16_f32 v124, v88, v89
    v_cvt_pk_bf16_f32 v125, v90, v91
    v_cvt_pk_bf16_f32 v126, v92, v93
    v_cvt_pk_bf16_f32 v127, v94, v95
    v_mul_f32 v64, v64, v16
    v_mul_f32 v65, v65, v16
    v_mul_f32 v66, v66, v16
    v_mul_f32 v67, v67, v16
    v_mul_f32 v68, v68, v16
    v_mul_f32 v69, v69, v16
    v_mul_f32 v70, v70, v16
    v_mul_f32 v71, v71, v16
    v_cvt_pk_bf16_f32 v128, v64, v65
    v_cvt_pk_bf16_f32 v129, v66, v67
    v_cvt_pk_bf16_f32 v130, v68, v69
    v_cvt_pk_bf16_f32 v131, v70, v71
    v_mul_f32 v96, v96, v17
    v_mul_f32 v97, v97, v17
    v_mul_f32 v98, v98, v17
    v_mul_f32 v99, v99, v17
    v_mul_f32 v100, v100, v17
    v_mul_f32 v101, v101, v17
    v_mul_f32 v102, v102, v17
    v_mul_f32 v103, v103, v17
    v_cvt_pk_bf16_f32 v132, v96, v97
    v_cvt_pk_bf16_f32 v133, v98, v99
    v_cvt_pk_bf16_f32 v134, v100, v101
    v_cvt_pk_bf16_f32 v135, v102, v103
    v_mul_f32 v72, v72, v16
    v_mul_f32 v73, v73, v16
    v_mul_f32 v74, v74, v16
    v_mul_f32 v75, v75, v16
    v_mul_f32 v76, v76, v16
    v_mul_f32 v77, v77, v16
    v_mul_f32 v78, v78, v16
    v_mul_f32 v79, v79, v16
    v_cvt_pk_bf16_f32 v136, v72, v73
    v_cvt_pk_bf16_f32 v137, v74, v75
    v_cvt_pk_bf16_f32 v138, v76, v77
    v_cvt_pk_bf16_f32 v139, v78, v79
    v_mul_f32 v104, v104, v17
    v_mul_f32 v105, v105, v17
    v_mul_f32 v106, v106, v17
    v_mul_f32 v107, v107, v17
    v_mul_f32 v108, v108, v17
    v_mul_f32 v109, v109, v17
    v_mul_f32 v110, v110, v17
    v_mul_f32 v111, v111, v17
    v_cvt_pk_bf16_f32 v140, v104, v105
    v_cvt_pk_bf16_f32 v141, v106, v107
    v_cvt_pk_bf16_f32 v142, v108, v109
    v_cvt_pk_bf16_f32 v143, v110, v111
    v_mul_f32 v80, v80, v16
    v_mul_f32 v81, v81, v16
    v_mul_f32 v82, v82, v16
    v_mul_f32 v83, v83, v16
    v_mul_f32 v84, v84, v16
    v_mul_f32 v85, v85, v16
    v_mul_f32 v86, v86, v16
    v_mul_f32 v87, v87, v16
    v_cvt_pk_bf16_f32 v144, v80, v81
    v_cvt_pk_bf16_f32 v145, v82, v83
    v_cvt_pk_bf16_f32 v146, v84, v85
    v_cvt_pk_bf16_f32 v147, v86, v87
    v_mul_f32 v112, v112, v17
    v_mul_f32 v113, v113, v17
    v_mul_f32 v114, v114, v17
    v_mul_f32 v115, v115, v17
    v_mul_f32 v116, v116, v17
    v_mul_f32 v117, v117, v17
    v_mul_f32 v118, v118, v17
    v_mul_f32 v119, v119, v17
    v_cvt_pk_bf16_f32 v148, v112, v113
    v_cvt_pk_bf16_f32 v149, v114, v115
    v_cvt_pk_bf16_f32 v150, v116, v117
    v_cvt_pk_bf16_f32 v151, v118, v119
    s_lshl_b32 s60, s98, 8
    s_add_u32 s8, s12, s60
    s_addc_u32 s9, s13, 0
    s_mov_b32 s10, 0
    s_mov_b32 s11, 0x20000
    s_sub_u32 s10, 4194304, s60
    v_lshrrev_b32 v248, 4, v22
    v_mul_u32_u24 v248, 768, v248
    v_add_u32 v248, v14, v248
    s_lshl_b32 s60, s52, 13
    v_add_u32 v248, s60, v248
    v_xor_b32 v249, 0x80, v248
    v_and_b32 v12, 3, v22
    v_lshlrev_b32 v12, 7, v12
    v_add_u32 v19, s56, v23
    s_setprio 3
    s_waitcnt vmcnt(0)
    s_barrier
    s_cmp_eq_u32 s6, 0
    s_cbranch_scc1 L_far4
    s_movk_i32 s60, 4096
    buffer_store_dwordx4 v[120:123], v23, s[48:51], 0 offen offset:0
    buffer_store_dwordx4 v[124:127], v23, s[48:51], 0 offen offset:1024
    buffer_store_dwordx4 v[128:131], v23, s[48:51], 0 offen offset:2048
    buffer_store_dwordx4 v[132:135], v23, s[48:51], 0 offen offset:3072
    buffer_store_dwordx4 v[136:139], v23, s[48:51], s60 offen offset:0
    buffer_store_dwordx4 v[140:143], v23, s[48:51], s60 offen offset:1024
    buffer_store_dwordx4 v[144:147], v23, s[48:51], s60 offen offset:2048
    buffer_store_dwordx4 v[148:151], v23, s[48:51], s60 offen offset:3072
    s_branch L_near4
L_far4:
    s_movk_i32 s60, 4096
    buffer_store_dwordx4 v[120:123], v23, s[48:51], 0 offen offset:0 sc1
    buffer_store_dwordx4 v[124:127], v23, s[48:51], 0 offen offset:1024 sc1
    buffer_store_dwordx4 v[128:131], v23, s[48:51], 0 offen offset:2048 sc1
    buffer_store_dwordx4 v[132:135], v23, s[48:51], 0 offen offset:3072 sc1
    buffer_store_dwordx4 v[136:139], v23, s[48:51], s60 offen offset:0 sc1
    buffer_store_dwordx4 v[140:143], v23, s[48:51], s60 offen offset:1024 sc1
    buffer_store_dwordx4 v[144:147], v23, s[48:51], s60 offen offset:2048 sc1
    buffer_store_dwordx4 v[148:151], v23, s[48:51], s60 offen offset:3072 sc1
L_near4:
    ds_write_b128 v19, v[120:123] offset:0
    ds_write_b128 v19, v[124:127] offset:1024
    ds_write_b128 v19, v[128:131] offset:8192
    ds_write_b128 v19, v[132:135] offset:9216
    ds_write_b128 v19, v[136:139] offset:16384
    ds_write_b128 v19, v[140:143] offset:17408
    ds_write_b128 v19, v[144:147] offset:24576
    ds_write_b128 v19, v[148:151] offset:25600
    s_waitcnt vmcnt(0)
    s_mov_b64 exec, 1
    s_cmp_eq_u32 s6, 0
    s_cbranch_scc1 L_far5
    buffer_store_dwordx2 v[252:253], v254, s[16:19], s20 offen
    s_branch L_near5
L_far5:
    buffer_store_dwordx2 v[252:253], v254, s[16:19], s20 offen sc1
L_near5:
    s_mov_b64 exec, -1
    s_add_u32 s3, s98, 1
    s_and_b32 s3, s3, 3
    s_lshl_b32 s3, s3, 1
    s_lshl_b32 s63, s97, 3
    s_add_u32 s3, s3, s63
    s_add_u32 s3, s3, 1
    s_lshl_b32 s3, s3, 17
    s_add_u32 m0, s56, 131072
    s_add_u32 s60, s3, 0
    buffer_load_dwordx4 v248, s[8:11], s60 offen lds
    s_add_u32 m0, s56, 132096
    s_add_u32 s60, s3, 4096
    buffer_load_dwordx4 v249, s[8:11], s60 offen lds
    s_add_u32 s3, s98, 1
    s_and_b32 s3, s3, 3
    s_lshl_b32 s3, s3, 1
    s_lshl_b32 s63, s97, 3
    s_add_u32 s3, s3, s63
    s_add_u32 s3, s3, 1
    s_lshl_b32 s3, s3, 17
    s_add_u32 m0, s56, 139264
    s_add_u32 s60, s3, 32768
    buffer_load_dwordx4 v248, s[8:11], s60 offen lds
    s_add_u32 m0, s56, 140288
    s_add_u32 s60, s3, 36864
    buffer_load_dwordx4 v249, s[8:11], s60 offen lds
    s_add_u32 s3, s98, 1
    s_and_b32 s3, s3, 3
    s_lshl_b32 s3, s3, 1
    s_lshl_b32 s63, s97, 3
    s_add_u32 s3, s3, s63
    s_add_u32 s3, s3, 1
    s_lshl_b32 s3, s3, 17
    s_add_u32 m0, s56, 147456
    s_add_u32 s60, s3, 65536
    buffer_load_dwordx4 v248, s[8:11], s60 offen lds
    s_add_u32 m0, s56, 148480
    s_add_u32 s60, s3, 69632
    buffer_load_dwordx4 v249, s[8:11], s60 offen lds
    s_add_u32 s3, s98, 1
    s_and_b32 s3, s3, 3
    s_lshl_b32 s3, s3, 1
    s_lshl_b32 s63, s97, 3
    s_add_u32 s3, s3, s63
    s_add_u32 s3, s3, 1
    s_lshl_b32 s3, s3, 17
    s_add_u32 m0, s56, 155648
    s_add_u32 s60, s3, 98304
    buffer_load_dwordx4 v248, s[8:11], s60 offen lds
    s_add_u32 m0, s56, 156672
    s_add_u32 s60, s3, 102400
    buffer_load_dwordx4 v249, s[8:11], s60 offen lds
    s_waitcnt lgkmcnt(0)
    s_barrier
    s_add_u32 s3, s98, 2
    s_and_b32 s3, s3, 3
    s_lshl_b32 s3, s3, 1
    s_lshl_b32 s63, s97, 3
    s_add_u32 s3, s3, s63
    s_add_u32 s3, s3, 1
    s_lshl_b32 s3, s3, 17
    s_add_u32 m0, s56, 65536
    s_add_u32 s60, s3, 0
    buffer_load_dwordx4 v248, s[8:11], s60 offen lds
    s_add_u32 m0, s56, 66560
    s_add_u32 s60, s3, 4096
    buffer_load_dwordx4 v249, s[8:11], s60 offen lds
    s_add_u32 s3, s98, 2
    s_and_b32 s3, s3, 3
    s_lshl_b32 s3, s3, 1
    s_lshl_b32 s63, s97, 3
    s_add_u32 s3, s3, s63
    s_add_u32 s3, s3, 1
    s_lshl_b32 s3, s3, 17
    s_add_u32 m0, s56, 73728
    s_add_u32 s60, s3, 32768
    buffer_load_dwordx4 v248, s[8:11], s60 offen lds
    s_add_u32 m0, s56, 74752
    s_add_u32 s60, s3, 36864
    buffer_load_dwordx4 v249, s[8:11], s60 offen lds
    s_add_u32 s3, s98, 2
    s_and_b32 s3, s3, 3
    s_lshl_b32 s3, s3, 1
    s_lshl_b32 s63, s97, 3
    s_add_u32 s3, s3, s63
    s_add_u32 s3, s3, 1
    s_lshl_b32 s3, s3, 17
    s_add_u32 m0, s56, 81920
    s_add_u32 s60, s3, 65536
    buffer_load_dwordx4 v248, s[8:11], s60 offen lds
    s_add_u32 m0, s56, 82944
    s_add_u32 s60, s3, 69632
    buffer_load_dwordx4 v249, s[8:11], s60 offen lds
    s_add_u32 s3, s98, 2
    s_and_b32 s3, s3, 3
    s_lshl_b32 s3, s3, 1
    s_lshl_b32 s63, s97, 3
    s_add_u32 s3, s3, s63
    s_add_u32 s3, s3, 1
    s_lshl_b32 s3, s3, 17
    s_add_u32 m0, s56, 90112
    s_add_u32 s60, s3, 98304
    buffer_load_dwordx4 v248, s[8:11], s60 offen lds
    s_add_u32 m0, s56, 91136
    s_add_u32 s60, s3, 102400
    buffer_load_dwordx4 v249, s[8:11], s60 offen lds
    s_mov_b32 s63, 0x200000
    s_mov_b64 exec, 15
L_pollo2:
    buffer_load_dwordx2 v[20:21], v12, s[16:19], s23 offen sc1
    s_waitcnt vmcnt(0)
    v_cmp_ne_u32 vcc, s99, v20
    v_cmp_ne_u32 s[4:5], s100, v21
    s_or_b64 vcc, vcc, s[4:5]
    s_cbranch_scc0 L_polldo2
    s_sleep 2
    s_sub_u32 s63, s63, 1
    s_cmp_lg_u32 s63, 0
    s_cbranch_scc1 L_pollo2
    s_branch L_end
L_polldo2:
    s_mov_b64 exec, -1
    s_barrier
    s_add_u32 s3, s98, 3
    s_and_b32 s3, s3, 3
    s_lshl_b32 s3, s3, 1
    s_lshl_b32 s63, s97, 3
    s_add_u32 s3, s3, s63
    s_add_u32 s3, s3, 1
    s_lshl_b32 s3, s3, 17
    s_add_u32 m0, s56, 32768
    s_add_u32 s60, s3, 0
    buffer_load_dwordx4 v248, s[8:11], s60 offen lds
    s_add_u32 m0, s56, 33792
    s_add_u32 s60, s3, 4096
    buffer_load_dwordx4 v249, s[8:11], s60 offen lds
    s_add_u32 s3, s98, 3
    s_and_b32 s3, s3, 3
    s_lshl_b32 s3, s3, 1
    s_lshl_b32 s63, s97, 3
    s_add_u32 s3, s3, s63
    s_add_u32 s3, s3, 1
    s_lshl_b32 s3, s3, 17
    s_add_u32 m0, s56, 40960
    s_add_u32 s60, s3, 32768
    buffer_load_dwordx4 v248, s[8:11], s60 offen lds
    s_add_u32 m0, s56, 41984
    s_add_u32 s60, s3, 36864
    buffer_load_dwordx4 v249, s[8:11], s60 offen lds
    s_add_u32 s3, s98, 3
    s_and_b32 s3, s3, 3
    s_lshl_b32 s3, s3, 1
    s_lshl_b32 s63, s97, 3
    s_add_u32 s3, s3, s63
    s_add_u32 s3, s3, 1
    s_lshl_b32 s3, s3, 17
    s_add_u32 m0, s56, 49152
    s_add_u32 s60, s3, 65536
    buffer_load_dwordx4 v248, s[8:11], s60 offen lds
    s_add_u32 m0, s56, 50176
    s_add_u32 s60, s3, 69632
    buffer_load_dwordx4 v249, s[8:11], s60 offen lds
    s_add_u32 s3, s98, 3
    s_and_b32 s3, s3, 3
    s_lshl_b32 s3, s3, 1
    s_lshl_b32 s63, s97, 3
    s_add_u32 s3, s3, s63
    s_add_u32 s3, s3, 1
    s_lshl_b32 s3, s3, 17
    s_add_u32 m0, s56, 57344
    s_add_u32 s60, s3, 98304
    buffer_load_dwordx4 v248, s[8:11], s60 offen lds
    s_add_u32 m0, s56, 58368
    s_add_u32 s60, s3, 102400
    buffer_load_dwordx4 v249, s[8:11], s60 offen lds
    s_waitcnt vmcnt(0)
    s_barrier
L_fin:
L_end:
    s_endpgm
L_g0:
    s_lshl_b32 s60, s55, 5
    s_add_u32 s60, s60, s54
    s_lshl_b32 s60, s60, 18
    s_add_u32 s32, s6, s60
    s_addc_u32 s33, s7, 0
    s_mov_b32 s34, 524288
    s_mov_b32 s35, 0x20000
    s_add_u32 s36, s8, s60
    s_addc_u32 s37, s9, 0
    s_mov_b32 s38, 524288
    s_mov_b32 s39, 0x20000
    s_lshl_b32 s21, s53, 3
    s_add_u32 s21, s21, s55
    s_lshl_b32 s21, s21, 2
    s_add_u32 s60, s21, s97
    s_lshl_b32 s60, s60, 2
    s_add_u32 s60, s60, s52
    s_lshl_b32 s60, s60, 2
    s_add_u32 s60, s60, s98
    s_mul_i32 s60, s60, 8192
    s_add_u32 s60, s60, 67108864
    s_add_u32 s48, s28, s60
    s_addc_u32 s49, s29, 0
    s_mov_b32 s50, 8192
    s_mov_b32 s51, 0x20000
    s_add_u32 s16, s28, 50331648
    s_addc_u32 s17, s29, 0
    s_mov_b32 s18, 557184
    s_mov_b32 s19, 0x20000
    s_add_u32 s23, s21, s97
    s_lshl_b32 s23, s23, 3
    s_add_u32 s23, s23, s52
    s_lshl_b32 s60, s96, 2
    s_add_u32 s23, s23, s60
    s_lshl_b32 s23, s23, 9
    s_lshl_b32 s20, s98, 7
    s_add_u32 s20, s20, s23
    s_add_u32 s7, s21, s97
    s_lshl_b32 s7, s7, 9
    s_add_u32 s7, s7, 262144
    s_lshl_b32 s14, s2, 2
    s_add_u32 s14, s14, s52
    s_mov_b32 s61, 0x41000000
    s_mov_b32 s62, 0x3e0293ee
    v_xor_b32 v15, 0x80, v14
    s_and_b32 s60, s52, 1
    s_lshl_b32 s60, s60, 3
    v_add_u32 v26, s60, v24
    v_xor_b32 v12, v26, v25
    v_xor_b32 v13, 4, v12
    v_lshlrev_b32 v12, 4, v12
    v_lshlrev_b32 v13, 4, v13
    v_lshl_add_u32 v12, v24, 8, v12
    v_lshl_add_u32 v13, v24, 8, v13
    v_lshrrev_b32 v26, 1, v25
    v_lshrrev_b32 v27, 1, v24
    v_xor_b32 v26, v26, v27
    v_lshlrev_b32 v26, 4, v26
    v_lshl_add_u32 v16, v25, 7, v26
    v_and_b32 v27, 1, v24
    v_lshl_add_u32 v16, v27, 3, v16
    v_add_u32 v16, s101, v16
    v_xor_b32 v17, 32, v16
    v_xor_b32 v18, 64, v16
    v_xor_b32 v19, 96, v16
    v_xor_b32 v0, v24, v25
    v_lshlrev_b32 v0, 4, v0
    v_lshl_add_u32 v0, v25, 8, v0
    v_xor_b32 v1, 64, v0
    v_xor_b32 v2, 128, v0
    v_xor_b32 v3, 192, v0
    v_lshrrev_b32 v26, 2, v22
    v_and_b32 v27, 7, v26
    v_lshlrev_b32 v27, 5, v27
    v_lshl_add_u32 v4, v26, 8, v27
    v_and_b32 v26, 3, v22
    v_lshl_add_u32 v4, v26, 3, v4
    v_add_u32 v4, 65536, v4
    v_xor_b32 v5, 32, v4
    v_xor_b32 v6, 64, v4
    v_xor_b32 v7, 96, v4
    v_xor_b32 v8, 128, v4
    v_xor_b32 v9, 160, v4
    v_xor_b32 v10, 192, v4
    v_xor_b32 v11, 224, v4
    v_lshlrev_b32 v23, 4, v22
    v_mov_b32 v254, 0
    s_lshr_b32 s60, s2, 3
    s_lshl_b32 s60, s60, 2
    s_add_u32 s60, s60, s52
    s_cmp_lt_u32 s60, (L_codeend-concat_heads__mha_block_cached__gqa_block_cached__near_ridge_kernel)>>10
    s_cbranch_scc0 L_nowarma
    s_lshl_b32 s60, s60, 10
    s_getpc_b64 s[4:5]
L_pca:
    s_sub_u32 s4, s4, L_pca-concat_heads__mha_block_cached__gqa_block_cached__near_ridge_kernel
    s_subb_u32 s5, s5, 0
    s_add_u32 s4, s4, s60
    s_addc_u32 s5, s5, 0
    v_mov_b32 v245, s5
    v_add_co_u32 v244, vcc, s4, v23
    s_nop 1
    v_addc_co_u32 v245, vcc, 0, v245, vcc
    global_load_dwordx4 v[240:243], v[244:245], off
L_nowarma:
    s_add_u32 s57, s56, 32768
    s_add_u32 s58, s56, 16384
    s_barrier
    ds_read_b64 v[184:185], v16 offset:0
    ds_read_b64 v[186:187], v17 offset:0
    ds_read_b64 v[188:189], v16 offset:2048
    ds_read_b64 v[190:191], v17 offset:2048
    ds_read_b64 v[192:193], v18 offset:0
    ds_read_b64 v[194:195], v19 offset:0
    ds_read_b64 v[196:197], v18 offset:2048
    ds_read_b64 v[198:199], v19 offset:2048
    ds_read_b64_tr_b16 v[24:25], v4 offset:0
    ds_read_b64_tr_b16 v[26:27], v4 offset:4096
    ds_read_b64_tr_b16 v[28:29], v5 offset:0
    ds_read_b64_tr_b16 v[30:31], v5 offset:4096
    ds_read_b64_tr_b16 v[32:33], v6 offset:0
    ds_read_b64_tr_b16 v[34:35], v6 offset:4096
    ds_read_b64_tr_b16 v[36:37], v7 offset:0
    ds_read_b64_tr_b16 v[38:39], v7 offset:4096
    ds_read_b64_tr_b16 v[40:41], v8 offset:0
    ds_read_b64_tr_b16 v[42:43], v8 offset:4096
    ds_read_b64_tr_b16 v[44:45], v9 offset:0
    ds_read_b64_tr_b16 v[46:47], v9 offset:4096
    ds_read_b64_tr_b16 v[48:49], v10 offset:0
    ds_read_b64_tr_b16 v[50:51], v10 offset:4096
    ds_read_b64_tr_b16 v[52:53], v11 offset:0
    ds_read_b64_tr_b16 v[54:55], v11 offset:4096
    s_waitcnt lgkmcnt(14)
    v_mfma_f32_16x16x32_bf16 v[56:59], v[24:27], v[184:187], 0
    ds_read_b64_tr_b16 v[152:153], v4 offset:8192
    ds_read_b64_tr_b16 v[154:155], v4 offset:12288
    v_mfma_f32_16x16x32_bf16 v[88:91], v[24:27], v[188:191], 0
    ds_read_b64_tr_b16 v[156:157], v5 offset:8192
    ds_read_b64_tr_b16 v[158:159], v5 offset:12288
    s_waitcnt lgkmcnt(14)
    v_mfma_f32_16x16x32_bf16 v[60:63], v[28:31], v[184:187], 0
    ds_read_b64_tr_b16 v[160:161], v6 offset:8192
    v_mfma_f32_16x16x32_bf16 v[92:95], v[28:31], v[188:191], 0
    ds_read_b64_tr_b16 v[162:163], v6 offset:12288
    ds_read_b64_tr_b16 v[164:165], v7 offset:8192
    v_mfma_f32_16x16x32_bf16 v[64:67], v[32:35], v[184:187], 0
    ds_read_b64_tr_b16 v[166:167], v7 offset:12288
    v_mfma_f32_16x16x32_bf16 v[96:99], v[32:35], v[188:191], 0
    ds_read_b64_tr_b16 v[168:169], v8 offset:8192
    ds_read_b64_tr_b16 v[170:171], v8 offset:12288
    s_waitcnt lgkmcnt(14)
    v_mfma_f32_16x16x32_bf16 v[68:71], v[36:39], v[184:187], 0
    ds_read_b64_tr_b16 v[172:173], v9 offset:8192
    ds_read_b64_tr_b16 v[174:175], v9 offset:12288
    v_mfma_f32_16x16x32_bf16 v[100:103], v[36:39], v[188:191], 0
    ds_read_b64_tr_b16 v[176:177], v10 offset:8192
    v_mfma_f32_16x16x32_bf16 v[72:75], v[40:43], v[184:187], 0
    ds_read_b64_tr_b16 v[178:179], v10 offset:12288
    ds_read_b64_tr_b16 v[180:181], v11 offset:8192
    v_mfma_f32_16x16x32_bf16 v[104:107], v[40:43], v[188:191], 0
    ds_read_b64_tr_b16 v[182:183], v11 offset:12288
    v_mfma_f32_16x16x32_bf16 v[76:79], v[44:47], v[184:187], 0
    v_mfma_f32_16x16x32_bf16 v[108:111], v[44:47], v[188:191], 0
    s_waitcnt lgkmcnt(14)
    v_mfma_f32_16x16x32_bf16 v[80:83], v[48:51], v[184:187], 0
    v_mfma_f32_16x16x32_bf16 v[112:115], v[48:51], v[188:191], 0
    v_mfma_f32_16x16x32_bf16 v[84:87], v[52:55], v[184:187], 0
    v_mfma_f32_16x16x32_bf16 v[116:119], v[52:55], v[188:191], 0
    s_waitcnt lgkmcnt(0)
    s_barrier
    v_mfma_f32_16x16x32_bf16 v[56:59], v[152:155], v[192:195], v[56:59]
    ds_read_b64 v[200:201], v16 offset:16384
    ds_read_b64 v[202:203], v17 offset:16384
    v_mfma_f32_16x16x32_bf16 v[88:91], v[152:155], v[196:199], v[88:91]
    ds_read_b64 v[204:205], v16 offset:18432
    ds_read_b64 v[206:207], v17 offset:18432
    v_mfma_f32_16x16x32_bf16 v[60:63], v[156:159], v[192:195], v[60:63]
    ds_read_b64 v[208:209], v18 offset:16384
    ds_read_b64 v[210:211], v19 offset:16384
    v_mfma_f32_16x16x32_bf16 v[92:95], v[156:159], v[196:199], v[92:95]
    ds_read_b64 v[212:213], v18 offset:18432
    ds_read_b64 v[214:215], v19 offset:18432
    v_mfma_f32_16x16x32_bf16 v[64:67], v[160:163], v[192:195], v[64:67]
    ds_read_b64_tr_b16 v[24:25], v4 offset:16384
    ds_read_b64_tr_b16 v[26:27], v4 offset:20480
    v_mfma_f32_16x16x32_bf16 v[96:99], v[160:163], v[196:199], v[96:99]
    ds_read_b64_tr_b16 v[28:29], v5 offset:16384
    ds_read_b64_tr_b16 v[30:31], v5 offset:20480
    v_mfma_f32_16x16x32_bf16 v[68:71], v[164:167], v[192:195], v[68:71]
    ds_read_b64_tr_b16 v[32:33], v6 offset:16384
    v_mfma_f32_16x16x32_bf16 v[100:103], v[164:167], v[196:199], v[100:103]
    ds_read_b64_tr_b16 v[34:35], v6 offset:20480
    ds_read_b64_tr_b16 v[36:37], v7 offset:16384
    v_mfma_f32_16x16x32_bf16 v[72:75], v[168:171], v[192:195], v[72:75]
    ds_read_b64_tr_b16 v[38:39], v7 offset:20480
    v_mfma_f32_16x16x32_bf16 v[104:107], v[168:171], v[196:199], v[104:107]
    ds_read_b64_tr_b16 v[40:41], v8 offset:16384
    ds_read_b64_tr_b16 v[42:43], v8 offset:20480
    v_mfma_f32_16x16x32_bf16 v[76:79], v[172:175], v[192:195], v[76:79]
    ds_read_b64_tr_b16 v[44:45], v9 offset:16384
    ds_read_b64_tr_b16 v[46:47], v9 offset:20480
    v_mfma_f32_16x16x32_bf16 v[108:111], v[172:175], v[196:199], v[108:111]
    ds_read_b64_tr_b16 v[48:49], v10 offset:16384
    v_mfma_f32_16x16x32_bf16 v[80:83], v[176:179], v[192:195], v[80:83]
    ds_read_b64_tr_b16 v[50:51], v10 offset:20480
    ds_read_b64_tr_b16 v[52:53], v11 offset:16384
    v_mfma_f32_16x16x32_bf16 v[112:115], v[176:179], v[196:199], v[112:115]
    ds_read_b64_tr_b16 v[54:55], v11 offset:20480
    v_mfma_f32_16x16x32_bf16 v[84:87], v[180:183], v[192:195], v[84:87]
    v_mfma_f32_16x16x32_bf16 v[116:119], v[180:183], v[196:199], v[116:119]
    s_waitcnt lgkmcnt(14)
    v_mfma_f32_16x16x32_bf16 v[56:59], v[24:27], v[200:203], v[56:59]
    ds_read_b64_tr_b16 v[152:153], v4 offset:24576
    ds_read_b64_tr_b16 v[154:155], v4 offset:28672
    v_mfma_f32_16x16x32_bf16 v[88:91], v[24:27], v[204:207], v[88:91]
    ds_read_b64_tr_b16 v[156:157], v5 offset:24576
    ds_read_b64_tr_b16 v[158:159], v5 offset:28672
    s_waitcnt lgkmcnt(14)
    v_mfma_f32_16x16x32_bf16 v[60:63], v[28:31], v[200:203], v[60:63]
    ds_read_b64_tr_b16 v[160:161], v6 offset:24576
    v_mfma_f32_16x16x32_bf16 v[92:95], v[28:31], v[204:207], v[92:95]
    ds_read_b64_tr_b16 v[162:163], v6 offset:28672
    ds_read_b64_tr_b16 v[164:165], v7 offset:24576
    v_mfma_f32_16x16x32_bf16 v[64:67], v[32:35], v[200:203], v[64:67]
    ds_read_b64_tr_b16 v[166:167], v7 offset:28672
    v_mfma_f32_16x16x32_bf16 v[96:99], v[32:35], v[204:207], v[96:99]
    ds_read_b64_tr_b16 v[168:169], v8 offset:24576
    ds_read_b64_tr_b16 v[170:171], v8 offset:28672
    s_waitcnt lgkmcnt(14)
    v_mfma_f32_16x16x32_bf16 v[68:71], v[36:39], v[200:203], v[68:71]
    ds_read_b64_tr_b16 v[172:173], v9 offset:24576
    ds_read_b64_tr_b16 v[174:175], v9 offset:28672
    v_mfma_f32_16x16x32_bf16 v[100:103], v[36:39], v[204:207], v[100:103]
    ds_read_b64_tr_b16 v[176:177], v10 offset:24576
    v_mfma_f32_16x16x32_bf16 v[72:75], v[40:43], v[200:203], v[72:75]
    ds_read_b64_tr_b16 v[178:179], v10 offset:28672
    ds_read_b64_tr_b16 v[180:181], v11 offset:24576
    v_mfma_f32_16x16x32_bf16 v[104:107], v[40:43], v[204:207], v[104:107]
    ds_read_b64_tr_b16 v[182:183], v11 offset:28672
    v_mfma_f32_16x16x32_bf16 v[76:79], v[44:47], v[200:203], v[76:79]
    v_mfma_f32_16x16x32_bf16 v[108:111], v[44:47], v[204:207], v[108:111]
    s_waitcnt lgkmcnt(14)
    v_mfma_f32_16x16x32_bf16 v[80:83], v[48:51], v[200:203], v[80:83]
    v_mfma_f32_16x16x32_bf16 v[112:115], v[48:51], v[204:207], v[112:115]
    v_mfma_f32_16x16x32_bf16 v[84:87], v[52:55], v[200:203], v[84:87]
    v_mfma_f32_16x16x32_bf16 v[116:119], v[52:55], v[204:207], v[116:119]
    s_waitcnt lgkmcnt(0)
    s_barrier
    v_mfma_f32_16x16x32_bf16 v[56:59], v[152:155], v[208:211], v[56:59]
    ds_read_b64 v[184:185], v16 offset:32768
    ds_read_b64 v[186:187], v17 offset:32768
    v_mfma_f32_16x16x32_bf16 v[88:91], v[152:155], v[212:215], v[88:91]
    ds_read_b64 v[188:189], v16 offset:34816
    ds_read_b64 v[190:191], v17 offset:34816
    v_mfma_f32_16x16x32_bf16 v[60:63], v[156:159], v[208:211], v[60:63]
    ds_read_b64 v[192:193], v18 offset:32768
    ds_read_b64 v[194:195], v19 offset:32768
    v_mfma_f32_16x16x32_bf16 v[92:95], v[156:159], v[212:215], v[92:95]
    ds_read_b64 v[196:197], v18 offset:34816
    ds_read_b64 v[198:199], v19 offset:34816
    v_mfma_f32_16x16x32_bf16 v[64:67], v[160:163], v[208:211], v[64:67]
    ds_read_b64_tr_b16 v[24:25], v4 offset:32768
    ds_read_b64_tr_b16 v[26:27], v4 offset:36864
    v_mfma_f32_16x16x32_bf16 v[96:99], v[160:163], v[212:215], v[96:99]
    ds_read_b64_tr_b16 v[28:29], v5 offset:32768
    ds_read_b64_tr_b16 v[30:31], v5 offset:36864
    v_mfma_f32_16x16x32_bf16 v[68:71], v[164:167], v[208:211], v[68:71]
    ds_read_b64_tr_b16 v[32:33], v6 offset:32768
    v_mfma_f32_16x16x32_bf16 v[100:103], v[164:167], v[212:215], v[100:103]
    ds_read_b64_tr_b16 v[34:35], v6 offset:36864
    ds_read_b64_tr_b16 v[36:37], v7 offset:32768
    v_mfma_f32_16x16x32_bf16 v[72:75], v[168:171], v[208:211], v[72:75]
    ds_read_b64_tr_b16 v[38:39], v7 offset:36864
    v_mfma_f32_16x16x32_bf16 v[104:107], v[168:171], v[212:215], v[104:107]
    ds_read_b64_tr_b16 v[40:41], v8 offset:32768
    ds_read_b64_tr_b16 v[42:43], v8 offset:36864
    v_mfma_f32_16x16x32_bf16 v[76:79], v[172:175], v[208:211], v[76:79]
    ds_read_b64_tr_b16 v[44:45], v9 offset:32768
    ds_read_b64_tr_b16 v[46:47], v9 offset:36864
    v_mfma_f32_16x16x32_bf16 v[108:111], v[172:175], v[212:215], v[108:111]
    ds_read_b64_tr_b16 v[48:49], v10 offset:32768
    v_mfma_f32_16x16x32_bf16 v[80:83], v[176:179], v[208:211], v[80:83]
    ds_read_b64_tr_b16 v[50:51], v10 offset:36864
    ds_read_b64_tr_b16 v[52:53], v11 offset:32768
    v_mfma_f32_16x16x32_bf16 v[112:115], v[176:179], v[212:215], v[112:115]
    ds_read_b64_tr_b16 v[54:55], v11 offset:36864
    v_mfma_f32_16x16x32_bf16 v[84:87], v[180:183], v[208:211], v[84:87]
    v_mfma_f32_16x16x32_bf16 v[116:119], v[180:183], v[212:215], v[116:119]
    s_waitcnt lgkmcnt(14)
    v_mfma_f32_16x16x32_bf16 v[56:59], v[24:27], v[184:187], v[56:59]
    ds_read_b64_tr_b16 v[152:153], v4 offset:40960
    ds_read_b64_tr_b16 v[154:155], v4 offset:45056
    v_mfma_f32_16x16x32_bf16 v[88:91], v[24:27], v[188:191], v[88:91]
    ds_read_b64_tr_b16 v[156:157], v5 offset:40960
    ds_read_b64_tr_b16 v[158:159], v5 offset:45056
    s_waitcnt lgkmcnt(14)
    v_mfma_f32_16x16x32_bf16 v[60:63], v[28:31], v[184:187], v[60:63]
    ds_read_b64_tr_b16 v[160:161], v6 offset:40960
    v_mfma_f32_16x16x32_bf16 v[92:95], v[28:31], v[188:191], v[92:95]
    ds_read_b64_tr_b16 v[162:163], v6 offset:45056
    ds_read_b64_tr_b16 v[164:165], v7 offset:40960
    v_mfma_f32_16x16x32_bf16 v[64:67], v[32:35], v[184:187], v[64:67]
    ds_read_b64_tr_b16 v[166:167], v7 offset:45056
    v_mfma_f32_16x16x32_bf16 v[96:99], v[32:35], v[188:191], v[96:99]
    ds_read_b64_tr_b16 v[168:169], v8 offset:40960
    ds_read_b64_tr_b16 v[170:171], v8 offset:45056
    s_waitcnt lgkmcnt(14)
    v_mfma_f32_16x16x32_bf16 v[68:71], v[36:39], v[184:187], v[68:71]
    ds_read_b64_tr_b16 v[172:173], v9 offset:40960
    ds_read_b64_tr_b16 v[174:175], v9 offset:45056
    v_mfma_f32_16x16x32_bf16 v[100:103], v[36:39], v[188:191], v[100:103]
    ds_read_b64_tr_b16 v[176:177], v10 offset:40960
    v_mfma_f32_16x16x32_bf16 v[72:75], v[40:43], v[184:187], v[72:75]
    ds_read_b64_tr_b16 v[178:179], v10 offset:45056
    ds_read_b64_tr_b16 v[180:181], v11 offset:40960
    v_mfma_f32_16x16x32_bf16 v[104:107], v[40:43], v[188:191], v[104:107]
    ds_read_b64_tr_b16 v[182:183], v11 offset:45056
    v_mfma_f32_16x16x32_bf16 v[76:79], v[44:47], v[184:187], v[76:79]
    v_mfma_f32_16x16x32_bf16 v[108:111], v[44:47], v[188:191], v[108:111]
    s_waitcnt lgkmcnt(14)
    v_mfma_f32_16x16x32_bf16 v[80:83], v[48:51], v[184:187], v[80:83]
    v_mfma_f32_16x16x32_bf16 v[112:115], v[48:51], v[188:191], v[112:115]
    v_mfma_f32_16x16x32_bf16 v[84:87], v[52:55], v[184:187], v[84:87]
    v_mfma_f32_16x16x32_bf16 v[116:119], v[52:55], v[188:191], v[116:119]
    s_waitcnt lgkmcnt(0)
    s_barrier
    v_mfma_f32_16x16x32_bf16 v[56:59], v[152:155], v[192:195], v[56:59]
    ds_read_b64 v[200:201], v16 offset:0
    ds_read_b64 v[202:203], v17 offset:0
    v_mfma_f32_16x16x32_bf16 v[88:91], v[152:155], v[196:199], v[88:91]
    ds_read_b64 v[204:205], v16 offset:2048
    ds_read_b64 v[206:207], v17 offset:2048
    v_mfma_f32_16x16x32_bf16 v[60:63], v[156:159], v[192:195], v[60:63]
    ds_read_b64 v[208:209], v18 offset:0
    ds_read_b64 v[210:211], v19 offset:0
    v_mfma_f32_16x16x32_bf16 v[92:95], v[156:159], v[196:199], v[92:95]
    ds_read_b64 v[212:213], v18 offset:2048
    ds_read_b64 v[214:215], v19 offset:2048
    v_mfma_f32_16x16x32_bf16 v[64:67], v[160:163], v[192:195], v[64:67]
    ds_read_b64_tr_b16 v[24:25], v4 offset:0
    ds_read_b64_tr_b16 v[26:27], v4 offset:4096
    v_mfma_f32_16x16x32_bf16 v[96:99], v[160:163], v[196:199], v[96:99]
    ds_read_b64_tr_b16 v[28:29], v5 offset:0
    ds_read_b64_tr_b16 v[30:31], v5 offset:4096
    v_mfma_f32_16x16x32_bf16 v[68:71], v[164:167], v[192:195], v[68:71]
    ds_read_b64_tr_b16 v[32:33], v6 offset:0
    v_mfma_f32_16x16x32_bf16 v[100:103], v[164:167], v[196:199], v[100:103]
    ds_read_b64_tr_b16 v[34:35], v6 offset:4096
    ds_read_b64_tr_b16 v[36:37], v7 offset:0
    v_mfma_f32_16x16x32_bf16 v[72:75], v[168:171], v[192:195], v[72:75]
    ds_read_b64_tr_b16 v[38:39], v7 offset:4096
    v_mfma_f32_16x16x32_bf16 v[104:107], v[168:171], v[196:199], v[104:107]
    ds_read_b64_tr_b16 v[40:41], v8 offset:0
    ds_read_b64_tr_b16 v[42:43], v8 offset:4096
    v_mfma_f32_16x16x32_bf16 v[76:79], v[172:175], v[192:195], v[76:79]
    ds_read_b64_tr_b16 v[44:45], v9 offset:0
    ds_read_b64_tr_b16 v[46:47], v9 offset:4096
    v_mfma_f32_16x16x32_bf16 v[108:111], v[172:175], v[196:199], v[108:111]
    ds_read_b64_tr_b16 v[48:49], v10 offset:0
    v_mfma_f32_16x16x32_bf16 v[80:83], v[176:179], v[192:195], v[80:83]
    ds_read_b64_tr_b16 v[50:51], v10 offset:4096
    ds_read_b64_tr_b16 v[52:53], v11 offset:0
    v_mfma_f32_16x16x32_bf16 v[112:115], v[176:179], v[196:199], v[112:115]
    ds_read_b64_tr_b16 v[54:55], v11 offset:4096
    v_mfma_f32_16x16x32_bf16 v[84:87], v[180:183], v[192:195], v[84:87]
    v_mfma_f32_16x16x32_bf16 v[116:119], v[180:183], v[196:199], v[116:119]
    s_waitcnt lgkmcnt(14)
    v_mfma_f32_16x16x32_bf16 v[56:59], v[24:27], v[200:203], v[56:59]
    ds_read_b64_tr_b16 v[152:153], v4 offset:8192
    ds_read_b64_tr_b16 v[154:155], v4 offset:12288
    v_mfma_f32_16x16x32_bf16 v[88:91], v[24:27], v[204:207], v[88:91]
    ds_read_b64_tr_b16 v[156:157], v5 offset:8192
    ds_read_b64_tr_b16 v[158:159], v5 offset:12288
    s_waitcnt lgkmcnt(14)
    v_mfma_f32_16x16x32_bf16 v[60:63], v[28:31], v[200:203], v[60:63]
    ds_read_b64_tr_b16 v[160:161], v6 offset:8192
    v_mfma_f32_16x16x32_bf16 v[92:95], v[28:31], v[204:207], v[92:95]
    ds_read_b64_tr_b16 v[162:163], v6 offset:12288
    ds_read_b64_tr_b16 v[164:165], v7 offset:8192
    v_mfma_f32_16x16x32_bf16 v[64:67], v[32:35], v[200:203], v[64:67]
    ds_read_b64_tr_b16 v[166:167], v7 offset:12288
    v_mfma_f32_16x16x32_bf16 v[96:99], v[32:35], v[204:207], v[96:99]
    ds_read_b64_tr_b16 v[168:169], v8 offset:8192
    ds_read_b64_tr_b16 v[170:171], v8 offset:12288
    s_waitcnt lgkmcnt(14)
    v_mfma_f32_16x16x32_bf16 v[68:71], v[36:39], v[200:203], v[68:71]
    ds_read_b64_tr_b16 v[172:173], v9 offset:8192
    ds_read_b64_tr_b16 v[174:175], v9 offset:12288
    v_mfma_f32_16x16x32_bf16 v[100:103], v[36:39], v[204:207], v[100:103]
    ds_read_b64_tr_b16 v[176:177], v10 offset:8192
    v_mfma_f32_16x16x32_bf16 v[72:75], v[40:43], v[200:203], v[72:75]
    ds_read_b64_tr_b16 v[178:179], v10 offset:12288
    ds_read_b64_tr_b16 v[180:181], v11 offset:8192
    v_mfma_f32_16x16x32_bf16 v[104:107], v[40:43], v[204:207], v[104:107]
    ds_read_b64_tr_b16 v[182:183], v11 offset:12288
    v_mfma_f32_16x16x32_bf16 v[76:79], v[44:47], v[200:203], v[76:79]
    v_mfma_f32_16x16x32_bf16 v[108:111], v[44:47], v[204:207], v[108:111]
    s_waitcnt lgkmcnt(14)
    v_mfma_f32_16x16x32_bf16 v[80:83], v[48:51], v[200:203], v[80:83]
    v_mfma_f32_16x16x32_bf16 v[112:115], v[48:51], v[204:207], v[112:115]
    v_mfma_f32_16x16x32_bf16 v[84:87], v[52:55], v[200:203], v[84:87]
    v_mfma_f32_16x16x32_bf16 v[116:119], v[52:55], v[204:207], v[116:119]
    s_waitcnt lgkmcnt(0)
    s_barrier
    v_mfma_f32_16x16x32_bf16 v[56:59], v[152:155], v[208:211], v[56:59]
    ds_read_b64 v[184:185], v16 offset:16384
    ds_read_b64 v[186:187], v17 offset:16384
    v_mfma_f32_16x16x32_bf16 v[88:91], v[152:155], v[212:215], v[88:91]
    ds_read_b64 v[188:189], v16 offset:18432
    ds_read_b64 v[190:191], v17 offset:18432
    v_mfma_f32_16x16x32_bf16 v[60:63], v[156:159], v[208:211], v[60:63]
    ds_read_b64 v[192:193], v18 offset:16384
    ds_read_b64 v[194:195], v19 offset:16384
    v_mfma_f32_16x16x32_bf16 v[92:95], v[156:159], v[212:215], v[92:95]
    ds_read_b64 v[196:197], v18 offset:18432
    ds_read_b64 v[198:199], v19 offset:18432
    v_mfma_f32_16x16x32_bf16 v[64:67], v[160:163], v[208:211], v[64:67]
    ds_read_b64_tr_b16 v[24:25], v4 offset:16384
    ds_read_b64_tr_b16 v[26:27], v4 offset:20480
    v_mfma_f32_16x16x32_bf16 v[96:99], v[160:163], v[212:215], v[96:99]
    ds_read_b64_tr_b16 v[28:29], v5 offset:16384
    ds_read_b64_tr_b16 v[30:31], v5 offset:20480
    v_mfma_f32_16x16x32_bf16 v[68:71], v[164:167], v[208:211], v[68:71]
    ds_read_b64_tr_b16 v[32:33], v6 offset:16384
    v_mfma_f32_16x16x32_bf16 v[100:103], v[164:167], v[212:215], v[100:103]
    ds_read_b64_tr_b16 v[34:35], v6 offset:20480
    ds_read_b64_tr_b16 v[36:37], v7 offset:16384
    v_mfma_f32_16x16x32_bf16 v[72:75], v[168:171], v[208:211], v[72:75]
    ds_read_b64_tr_b16 v[38:39], v7 offset:20480
    v_mfma_f32_16x16x32_bf16 v[104:107], v[168:171], v[212:215], v[104:107]
    ds_read_b64_tr_b16 v[40:41], v8 offset:16384
    ds_read_b64_tr_b16 v[42:43], v8 offset:20480
    v_mfma_f32_16x16x32_bf16 v[76:79], v[172:175], v[208:211], v[76:79]
    ds_read_b64_tr_b16 v[44:45], v9 offset:16384
    ds_read_b64_tr_b16 v[46:47], v9 offset:20480
    v_mfma_f32_16x16x32_bf16 v[108:111], v[172:175], v[212:215], v[108:111]
    ds_read_b64_tr_b16 v[48:49], v10 offset:16384
    v_mfma_f32_16x16x32_bf16 v[80:83], v[176:179], v[208:211], v[80:83]
    ds_read_b64_tr_b16 v[50:51], v10 offset:20480
    ds_read_b64_tr_b16 v[52:53], v11 offset:16384
    v_mfma_f32_16x16x32_bf16 v[112:115], v[176:179], v[212:215], v[112:115]
    ds_read_b64_tr_b16 v[54:55], v11 offset:20480
    v_mfma_f32_16x16x32_bf16 v[84:87], v[180:183], v[208:211], v[84:87]
    v_mfma_f32_16x16x32_bf16 v[116:119], v[180:183], v[212:215], v[116:119]
    s_waitcnt lgkmcnt(14)
    v_mfma_f32_16x16x32_bf16 v[56:59], v[24:27], v[184:187], v[56:59]
    ds_read_b64_tr_b16 v[152:153], v4 offset:24576
    ds_read_b64_tr_b16 v[154:155], v4 offset:28672
    v_mfma_f32_16x16x32_bf16 v[88:91], v[24:27], v[188:191], v[88:91]
    ds_read_b64_tr_b16 v[156:157], v5 offset:24576
    ds_read_b64_tr_b16 v[158:159], v5 offset:28672
    s_waitcnt lgkmcnt(14)
    v_mfma_f32_16x16x32_bf16 v[60:63], v[28:31], v[184:187], v[60:63]
    ds_read_b64_tr_b16 v[160:161], v6 offset:24576
    v_mfma_f32_16x16x32_bf16 v[92:95], v[28:31], v[188:191], v[92:95]
    ds_read_b64_tr_b16 v[162:163], v6 offset:28672
    ds_read_b64_tr_b16 v[164:165], v7 offset:24576
    v_mfma_f32_16x16x32_bf16 v[64:67], v[32:35], v[184:187], v[64:67]
    ds_read_b64_tr_b16 v[166:167], v7 offset:28672
    v_mfma_f32_16x16x32_bf16 v[96:99], v[32:35], v[188:191], v[96:99]
    ds_read_b64_tr_b16 v[168:169], v8 offset:24576
    ds_read_b64_tr_b16 v[170:171], v8 offset:28672
    s_waitcnt lgkmcnt(14)
    v_mfma_f32_16x16x32_bf16 v[68:71], v[36:39], v[184:187], v[68:71]
    ds_read_b64_tr_b16 v[172:173], v9 offset:24576
    ds_read_b64_tr_b16 v[174:175], v9 offset:28672
    v_mfma_f32_16x16x32_bf16 v[100:103], v[36:39], v[188:191], v[100:103]
    ds_read_b64_tr_b16 v[176:177], v10 offset:24576
    v_mfma_f32_16x16x32_bf16 v[72:75], v[40:43], v[184:187], v[72:75]
    ds_read_b64_tr_b16 v[178:179], v10 offset:28672
    ds_read_b64_tr_b16 v[180:181], v11 offset:24576
    v_mfma_f32_16x16x32_bf16 v[104:107], v[40:43], v[188:191], v[104:107]
    ds_read_b64_tr_b16 v[182:183], v11 offset:28672
    v_mfma_f32_16x16x32_bf16 v[76:79], v[44:47], v[184:187], v[76:79]
    v_mfma_f32_16x16x32_bf16 v[108:111], v[44:47], v[188:191], v[108:111]
    s_waitcnt lgkmcnt(14)
    v_mfma_f32_16x16x32_bf16 v[80:83], v[48:51], v[184:187], v[80:83]
    v_mfma_f32_16x16x32_bf16 v[112:115], v[48:51], v[188:191], v[112:115]
    v_mfma_f32_16x16x32_bf16 v[84:87], v[52:55], v[184:187], v[84:87]
    v_mfma_f32_16x16x32_bf16 v[116:119], v[52:55], v[188:191], v[116:119]
    s_waitcnt lgkmcnt(0)
    s_barrier
    v_mfma_f32_16x16x32_bf16 v[56:59], v[152:155], v[192:195], v[56:59]
    ds_read_b64 v[200:201], v16 offset:32768
    ds_read_b64 v[202:203], v17 offset:32768
    v_mfma_f32_16x16x32_bf16 v[88:91], v[152:155], v[196:199], v[88:91]
    ds_read_b64 v[204:205], v16 offset:34816
    ds_read_b64 v[206:207], v17 offset:34816
    v_mfma_f32_16x16x32_bf16 v[60:63], v[156:159], v[192:195], v[60:63]
    ds_read_b64 v[208:209], v18 offset:32768
    ds_read_b64 v[210:211], v19 offset:32768
    v_mfma_f32_16x16x32_bf16 v[92:95], v[156:159], v[196:199], v[92:95]
    ds_read_b64 v[212:213], v18 offset:34816
    ds_read_b64 v[214:215], v19 offset:34816
    v_mfma_f32_16x16x32_bf16 v[64:67], v[160:163], v[192:195], v[64:67]
    ds_read_b64_tr_b16 v[24:25], v4 offset:32768
    ds_read_b64_tr_b16 v[26:27], v4 offset:36864
    v_mfma_f32_16x16x32_bf16 v[96:99], v[160:163], v[196:199], v[96:99]
    ds_read_b64_tr_b16 v[28:29], v5 offset:32768
    ds_read_b64_tr_b16 v[30:31], v5 offset:36864
    v_mfma_f32_16x16x32_bf16 v[68:71], v[164:167], v[192:195], v[68:71]
    ds_read_b64_tr_b16 v[32:33], v6 offset:32768
    v_mfma_f32_16x16x32_bf16 v[100:103], v[164:167], v[196:199], v[100:103]
    ds_read_b64_tr_b16 v[34:35], v6 offset:36864
    ds_read_b64_tr_b16 v[36:37], v7 offset:32768
    v_mfma_f32_16x16x32_bf16 v[72:75], v[168:171], v[192:195], v[72:75]
    ds_read_b64_tr_b16 v[38:39], v7 offset:36864
    v_mfma_f32_16x16x32_bf16 v[104:107], v[168:171], v[196:199], v[104:107]
    ds_read_b64_tr_b16 v[40:41], v8 offset:32768
    ds_read_b64_tr_b16 v[42:43], v8 offset:36864
    v_mfma_f32_16x16x32_bf16 v[76:79], v[172:175], v[192:195], v[76:79]
    ds_read_b64_tr_b16 v[44:45], v9 offset:32768
    ds_read_b64_tr_b16 v[46:47], v9 offset:36864
    v_mfma_f32_16x16x32_bf16 v[108:111], v[172:175], v[196:199], v[108:111]
    ds_read_b64_tr_b16 v[48:49], v10 offset:32768
    v_mfma_f32_16x16x32_bf16 v[80:83], v[176:179], v[192:195], v[80:83]
    ds_read_b64_tr_b16 v[50:51], v10 offset:36864
    ds_read_b64_tr_b16 v[52:53], v11 offset:32768
    v_mfma_f32_16x16x32_bf16 v[112:115], v[176:179], v[196:199], v[112:115]
    ds_read_b64_tr_b16 v[54:55], v11 offset:36864
    v_mfma_f32_16x16x32_bf16 v[84:87], v[180:183], v[192:195], v[84:87]
    v_mfma_f32_16x16x32_bf16 v[116:119], v[180:183], v[196:199], v[116:119]
    s_waitcnt lgkmcnt(14)
    v_mfma_f32_16x16x32_bf16 v[56:59], v[24:27], v[200:203], v[56:59]
    ds_read_b64_tr_b16 v[152:153], v4 offset:40960
    ds_read_b64_tr_b16 v[154:155], v4 offset:45056
    v_mfma_f32_16x16x32_bf16 v[88:91], v[24:27], v[204:207], v[88:91]
    ds_read_b64_tr_b16 v[156:157], v5 offset:40960
    ds_read_b64_tr_b16 v[158:159], v5 offset:45056
    s_waitcnt lgkmcnt(14)
    v_mfma_f32_16x16x32_bf16 v[60:63], v[28:31], v[200:203], v[60:63]
    ds_read_b64_tr_b16 v[160:161], v6 offset:40960
    v_mfma_f32_16x16x32_bf16 v[92:95], v[28:31], v[204:207], v[92:95]
    ds_read_b64_tr_b16 v[162:163], v6 offset:45056
    ds_read_b64_tr_b16 v[164:165], v7 offset:40960
    v_mfma_f32_16x16x32_bf16 v[64:67], v[32:35], v[200:203], v[64:67]
    ds_read_b64_tr_b16 v[166:167], v7 offset:45056
    v_mfma_f32_16x16x32_bf16 v[96:99], v[32:35], v[204:207], v[96:99]
    ds_read_b64_tr_b16 v[168:169], v8 offset:40960
    ds_read_b64_tr_b16 v[170:171], v8 offset:45056
    s_waitcnt lgkmcnt(14)
    v_mfma_f32_16x16x32_bf16 v[68:71], v[36:39], v[200:203], v[68:71]
    ds_read_b64_tr_b16 v[172:173], v9 offset:40960
    ds_read_b64_tr_b16 v[174:175], v9 offset:45056
    v_mfma_f32_16x16x32_bf16 v[100:103], v[36:39], v[204:207], v[100:103]
    ds_read_b64_tr_b16 v[176:177], v10 offset:40960
    v_mfma_f32_16x16x32_bf16 v[72:75], v[40:43], v[200:203], v[72:75]
    ds_read_b64_tr_b16 v[178:179], v10 offset:45056
    ds_read_b64_tr_b16 v[180:181], v11 offset:40960
    v_mfma_f32_16x16x32_bf16 v[104:107], v[40:43], v[204:207], v[104:107]
    ds_read_b64_tr_b16 v[182:183], v11 offset:45056
    v_mfma_f32_16x16x32_bf16 v[76:79], v[44:47], v[200:203], v[76:79]
    v_mfma_f32_16x16x32_bf16 v[108:111], v[44:47], v[204:207], v[108:111]
    s_waitcnt lgkmcnt(14)
    v_mfma_f32_16x16x32_bf16 v[80:83], v[48:51], v[200:203], v[80:83]
    v_mfma_f32_16x16x32_bf16 v[112:115], v[48:51], v[204:207], v[112:115]
    v_mfma_f32_16x16x32_bf16 v[84:87], v[52:55], v[200:203], v[84:87]
    v_mfma_f32_16x16x32_bf16 v[116:119], v[52:55], v[204:207], v[116:119]
    s_waitcnt lgkmcnt(0)
    s_barrier
    v_mfma_f32_16x16x32_bf16 v[56:59], v[152:155], v[208:211], v[56:59]
    ds_read_b64 v[184:185], v16 offset:0
    ds_read_b64 v[186:187], v17 offset:0
    v_mfma_f32_16x16x32_bf16 v[88:91], v[152:155], v[212:215], v[88:91]
    ds_read_b64 v[188:189], v16 offset:2048
    ds_read_b64 v[190:191], v17 offset:2048
    v_mfma_f32_16x16x32_bf16 v[60:63], v[156:159], v[208:211], v[60:63]
    ds_read_b64 v[192:193], v18 offset:0
    ds_read_b64 v[194:195], v19 offset:0
    v_mfma_f32_16x16x32_bf16 v[92:95], v[156:159], v[212:215], v[92:95]
    ds_read_b64 v[196:197], v18 offset:2048
    ds_read_b64 v[198:199], v19 offset:2048
    v_mfma_f32_16x16x32_bf16 v[64:67], v[160:163], v[208:211], v[64:67]
    ds_read_b64_tr_b16 v[24:25], v4 offset:0
    ds_read_b64_tr_b16 v[26:27], v4 offset:4096
    v_mfma_f32_16x16x32_bf16 v[96:99], v[160:163], v[212:215], v[96:99]
    ds_read_b64_tr_b16 v[28:29], v5 offset:0
    ds_read_b64_tr_b16 v[30:31], v5 offset:4096
    v_mfma_f32_16x16x32_bf16 v[68:71], v[164:167], v[208:211], v[68:71]
    ds_read_b64_tr_b16 v[32:33], v6 offset:0
    v_mfma_f32_16x16x32_bf16 v[100:103], v[164:167], v[212:215], v[100:103]
    ds_read_b64_tr_b16 v[34:35], v6 offset:4096
    ds_read_b64_tr_b16 v[36:37], v7 offset:0
    v_mfma_f32_16x16x32_bf16 v[72:75], v[168:171], v[208:211], v[72:75]
    ds_read_b64_tr_b16 v[38:39], v7 offset:4096
    v_mfma_f32_16x16x32_bf16 v[104:107], v[168:171], v[212:215], v[104:107]
    ds_read_b64_tr_b16 v[40:41], v8 offset:0
    ds_read_b64_tr_b16 v[42:43], v8 offset:4096
    v_mfma_f32_16x16x32_bf16 v[76:79], v[172:175], v[208:211], v[76:79]
    ds_read_b64_tr_b16 v[44:45], v9 offset:0
    ds_read_b64_tr_b16 v[46:47], v9 offset:4096
    v_mfma_f32_16x16x32_bf16 v[108:111], v[172:175], v[212:215], v[108:111]
    ds_read_b64_tr_b16 v[48:49], v10 offset:0
    v_mfma_f32_16x16x32_bf16 v[80:83], v[176:179], v[208:211], v[80:83]
    ds_read_b64_tr_b16 v[50:51], v10 offset:4096
    ds_read_b64_tr_b16 v[52:53], v11 offset:0
    v_mfma_f32_16x16x32_bf16 v[112:115], v[176:179], v[212:215], v[112:115]
    ds_read_b64_tr_b16 v[54:55], v11 offset:4096
    v_mfma_f32_16x16x32_bf16 v[84:87], v[180:183], v[208:211], v[84:87]
    v_mfma_f32_16x16x32_bf16 v[116:119], v[180:183], v[212:215], v[116:119]
    s_waitcnt lgkmcnt(14)
    v_mfma_f32_16x16x32_bf16 v[56:59], v[24:27], v[184:187], v[56:59]
    ds_read_b64_tr_b16 v[152:153], v4 offset:8192
    ds_read_b64_tr_b16 v[154:155], v4 offset:12288
    v_mfma_f32_16x16x32_bf16 v[88:91], v[24:27], v[188:191], v[88:91]
    ds_read_b64_tr_b16 v[156:157], v5 offset:8192
    ds_read_b64_tr_b16 v[158:159], v5 offset:12288
    s_waitcnt lgkmcnt(14)
    v_mfma_f32_16x16x32_bf16 v[60:63], v[28:31], v[184:187], v[60:63]
    ds_read_b64_tr_b16 v[160:161], v6 offset:8192
    v_mfma_f32_16x16x32_bf16 v[92:95], v[28:31], v[188:191], v[92:95]
    ds_read_b64_tr_b16 v[162:163], v6 offset:12288
    ds_read_b64_tr_b16 v[164:165], v7 offset:8192
    v_mfma_f32_16x16x32_bf16 v[64:67], v[32:35], v[184:187], v[64:67]
    ds_read_b64_tr_b16 v[166:167], v7 offset:12288
    v_mfma_f32_16x16x32_bf16 v[96:99], v[32:35], v[188:191], v[96:99]
    ds_read_b64_tr_b16 v[168:169], v8 offset:8192
    ds_read_b64_tr_b16 v[170:171], v8 offset:12288
    s_waitcnt lgkmcnt(14)
    v_mfma_f32_16x16x32_bf16 v[68:71], v[36:39], v[184:187], v[68:71]
    ds_read_b64_tr_b16 v[172:173], v9 offset:8192
    ds_read_b64_tr_b16 v[174:175], v9 offset:12288
    v_mfma_f32_16x16x32_bf16 v[100:103], v[36:39], v[188:191], v[100:103]
    ds_read_b64_tr_b16 v[176:177], v10 offset:8192
    v_mfma_f32_16x16x32_bf16 v[72:75], v[40:43], v[184:187], v[72:75]
    ds_read_b64_tr_b16 v[178:179], v10 offset:12288
    ds_read_b64_tr_b16 v[180:181], v11 offset:8192
    v_mfma_f32_16x16x32_bf16 v[104:107], v[40:43], v[188:191], v[104:107]
    ds_read_b64_tr_b16 v[182:183], v11 offset:12288
    v_mfma_f32_16x16x32_bf16 v[76:79], v[44:47], v[184:187], v[76:79]
    v_mfma_f32_16x16x32_bf16 v[108:111], v[44:47], v[188:191], v[108:111]
    s_waitcnt lgkmcnt(14)
    v_mfma_f32_16x16x32_bf16 v[80:83], v[48:51], v[184:187], v[80:83]
    v_mfma_f32_16x16x32_bf16 v[112:115], v[48:51], v[188:191], v[112:115]
    v_mfma_f32_16x16x32_bf16 v[84:87], v[52:55], v[184:187], v[84:87]
    v_mfma_f32_16x16x32_bf16 v[116:119], v[52:55], v[188:191], v[116:119]
    s_waitcnt lgkmcnt(0)
    s_barrier
    v_mfma_f32_16x16x32_bf16 v[56:59], v[152:155], v[192:195], v[56:59]
    ds_read_b64 v[200:201], v16 offset:16384
    ds_read_b64 v[202:203], v17 offset:16384
    v_mfma_f32_16x16x32_bf16 v[88:91], v[152:155], v[196:199], v[88:91]
    ds_read_b64 v[204:205], v16 offset:18432
    ds_read_b64 v[206:207], v17 offset:18432
    v_mfma_f32_16x16x32_bf16 v[60:63], v[156:159], v[192:195], v[60:63]
    ds_read_b64 v[208:209], v18 offset:16384
    ds_read_b64 v[210:211], v19 offset:16384
    v_mfma_f32_16x16x32_bf16 v[92:95], v[156:159], v[196:199], v[92:95]
    ds_read_b64 v[212:213], v18 offset:18432
    ds_read_b64 v[214:215], v19 offset:18432
    v_mfma_f32_16x16x32_bf16 v[64:67], v[160:163], v[192:195], v[64:67]
    ds_read_b64_tr_b16 v[24:25], v4 offset:16384
    ds_read_b64_tr_b16 v[26:27], v4 offset:20480
    v_mfma_f32_16x16x32_bf16 v[96:99], v[160:163], v[196:199], v[96:99]
    ds_read_b64_tr_b16 v[28:29], v5 offset:16384
    ds_read_b64_tr_b16 v[30:31], v5 offset:20480
    v_mfma_f32_16x16x32_bf16 v[68:71], v[164:167], v[192:195], v[68:71]
    ds_read_b64_tr_b16 v[32:33], v6 offset:16384
    v_mfma_f32_16x16x32_bf16 v[100:103], v[164:167], v[196:199], v[100:103]
    ds_read_b64_tr_b16 v[34:35], v6 offset:20480
    ds_read_b64_tr_b16 v[36:37], v7 offset:16384
    v_mfma_f32_16x16x32_bf16 v[72:75], v[168:171], v[192:195], v[72:75]
    ds_read_b64_tr_b16 v[38:39], v7 offset:20480
    v_mfma_f32_16x16x32_bf16 v[104:107], v[168:171], v[196:199], v[104:107]
    ds_read_b64_tr_b16 v[40:41], v8 offset:16384
    ds_read_b64_tr_b16 v[42:43], v8 offset:20480
    v_mfma_f32_16x16x32_bf16 v[76:79], v[172:175], v[192:195], v[76:79]
    ds_read_b64_tr_b16 v[44:45], v9 offset:16384
    ds_read_b64_tr_b16 v[46:47], v9 offset:20480
    v_mfma_f32_16x16x32_bf16 v[108:111], v[172:175], v[196:199], v[108:111]
    ds_read_b64_tr_b16 v[48:49], v10 offset:16384
    v_mfma_f32_16x16x32_bf16 v[80:83], v[176:179], v[192:195], v[80:83]
    ds_read_b64_tr_b16 v[50:51], v10 offset:20480
    ds_read_b64_tr_b16 v[52:53], v11 offset:16384
    v_mfma_f32_16x16x32_bf16 v[112:115], v[176:179], v[196:199], v[112:115]
    ds_read_b64_tr_b16 v[54:55], v11 offset:20480
    v_mfma_f32_16x16x32_bf16 v[84:87], v[180:183], v[192:195], v[84:87]
    v_mfma_f32_16x16x32_bf16 v[116:119], v[180:183], v[196:199], v[116:119]
    s_waitcnt lgkmcnt(14)
    v_mfma_f32_16x16x32_bf16 v[56:59], v[24:27], v[200:203], v[56:59]
    ds_read_b64_tr_b16 v[152:153], v4 offset:24576
    ds_read_b64_tr_b16 v[154:155], v4 offset:28672
    v_mfma_f32_16x16x32_bf16 v[88:91], v[24:27], v[204:207], v[88:91]
    ds_read_b64_tr_b16 v[156:157], v5 offset:24576
    ds_read_b64_tr_b16 v[158:159], v5 offset:28672
    s_waitcnt lgkmcnt(14)
    v_mfma_f32_16x16x32_bf16 v[60:63], v[28:31], v[200:203], v[60:63]
    ds_read_b64_tr_b16 v[160:161], v6 offset:24576
    v_mfma_f32_16x16x32_bf16 v[92:95], v[28:31], v[204:207], v[92:95]
    ds_read_b64_tr_b16 v[162:163], v6 offset:28672
    ds_read_b64_tr_b16 v[164:165], v7 offset:24576
    v_mfma_f32_16x16x32_bf16 v[64:67], v[32:35], v[200:203], v[64:67]
    ds_read_b64_tr_b16 v[166:167], v7 offset:28672
    v_mfma_f32_16x16x32_bf16 v[96:99], v[32:35], v[204:207], v[96:99]
    ds_read_b64_tr_b16 v[168:169], v8 offset:24576
    ds_read_b64_tr_b16 v[170:171], v8 offset:28672
    s_waitcnt lgkmcnt(14)
    v_mfma_f32_16x16x32_bf16 v[68:71], v[36:39], v[200:203], v[68:71]
    ds_read_b64_tr_b16 v[172:173], v9 offset:24576
    ds_read_b64_tr_b16 v[174:175], v9 offset:28672
    v_mfma_f32_16x16x32_bf16 v[100:103], v[36:39], v[204:207], v[100:103]
    ds_read_b64_tr_b16 v[176:177], v10 offset:24576
    v_mfma_f32_16x16x32_bf16 v[72:75], v[40:43], v[200:203], v[72:75]
    ds_read_b64_tr_b16 v[178:179], v10 offset:28672
    ds_read_b64_tr_b16 v[180:181], v11 offset:24576
    v_mfma_f32_16x16x32_bf16 v[104:107], v[40:43], v[204:207], v[104:107]
    ds_read_b64_tr_b16 v[182:183], v11 offset:28672
    v_mfma_f32_16x16x32_bf16 v[76:79], v[44:47], v[200:203], v[76:79]
    v_mfma_f32_16x16x32_bf16 v[108:111], v[44:47], v[204:207], v[108:111]
    s_waitcnt lgkmcnt(14)
    v_mfma_f32_16x16x32_bf16 v[80:83], v[48:51], v[200:203], v[80:83]
    v_mfma_f32_16x16x32_bf16 v[112:115], v[48:51], v[204:207], v[112:115]
    v_mfma_f32_16x16x32_bf16 v[84:87], v[52:55], v[200:203], v[84:87]
    v_mfma_f32_16x16x32_bf16 v[116:119], v[52:55], v[204:207], v[116:119]
    s_waitcnt lgkmcnt(0)
    s_barrier
    v_mfma_f32_16x16x32_bf16 v[56:59], v[152:155], v[208:211], v[56:59]
    v_mfma_f32_16x16x32_bf16 v[88:91], v[152:155], v[212:215], v[88:91]
    v_mfma_f32_16x16x32_bf16 v[60:63], v[156:159], v[208:211], v[60:63]
    v_mfma_f32_16x16x32_bf16 v[92:95], v[156:159], v[212:215], v[92:95]
    v_mfma_f32_16x16x32_bf16 v[64:67], v[160:163], v[208:211], v[64:67]
    v_mfma_f32_16x16x32_bf16 v[96:99], v[160:163], v[212:215], v[96:99]
    v_mfma_f32_16x16x32_bf16 v[68:71], v[164:167], v[208:211], v[68:71]
    v_mfma_f32_16x16x32_bf16 v[100:103], v[164:167], v[212:215], v[100:103]
    v_mfma_f32_16x16x32_bf16 v[72:75], v[168:171], v[208:211], v[72:75]
    v_mfma_f32_16x16x32_bf16 v[104:107], v[168:171], v[212:215], v[104:107]
    v_mfma_f32_16x16x32_bf16 v[76:79], v[172:175], v[208:211], v[76:79]
    v_mfma_f32_16x16x32_bf16 v[108:111], v[172:175], v[212:215], v[108:111]
    v_mfma_f32_16x16x32_bf16 v[80:83], v[176:179], v[208:211], v[80:83]
    v_mfma_f32_16x16x32_bf16 v[112:115], v[176:179], v[212:215], v[112:115]
    v_mfma_f32_16x16x32_bf16 v[84:87], v[180:183], v[208:211], v[84:87]
    v_mfma_f32_16x16x32_bf16 v[116:119], v[180:183], v[212:215], v[116:119]
    v_add_u32 v4, 0xffff0000, v4
    v_add_u32 v5, 0xffff0000, v5
    v_add_u32 v6, 0xffff0000, v6
    v_add_u32 v7, 0xffff0000, v7
    v_add_u32 v8, 0xffff0000, v8
    v_add_u32 v9, 0xffff0000, v9
    v_add_u32 v10, 0xffff0000, v10
    v_add_u32 v11, 0xffff0000, v11
    v_mul_f32 v56, s62, v56
    v_mul_f32 v57, s62, v57
    v_mul_f32 v58, s62, v58
    v_mul_f32 v59, s62, v59
    v_mul_f32 v60, s62, v60
    v_mul_f32 v61, s62, v61
    v_mul_f32 v62, s62, v62
    v_mul_f32 v63, s62, v63
    v_cvt_pk_bf16_f32 v120, v56, v57
    v_cvt_pk_bf16_f32 v121, v58, v59
    v_cvt_pk_bf16_f32 v122, v60, v61
    v_cvt_pk_bf16_f32 v123, v62, v63
    v_mul_f32 v64, s62, v64
    v_mul_f32 v65, s62, v65
    v_mul_f32 v66, s62, v66
    v_mul_f32 v67, s62, v67
    v_mul_f32 v68, s62, v68
    v_mul_f32 v69, s62, v69
    v_mul_f32 v70, s62, v70
    v_mul_f32 v71, s62, v71
    v_cvt_pk_bf16_f32 v124, v64, v65
    v_cvt_pk_bf16_f32 v125, v66, v67
    v_cvt_pk_bf16_f32 v126, v68, v69
    v_cvt_pk_bf16_f32 v127, v70, v71
    v_mul_f32 v72, s62, v72
    v_mul_f32 v73, s62, v73
    v_mul_f32 v74, s62, v74
    v_mul_f32 v75, s62, v75
    v_mul_f32 v76, s62, v76
    v_mul_f32 v77, s62, v77
    v_mul_f32 v78, s62, v78
    v_mul_f32 v79, s62, v79
    v_cvt_pk_bf16_f32 v128, v72, v73
    v_cvt_pk_bf16_f32 v129, v74, v75
    v_cvt_pk_bf16_f32 v130, v76, v77
    v_cvt_pk_bf16_f32 v131, v78, v79
    v_mul_f32 v80, s62, v80
    v_mul_f32 v81, s62, v81
    v_mul_f32 v82, s62, v82
    v_mul_f32 v83, s62, v83
    v_mul_f32 v84, s62, v84
    v_mul_f32 v85, s62, v85
    v_mul_f32 v86, s62, v86
    v_mul_f32 v87, s62, v87
    v_cvt_pk_bf16_f32 v132, v80, v81
    v_cvt_pk_bf16_f32 v133, v82, v83
    v_cvt_pk_bf16_f32 v134, v84, v85
    v_cvt_pk_bf16_f32 v135, v86, v87
    v_mul_f32 v88, s62, v88
    v_mul_f32 v89, s62, v89
    v_mul_f32 v90, s62, v90
    v_mul_f32 v91, s62, v91
    v_mul_f32 v92, s62, v92
    v_mul_f32 v93, s62, v93
    v_mul_f32 v94, s62, v94
    v_mul_f32 v95, s62, v95
    v_cvt_pk_bf16_f32 v136, v88, v89
    v_cvt_pk_bf16_f32 v137, v90, v91
    v_cvt_pk_bf16_f32 v138, v92, v93
    v_cvt_pk_bf16_f32 v139, v94, v95
    v_mul_f32 v96, s62, v96
    v_mul_f32 v97, s62, v97
    v_mul_f32 v98, s62, v98
    v_mul_f32 v99, s62, v99
    v_mul_f32 v100, s62, v100
    v_mul_f32 v101, s62, v101
    v_mul_f32 v102, s62, v102
    v_mul_f32 v103, s62, v103
    v_cvt_pk_bf16_f32 v140, v96, v97
    v_cvt_pk_bf16_f32 v141, v98, v99
    v_cvt_pk_bf16_f32 v142, v100, v101
    v_cvt_pk_bf16_f32 v143, v102, v103
    v_mul_f32 v104, s62, v104
    v_mul_f32 v105, s62, v105
    v_mul_f32 v106, s62, v106
    v_mul_f32 v107, s62, v107
    v_mul_f32 v108, s62, v108
    v_mul_f32 v109, s62, v109
    v_mul_f32 v110, s62, v110
    v_mul_f32 v111, s62, v111
    v_cvt_pk_bf16_f32 v144, v104, v105
    v_cvt_pk_bf16_f32 v145, v106, v107
    v_cvt_pk_bf16_f32 v146, v108, v109
    v_cvt_pk_bf16_f32 v147, v110, v111
    v_mul_f32 v112, s62, v112
    v_mul_f32 v113, s62, v113
    v_mul_f32 v114, s62, v114
    v_mul_f32 v115, s62, v115
    v_mul_f32 v116, s62, v116
    v_mul_f32 v117, s62, v117
    v_mul_f32 v118, s62, v118
    v_mul_f32 v119, s62, v119
    v_cvt_pk_bf16_f32 v148, v112, v113
    v_cvt_pk_bf16_f32 v149, v114, v115
    v_cvt_pk_bf16_f32 v150, v116, v117
    v_cvt_pk_bf16_f32 v151, v118, v119
    s_barrier
    ds_read_b128 v[152:155], v0 offset:0
    ds_read_b128 v[156:159], v0 offset:4096
    ds_read_b128 v[160:163], v1 offset:0
    ds_read_b128 v[164:167], v1 offset:4096
    ds_read_b128 v[168:171], v2 offset:0
    ds_read_b128 v[172:175], v2 offset:4096
    ds_read_b128 v[176:179], v3 offset:0
    ds_read_b128 v[180:183], v3 offset:4096
    s_nop 1
    v_permlane32_swap_b32 v120, v122
    v_permlane32_swap_b32 v121, v123
    v_permlane32_swap_b32 v124, v126
    v_permlane32_swap_b32 v125, v127
    v_permlane32_swap_b32 v128, v130
    v_permlane32_swap_b32 v129, v131
    v_permlane32_swap_b32 v132, v134
    v_permlane32_swap_b32 v133, v135
    v_permlane32_swap_b32 v136, v138
    v_permlane32_swap_b32 v137, v139
    v_permlane32_swap_b32 v140, v142
    v_permlane32_swap_b32 v141, v143
    v_permlane32_swap_b32 v144, v146
    v_permlane32_swap_b32 v145, v147
    v_permlane32_swap_b32 v148, v150
    v_permlane32_swap_b32 v149, v151
    s_nop 1
    v_permlane16_swap_b32 v120, v122
    v_permlane16_swap_b32 v121, v123
    v_permlane16_swap_b32 v124, v126
    v_permlane16_swap_b32 v125, v127
    v_permlane16_swap_b32 v128, v130
    v_permlane16_swap_b32 v129, v131
    v_permlane16_swap_b32 v132, v134
    v_permlane16_swap_b32 v133, v135
    v_permlane16_swap_b32 v136, v138
    v_permlane16_swap_b32 v137, v139
    v_permlane16_swap_b32 v140, v142
    v_permlane16_swap_b32 v141, v143
    v_permlane16_swap_b32 v144, v146
    v_permlane16_swap_b32 v145, v147
    v_permlane16_swap_b32 v148, v150
    v_permlane16_swap_b32 v149, v151
    s_nop 1
    s_branch L_att
L_rare0:
    v_max3_f32 v18, v200, v201, v202
    v_max3_f32 v18, v18, v203, v204
    v_max3_f32 v18, v18, v205, v206
    v_max_f32 v18, v18, v207
    v_mov_b32 v19, v18
    s_nop 1
    v_permlane32_swap_b32 v19, v18
    s_nop 1
    v_max_f32 v18, v18, v19
    v_mov_b32 v19, v18
    s_nop 1
    v_permlane16_swap_b32 v19, v18
    s_nop 1
    v_max_f32 v18, v18, v19
    v_max_f32 v18, 0, v18
    v_exp_f32 v20, -v18
    v_sub_f32 v216, v216, v18
    v_sub_f32 v217, v217, v18
    v_sub_f32 v218, v218, v18
    v_sub_f32 v219, v219, v18
    v_sub_f32 v200, v200, v18
    v_sub_f32 v201, v201, v18
    v_sub_f32 v202, v202, v18
    v_sub_f32 v203, v203, v18
    v_sub_f32 v204, v204, v18
    v_sub_f32 v205, v205, v18
    v_sub_f32 v206, v206, v18
    v_sub_f32 v207, v207, v18
    v_mul_f32 v16, v16, v20
    v_mul_f32 v56, v56, v20
    v_mul_f32 v57, v57, v20
    v_mul_f32 v58, v58, v20
    v_mul_f32 v59, v59, v20
    v_mul_f32 v60, v60, v20
    v_mul_f32 v61, v61, v20
    v_mul_f32 v62, v62, v20
    v_mul_f32 v63, v63, v20
    v_mul_f32 v64, v64, v20
    v_mul_f32 v65, v65, v20
    v_mul_f32 v66, v66, v20
    v_mul_f32 v67, v67, v20
    v_mul_f32 v68, v68, v20
    v_mul_f32 v69, v69, v20
    v_mul_f32 v70, v70, v20
    v_mul_f32 v71, v71, v20
    v_mul_f32 v72, v72, v20
    v_mul_f32 v73, v73, v20
    v_mul_f32 v74, v74, v20
    v_mul_f32 v75, v75, v20
    v_mul_f32 v76, v76, v20
    v_mul_f32 v77, v77, v20
    v_mul_f32 v78, v78, v20
    v_mul_f32 v79, v79, v20
    v_mul_f32 v80, v80, v20
    v_mul_f32 v81, v81, v20
    v_mul_f32 v82, v82, v20
    v_mul_f32 v83, v83, v20
    v_mul_f32 v84, v84, v20
    v_mul_f32 v85, v85, v20
    v_mul_f32 v86, v86, v20
    v_mul_f32 v87, v87, v20
    v_max3_f32 v18, v208, v209, v210
    v_max3_f32 v18, v18, v211, v212
    v_max3_f32 v18, v18, v213, v214
    v_max_f32 v18, v18, v215
    v_mov_b32 v19, v18
    s_nop 1
    v_permlane32_swap_b32 v19, v18
    s_nop 1
    v_max_f32 v18, v18, v19
    v_mov_b32 v19, v18
    s_nop 1
    v_permlane16_swap_b32 v19, v18
    s_nop 1
    v_max_f32 v18, v18, v19
    v_max_f32 v18, 0, v18
    v_exp_f32 v20, -v18
    v_sub_f32 v220, v220, v18
    v_sub_f32 v221, v221, v18
    v_sub_f32 v222, v222, v18
    v_sub_f32 v223, v223, v18
    v_sub_f32 v208, v208, v18
    v_sub_f32 v209, v209, v18
    v_sub_f32 v210, v210, v18
    v_sub_f32 v211, v211, v18
    v_sub_f32 v212, v212, v18
    v_sub_f32 v213, v213, v18
    v_sub_f32 v214, v214, v18
    v_sub_f32 v215, v215, v18
    v_mul_f32 v17, v17, v20
    v_mul_f32 v88, v88, v20
    v_mul_f32 v89, v89, v20
    v_mul_f32 v90, v90, v20
    v_mul_f32 v91, v91, v20
    v_mul_f32 v92, v92, v20
    v_mul_f32 v93, v93, v20
    v_mul_f32 v94, v94, v20
    v_mul_f32 v95, v95, v20
    v_mul_f32 v96, v96, v20
    v_mul_f32 v97, v97, v20
    v_mul_f32 v98, v98, v20
    v_mul_f32 v99, v99, v20
    v_mul_f32 v100, v100, v20
    v_mul_f32 v101, v101, v20
    v_mul_f32 v102, v102, v20
    v_mul_f32 v103, v103, v20
    v_mul_f32 v104, v104, v20
    v_mul_f32 v105, v105, v20
    v_mul_f32 v106, v106, v20
    v_mul_f32 v107, v107, v20
    v_mul_f32 v108, v108, v20
    v_mul_f32 v109, v109, v20
    v_mul_f32 v110, v110, v20
    v_mul_f32 v111, v111, v20
    v_mul_f32 v112, v112, v20
    v_mul_f32 v113, v113, v20
    v_mul_f32 v114, v114, v20
    v_mul_f32 v115, v115, v20
    v_mul_f32 v116, v116, v20
    v_mul_f32 v117, v117, v20
    v_mul_f32 v118, v118, v20
    v_mul_f32 v119, v119, v20
    s_branch L_back0
L_rare1:
    v_max3_f32 v18, v184, v185, v186
    v_max3_f32 v18, v18, v187, v188
    v_max3_f32 v18, v18, v189, v190
    v_max_f32 v18, v18, v191
    v_mov_b32 v19, v18
    s_nop 1
    v_permlane32_swap_b32 v19, v18
    s_nop 1
    v_max_f32 v18, v18, v19
    v_mov_b32 v19, v18
    s_nop 1
    v_permlane16_swap_b32 v19, v18
    s_nop 1
    v_max_f32 v18, v18, v19
    v_max_f32 v18, 0, v18
    v_exp_f32 v20, -v18
    v_sub_f32 v216, v216, v18
    v_sub_f32 v217, v217, v18
    v_sub_f32 v218, v218, v18
    v_sub_f32 v219, v219, v18
    v_sub_f32 v184, v184, v18
    v_sub_f32 v185, v185, v18
    v_sub_f32 v186, v186, v18
    v_sub_f32 v187, v187, v18
    v_sub_f32 v188, v188, v18
    v_sub_f32 v189, v189, v18
    v_sub_f32 v190, v190, v18
    v_sub_f32 v191, v191, v18
    v_mul_f32 v16, v16, v20
    v_mul_f32 v56, v56, v20
    v_mul_f32 v57, v57, v20
    v_mul_f32 v58, v58, v20
    v_mul_f32 v59, v59, v20
    v_mul_f32 v60, v60, v20
    v_mul_f32 v61, v61, v20
    v_mul_f32 v62, v62, v20
    v_mul_f32 v63, v63, v20
    v_mul_f32 v64, v64, v20
    v_mul_f32 v65, v65, v20
    v_mul_f32 v66, v66, v20
    v_mul_f32 v67, v67, v20
    v_mul_f32 v68, v68, v20
    v_mul_f32 v69, v69, v20
    v_mul_f32 v70, v70, v20
    v_mul_f32 v71, v71, v20
    v_mul_f32 v72, v72, v20
    v_mul_f32 v73, v73, v20
    v_mul_f32 v74, v74, v20
    v_mul_f32 v75, v75, v20
    v_mul_f32 v76, v76, v20
    v_mul_f32 v77, v77, v20
    v_mul_f32 v78, v78, v20
    v_mul_f32 v79, v79, v20
    v_mul_f32 v80, v80, v20
    v_mul_f32 v81, v81, v20
    v_mul_f32 v82, v82, v20
    v_mul_f32 v83, v83, v20
    v_mul_f32 v84, v84, v20
    v_mul_f32 v85, v85, v20
    v_mul_f32 v86, v86, v20
    v_mul_f32 v87, v87, v20
    v_max3_f32 v18, v192, v193, v194
    v_max3_f32 v18, v18, v195, v196
    v_max3_f32 v18, v18, v197, v198
    v_max_f32 v18, v18, v199
    v_mov_b32 v19, v18
    s_nop 1
    v_permlane32_swap_b32 v19, v18
    s_nop 1
    v_max_f32 v18, v18, v19
    v_mov_b32 v19, v18
    s_nop 1
    v_permlane16_swap_b32 v19, v18
    s_nop 1
    v_max_f32 v18, v18, v19
    v_max_f32 v18, 0, v18
    v_exp_f32 v20, -v18
    v_sub_f32 v220, v220, v18
    v_sub_f32 v221, v221, v18
    v_sub_f32 v222, v222, v18
    v_sub_f32 v223, v223, v18
    v_sub_f32 v192, v192, v18
    v_sub_f32 v193, v193, v18
    v_sub_f32 v194, v194, v18
    v_sub_f32 v195, v195, v18
    v_sub_f32 v196, v196, v18
    v_sub_f32 v197, v197, v18
    v_sub_f32 v198, v198, v18
    v_sub_f32 v199, v199, v18
    v_mul_f32 v17, v17, v20
    v_mul_f32 v88, v88, v20
    v_mul_f32 v89, v89, v20
    v_mul_f32 v90, v90, v20
    v_mul_f32 v91, v91, v20
    v_mul_f32 v92, v92, v20
    v_mul_f32 v93, v93, v20
    v_mul_f32 v94, v94, v20
    v_mul_f32 v95, v95, v20
    v_mul_f32 v96, v96, v20
    v_mul_f32 v97, v97, v20
    v_mul_f32 v98, v98, v20
    v_mul_f32 v99, v99, v20
    v_mul_f32 v100, v100, v20
    v_mul_f32 v101, v101, v20
    v_mul_f32 v102, v102, v20
    v_mul_f32 v103, v103, v20
    v_mul_f32 v104, v104, v20
    v_mul_f32 v105, v105, v20
    v_mul_f32 v106, v106, v20
    v_mul_f32 v107, v107, v20
    v_mul_f32 v108, v108, v20
    v_mul_f32 v109, v109, v20
    v_mul_f32 v110, v110, v20
    v_mul_f32 v111, v111, v20
    v_mul_f32 v112, v112, v20
    v_mul_f32 v113, v113, v20
    v_mul_f32 v114, v114, v20
    v_mul_f32 v115, v115, v20
    v_mul_f32 v116, v116, v20
    v_mul_f32 v117, v117, v20
    v_mul_f32 v118, v118, v20
    v_mul_f32 v119, v119, v20
    s_branch L_back1
L_rare2:
    v_max3_f32 v18, v200, v201, v202
    v_max3_f32 v18, v18, v203, v204
    v_max3_f32 v18, v18, v205, v206
    v_max_f32 v18, v18, v207
    v_mov_b32 v19, v18
    s_nop 1
    v_permlane32_swap_b32 v19, v18
    s_nop 1
    v_max_f32 v18, v18, v19
    v_mov_b32 v19, v18
    s_nop 1
    v_permlane16_swap_b32 v19, v18
    s_nop 1
    v_max_f32 v18, v18, v19
    v_max_f32 v18, 0, v18
    v_exp_f32 v20, -v18
    v_sub_f32 v216, v216, v18
    v_sub_f32 v217, v217, v18
    v_sub_f32 v218, v218, v18
    v_sub_f32 v219, v219, v18
    v_sub_f32 v200, v200, v18
    v_sub_f32 v201, v201, v18
    v_sub_f32 v202, v202, v18
    v_sub_f32 v203, v203, v18
    v_sub_f32 v204, v204, v18
    v_sub_f32 v205, v205, v18
    v_sub_f32 v206, v206, v18
    v_sub_f32 v207, v207, v18
    v_mul_f32 v16, v16, v20
    v_mul_f32 v56, v56, v20
    v_mul_f32 v57, v57, v20
    v_mul_f32 v58, v58, v20
    v_mul_f32 v59, v59, v20
    v_mul_f32 v60, v60, v20
    v_mul_f32 v61, v61, v20
    v_mul_f32 v62, v62, v20
    v_mul_f32 v63, v63, v20
    v_mul_f32 v64, v64, v20
    v_mul_f32 v65, v65, v20
    v_mul_f32 v66, v66, v20
    v_mul_f32 v67, v67, v20
    v_mul_f32 v68, v68, v20
    v_mul_f32 v69, v69, v20
    v_mul_f32 v70, v70, v20
    v_mul_f32 v71, v71, v20
    v_mul_f32 v72, v72, v20
    v_mul_f32 v73, v73, v20
    v_mul_f32 v74, v74, v20
    v_mul_f32 v75, v75, v20
    v_mul_f32 v76, v76, v20
    v_mul_f32 v77, v77, v20
    v_mul_f32 v78, v78, v20
    v_mul_f32 v79, v79, v20
    v_mul_f32 v80, v80, v20
    v_mul_f32 v81, v81, v20
    v_mul_f32 v82, v82, v20
    v_mul_f32 v83, v83, v20
    v_mul_f32 v84, v84, v20
    v_mul_f32 v85, v85, v20
    v_mul_f32 v86, v86, v20
    v_mul_f32 v87, v87, v20
    v_max3_f32 v18, v208, v209, v210
    v_max3_f32 v18, v18, v211, v212
    v_max3_f32 v18, v18, v213, v214
    v_max_f32 v18, v18, v215
    v_mov_b32 v19, v18
    s_nop 1
    v_permlane32_swap_b32 v19, v18
    s_nop 1
    v_max_f32 v18, v18, v19
    v_mov_b32 v19, v18
    s_nop 1
    v_permlane16_swap_b32 v19, v18
    s_nop 1
    v_max_f32 v18, v18, v19
    v_max_f32 v18, 0, v18
    v_exp_f32 v20, -v18
    v_sub_f32 v220, v220, v18
    v_sub_f32 v221, v221, v18
    v_sub_f32 v222, v222, v18
    v_sub_f32 v223, v223, v18
    v_sub_f32 v208, v208, v18
    v_sub_f32 v209, v209, v18
    v_sub_f32 v210, v210, v18
    v_sub_f32 v211, v211, v18
    v_sub_f32 v212, v212, v18
    v_sub_f32 v213, v213, v18
    v_sub_f32 v214, v214, v18
    v_sub_f32 v215, v215, v18
    v_mul_f32 v17, v17, v20
    v_mul_f32 v88, v88, v20
    v_mul_f32 v89, v89, v20
    v_mul_f32 v90, v90, v20
    v_mul_f32 v91, v91, v20
    v_mul_f32 v92, v92, v20
    v_mul_f32 v93, v93, v20
    v_mul_f32 v94, v94, v20
    v_mul_f32 v95, v95, v20
    v_mul_f32 v96, v96, v20
    v_mul_f32 v97, v97, v20
    v_mul_f32 v98, v98, v20
    v_mul_f32 v99, v99, v20
    v_mul_f32 v100, v100, v20
    v_mul_f32 v101, v101, v20
    v_mul_f32 v102, v102, v20
    v_mul_f32 v103, v103, v20
    v_mul_f32 v104, v104, v20
    v_mul_f32 v105, v105, v20
    v_mul_f32 v106, v106, v20
    v_mul_f32 v107, v107, v20
    v_mul_f32 v108, v108, v20
    v_mul_f32 v109, v109, v20
    v_mul_f32 v110, v110, v20
    v_mul_f32 v111, v111, v20
    v_mul_f32 v112, v112, v20
    v_mul_f32 v113, v113, v20
    v_mul_f32 v114, v114, v20
    v_mul_f32 v115, v115, v20
    v_mul_f32 v116, v116, v20
    v_mul_f32 v117, v117, v20
    v_mul_f32 v118, v118, v20
    v_mul_f32 v119, v119, v20
    s_branch L_back2
L_rare3:
    v_max3_f32 v18, v184, v185, v186
    v_max3_f32 v18, v18, v187, v188
    v_max3_f32 v18, v18, v189, v190
    v_max_f32 v18, v18, v191
    v_mov_b32 v19, v18
    s_nop 1
    v_permlane32_swap_b32 v19, v18
    s_nop 1
    v_max_f32 v18, v18, v19
    v_mov_b32 v19, v18
    s_nop 1
    v_permlane16_swap_b32 v19, v18
    s_nop 1
    v_max_f32 v18, v18, v19
    v_max_f32 v18, 0, v18
    v_exp_f32 v20, -v18
    v_sub_f32 v216, v216, v18
    v_sub_f32 v217, v217, v18
    v_sub_f32 v218, v218, v18
    v_sub_f32 v219, v219, v18
    v_sub_f32 v184, v184, v18
    v_sub_f32 v185, v185, v18
    v_sub_f32 v186, v186, v18
    v_sub_f32 v187, v187, v18
    v_sub_f32 v188, v188, v18
    v_sub_f32 v189, v189, v18
    v_sub_f32 v190, v190, v18
    v_sub_f32 v191, v191, v18
    v_mul_f32 v16, v16, v20
    v_mul_f32 v56, v56, v20
    v_mul_f32 v57, v57, v20
    v_mul_f32 v58, v58, v20
    v_mul_f32 v59, v59, v20
    v_mul_f32 v60, v60, v20
    v_mul_f32 v61, v61, v20
    v_mul_f32 v62, v62, v20
    v_mul_f32 v63, v63, v20
    v_mul_f32 v64, v64, v20
    v_mul_f32 v65, v65, v20
    v_mul_f32 v66, v66, v20
    v_mul_f32 v67, v67, v20
    v_mul_f32 v68, v68, v20
    v_mul_f32 v69, v69, v20
    v_mul_f32 v70, v70, v20
    v_mul_f32 v71, v71, v20
    v_mul_f32 v72, v72, v20
    v_mul_f32 v73, v73, v20
    v_mul_f32 v74, v74, v20
    v_mul_f32 v75, v75, v20
    v_mul_f32 v76, v76, v20
    v_mul_f32 v77, v77, v20
    v_mul_f32 v78, v78, v20
    v_mul_f32 v79, v79, v20
    v_mul_f32 v80, v80, v20
    v_mul_f32 v81, v81, v20
    v_mul_f32 v82, v82, v20
    v_mul_f32 v83, v83, v20
    v_mul_f32 v84, v84, v20
    v_mul_f32 v85, v85, v20
    v_mul_f32 v86, v86, v20
    v_mul_f32 v87, v87, v20
    v_max3_f32 v18, v192, v193, v194
    v_max3_f32 v18, v18, v195, v196
    v_max3_f32 v18, v18, v197, v198
    v_max_f32 v18, v18, v199
    v_mov_b32 v19, v18
    s_nop 1
    v_permlane32_swap_b32 v19, v18
    s_nop 1
    v_max_f32 v18, v18, v19
    v_mov_b32 v19, v18
    s_nop 1
    v_permlane16_swap_b32 v19, v18
    s_nop 1
    v_max_f32 v18, v18, v19
    v_max_f32 v18, 0, v18
    v_exp_f32 v20, -v18
    v_sub_f32 v220, v220, v18
    v_sub_f32 v221, v221, v18
    v_sub_f32 v222, v222, v18
    v_sub_f32 v223, v223, v18
    v_sub_f32 v192, v192, v18
    v_sub_f32 v193, v193, v18
    v_sub_f32 v194, v194, v18
    v_sub_f32 v195, v195, v18
    v_sub_f32 v196, v196, v18
    v_sub_f32 v197, v197, v18
    v_sub_f32 v198, v198, v18
    v_sub_f32 v199, v199, v18
    v_mul_f32 v17, v17, v20
    v_mul_f32 v88, v88, v20
    v_mul_f32 v89, v89, v20
    v_mul_f32 v90, v90, v20
    v_mul_f32 v91, v91, v20
    v_mul_f32 v92, v92, v20
    v_mul_f32 v93, v93, v20
    v_mul_f32 v94, v94, v20
    v_mul_f32 v95, v95, v20
    v_mul_f32 v96, v96, v20
    v_mul_f32 v97, v97, v20
    v_mul_f32 v98, v98, v20
    v_mul_f32 v99, v99, v20
    v_mul_f32 v100, v100, v20
    v_mul_f32 v101, v101, v20
    v_mul_f32 v102, v102, v20
    v_mul_f32 v103, v103, v20
    v_mul_f32 v104, v104, v20
    v_mul_f32 v105, v105, v20
    v_mul_f32 v106, v106, v20
    v_mul_f32 v107, v107, v20
    v_mul_f32 v108, v108, v20
    v_mul_f32 v109, v109, v20
    v_mul_f32 v110, v110, v20
    v_mul_f32 v111, v111, v20
    v_mul_f32 v112, v112, v20
    v_mul_f32 v113, v113, v20
    v_mul_f32 v114, v114, v20
    v_mul_f32 v115, v115, v20
    v_mul_f32 v116, v116, v20
    v_mul_f32 v117, v117, v20
    v_mul_f32 v118, v118, v20
    v_mul_f32 v119, v119, v20
    s_branch L_back3
L_codeend:
.section .rodata,"a"
.p2align 6
.amdhsa_kernel concat_heads__mha_block_cached__gqa_block_cached__near_ridge_kernel
  .amdhsa_next_free_vgpr 256
  .amdhsa_next_free_sgpr 102
  .amdhsa_accum_offset 256
  .amdhsa_group_segment_fixed_size 0
  .amdhsa_kernarg_size 104
  .amdhsa_user_sgpr_count 2
  .amdhsa_user_sgpr_kernarg_segment_ptr 1
  .amdhsa_system_sgpr_workgroup_id_x 1
.end_amdhsa_kernel
```
